```python
import torch

def _softmax(x, axis=-1):
    return torch.softmax(x, dim=axis)
def _gelu(x):
    return torch.nn.functional.gelu(x, approximate="tanh")
def _silu(x):
    return torch.nn.functional.silu(x)
def _sigmoid(x):
    return torch.sigmoid(x)
def _layernorm(x, axis=-1, eps=1e-5):
    m = x.mean(dim=axis, keepdim=True)
    v = x.var(dim=axis, keepdim=True, unbiased=False)
    return (x - m) / torch.sqrt(v + eps)
def _scatter_add(tgt, idx, src, axis=0):
    return tgt.clone().index_add_(axis, idx, src)
def _segment_sum(src, seg, n):
    out = torch.zeros((n,) + src.shape[1:], dtype=src.dtype)
    return out.index_add_(0, seg, src)
def _pad(x, pw):
    flat = tuple(v for pair in reversed(pw) for v in pair)
    return torch.nn.functional.pad(x, flat)

kernel_name = 'gated_mix__linear_kernel_hedgehog__mixer_s_mlp__prompt'

def setup_inputs():

    _w = (lambda a: (lambda t: t.to(torch.bfloat16) if t.is_floating_point() else t)(torch.as_tensor(a)))
    def _A_setup():
        B, S, D, H = 1, 2048, 448, 16
        Dh = D // H
        return {
            "x": _w((lambda *s: torch.randn(*s, dtype=torch.bfloat16) * 0.05)(B, S, D)),
            "wqkv": _w((lambda *s: torch.randn(*s, dtype=torch.bfloat16) * 1.6)(D, 3 * D)),
            "w_phi": _w((lambda *s: torch.randn(*s, dtype=torch.bfloat16) * 1.6)(H, Dh, Dh) * (Dh ** -0.5)),
            "wo": _w((lambda *s: torch.randn(*s, dtype=torch.bfloat16) * 0.1)(D, D)),
        }
    _A_in = _A_setup()

    def _B_setup():
        B, S, D, F = 1, 2048, 448, 1792
        return {
            "x":  _w((lambda *s: torch.randn(*s, dtype=torch.bfloat16) * 0.05)(B, S, D)),
            "w1": _w((lambda *s: torch.randn(*s, dtype=torch.bfloat16) * 0.4)(D, D) * (D ** -0.5)),
            "w2": _w((lambda *s: torch.randn(*s, dtype=torch.bfloat16) * 0.4)(D, D) * (D ** -0.5)),
            "w3": _w((lambda *s: torch.randn(*s, dtype=torch.bfloat16) * 0.4)(D, F) * (D ** -0.5)),
            "w4": _w((lambda *s: torch.randn(*s, dtype=torch.bfloat16) * 0.4)(F, D) * (F ** -0.5)),
        }
    _B_in = _B_setup()

    return {
        "A_x": _A_in["x"],
        "A_wqkv": _A_in["wqkv"],
        "A_w_phi": _A_in["w_phi"],
        "A_wo": _A_in["wo"],
        "B_x": _B_in["x"],
        "B_w1": _B_in["w1"],
        "B_w2": _B_in["w2"],
        "B_w3": _B_in["w3"],
        "B_w4": _B_in["w4"],
        "gate_w": _w((lambda *s: torch.randn(*s, dtype=torch.bfloat16) * 0.05)(448) * 16.0),
    }

def reference(A_x, A_wqkv, A_w_phi, A_wo, B_x, B_w1, B_w2, B_w3, B_w4, gate_w):
    def _A_ref(x, wqkv, w_phi, wo):
        B, S, D = x.shape
        H = 16; Dh = D // H
        qkv = (lambda x, *d: x.permute(*d))((x @ wqkv).reshape(B, S, 3, H, Dh), 2, 0, 3, 1, 4)
        q, k, v = qkv[0], qkv[1], qkv[2]
        pq = torch.einsum("bhsd,hdf->bhsf", q, w_phi)
        pk = torch.einsum("bhsd,hdf->bhsf", k, w_phi)
        phi_q = torch.concatenate([_softmax(pq, axis=-1), _softmax(-pq, axis=-1)], axis=-1)
        phi_k = torch.concatenate([_softmax(pk, axis=-1), _softmax(-pk, axis=-1)], axis=-1)
        kv = torch.einsum("bhsf,bhsd->bhfd", phi_k, v)
        z  = torch.einsum("bhsf->bhf", phi_k)
        num = torch.einsum("bhqf,bhfd->bhqd", phi_q, kv)
        den = torch.einsum("bhqf,bhf->bhq", phi_q, z)[..., None] + 1e-6
        o = num / den
        return (lambda x, *d: x.permute(*d))(o, 0, 2, 1, 3).reshape(B, S, D) @ wo

    def _B_ref(x, w1, w2, w3, w4):
        B, S, D = x.shape
        h = _gelu(_layernorm(x, axis=-1) @ w1)
        c = D // 4
        g0 = _pad(h[:, :, 0*c:1*c], ((0, 0), (1, 0), (0, 0)))[:, :S, :]
        g1 = _pad(h[:, :, 1*c:2*c], ((0, 0), (0, 1), (0, 0)))[:, 1:, :]
        g2 = _pad(h[:, :, 2*c:3*c], ((0, 0), (2, 0), (0, 0)))[:, :S, :]
        g3 = _pad(h[:, :, 3*c:   ], ((0, 0), (0, 2), (0, 0)))[:, 2:, :]
        hs = torch.concatenate([g0, g1, g2, g3], axis=-1) @ w2
        x1 = x + hs
        h2 = _gelu(_layernorm(x1, axis=-1) @ w3) @ w4
        return x1 + h2

    x = A_x
    g = _sigmoid((x * gate_w).sum(-1, keepdims=True))
    a = _A_ref(x, A_wqkv, A_w_phi, A_wo)
    b = _B_ref(x, B_w1, B_w2, B_w3, B_w4)
    return g * a + (1 - g) * b
```

```asm
; @launch kernel=k1_kernel grid=(256,1,1) block=(256,1,1) lds=163840
; @launch kernel=kf_kernel grid=(256,1,1) block=(256,1,1) lds=163840
.amdgcn_target "amdgcn-amd-amdhsa--gfx950"
.text
.globl k1_kernel
.p2align 8
.type k1_kernel,@function
k1_kernel:
    s_load_dwordx16 s[16:31], s[0:1], 0
    s_load_dwordx8 s[32:39], s[0:1], 64
    s_load_dwordx2 s[40:41], s[0:1], 96
    s_cmp_ge_u32 s2, 256
    s_cbranch_scc1 k1_kernel_end
    s_mov_b32 s43, 0
    v_and_b32 v1, 63, v0
    v_lshrrev_b32 v2, 6, v0
    s_nop 0
    v_readfirstlane_b32 s3, v2
    s_and_b32 s4, s2, 7
    s_lshr_b32 s5, s2, 3
    s_lshr_b32 s6, s4, 1
    s_lshl_b32 s6, s6, 2
    s_lshr_b32 s62, s5, 3
    s_add_u32 s6, s6, s62
    s_and_b32 s7, s4, 1
    s_lshl_b32 s7, s7, 3
    s_and_b32 s62, s5, 7
    s_add_u32 s7, s7, s62
    v_and_b32 v3, 15, v1
    v_lshrrev_b32 v4, 4, v1
    s_and_b32 s15, s5, 7
    s_lshr_b32 s67, s5, 3
    s_lshl_b32 s67, s67, 1
    s_add_u32 s15, s15, s67
    s_sub_u32 s67, s15, 7
    s_cmp_ge_u32 s15, 7
    s_cselect_b32 s15, s67, s15
    s_lshl_b32 s62, s6, 7
    s_lshl_b32 s63, s3, 5
    s_add_u32 s62, s62, s63
    v_lshrrev_b32 v5, 2, v1
    v_add_u32 v5, s62, v5
    v_mul_u32_u24 v5, 896, v5
    v_and_b32 v6, 3, v1
    v_xor_b32 v6, v6, v4
    v_lshl_add_u32 v10, v6, 4, v5
    v_add_u32 v11, 14336, v10
    s_lshl_b32 s42, s3, 13
    s_add_u32 s42, s42, 131072
    s_mov_b32 s60, s15
    v_mul_u32_u24 v5, 37, v1
    v_lshrrev_b32 v5, 9, v5
    v_mul_u32_u24 v6, 14, v5
    v_sub_u32 v6, v1, v6
    s_mul_i32 s61, s3, 1088
    s_mov_b32 s8, 2688
    s_mov_b32 s10, 0
    s_mul_i32 s9, s7, 224
    s_lshl_b32 s11, s7, 2
    s_mov_b32 s12, 3
    s_waitcnt lgkmcnt(0)
    s_mov_b32 s44, s16
    s_mov_b32 s45, s17
    s_mov_b32 s46, 0x1c0000
    s_mov_b32 s47, 0x20000
    s_lshl_b32 s67, s60, 7
    s_add_u32 s60, s60, 1
    s_cmp_eq_u32 s60, 7
    s_cselect_b32 s60, 0, s60
    s_add_u32 m0, s42, 0
    s_nop 0
    buffer_load_dwordx4 v10, s[44:47], s67 offen offset:0 lds
    s_add_u32 m0, s42, 960
    s_nop 0
    buffer_load_dwordx4 v10, s[44:47], s67 offen offset:64 lds
    s_add_u32 m0, s42, 2048
    s_nop 0
    buffer_load_dwordx4 v11, s[44:47], s67 offen offset:0 lds
    s_add_u32 m0, s42, 3008
    s_nop 0
    buffer_load_dwordx4 v11, s[44:47], s67 offen offset:64 lds
    s_cmp_ge_u32 s7, 12
    s_cbranch_scc1 k1_kernel_w1
    s_mov_b32 s48, s18
    s_mov_b32 s49, s19
    s_mov_b32 s50, 0x126000
    s_mov_b32 s51, 0x20000
    s_mov_b32 s52, s20
    s_mov_b32 s53, s21
    s_mov_b32 s54, 0x6200
    s_mov_b32 s55, 0x20000
    s_cmp_lt_u32 s7, 4
    s_cbranch_scc1 k1_kernel_qk
    s_sub_u32 s62, s7, 4
    s_mul_i32 s9, s62, 112
    s_add_u32 s9, s9, 896
    s_mov_b32 s10, 784
    s_lshl_b32 s11, s62, 1
    s_mov_b32 s12, 1
k1_kernel_qk:
    v_mul_lo_u32 v7, v5, s8
    v_lshl_add_u32 v7, v6, 4, v7
    v_add_u32 v7, s9, v7
    v_add_u32 v8, s10, v7
    v_cmp_lt_u32 vcc, 6, v6
    s_nop 1
    v_cndmask_b32 v7, v7, v8, vcc
    v_mov_b32 v8, 0x80000000
    v_cmp_lt_u32 vcc, 55, v1
    s_nop 1
    v_cndmask_b32 v12, v7, v8, vcc
    s_lshl_b32 s14, s8, 2
    s_mul_i32 s13, s14, s3
    s_lshl_b32 s14, s14, 2
    s_mov_b32 s68, s13
    s_lshl_b32 s13, s14, 2
    s_mul_i32 s13, s13, s15
    s_add_u32 s13, s13, s68
    s_add_u32 s15, s15, 1
    s_cmp_eq_u32 s15, 7
    s_cselect_b32 s15, 0, s15
    s_add_u32 m0, s61, 0
    s_nop 0
    buffer_load_dwordx4 v12, s[48:51], s13 offen lds
    s_add_u32 s13, s13, s14
    s_add_u32 m0, s61, 4352
    s_nop 0
    buffer_load_dwordx4 v12, s[48:51], s13 offen lds
    s_add_u32 s13, s13, s14
    s_add_u32 m0, s61, 8704
    s_nop 0
    buffer_load_dwordx4 v12, s[48:51], s13 offen lds
    s_add_u32 s13, s13, s14
    s_add_u32 m0, s61, 13056
    s_nop 0
    buffer_load_dwordx4 v12, s[48:51], s13 offen lds
    s_lshl_b32 s67, s60, 7
    s_add_u32 s60, s60, 1
    s_cmp_eq_u32 s60, 7
    s_cselect_b32 s60, 0, s60
    s_add_u32 m0, s42, 4096
    s_nop 0
    buffer_load_dwordx4 v10, s[44:47], s67 offen offset:0 lds
    s_add_u32 m0, s42, 5056
    s_nop 0
    buffer_load_dwordx4 v10, s[44:47], s67 offen offset:64 lds
    s_add_u32 m0, s42, 6144
    s_nop 0
    buffer_load_dwordx4 v11, s[44:47], s67 offen offset:0 lds
    s_add_u32 m0, s42, 7104
    s_nop 0
    buffer_load_dwordx4 v11, s[44:47], s67 offen offset:64 lds
    s_lshl_b32 s13, s14, 2
    s_mul_i32 s13, s13, s15
    s_add_u32 s13, s13, s68
    s_add_u32 s15, s15, 1
    s_cmp_eq_u32 s15, 7
    s_cselect_b32 s15, 0, s15
    s_add_u32 m0, s61, 17408
    s_nop 0
    buffer_load_dwordx4 v12, s[48:51], s13 offen lds
    s_add_u32 s13, s13, s14
    s_add_u32 m0, s61, 21760
    s_nop 0
    buffer_load_dwordx4 v12, s[48:51], s13 offen lds
    s_add_u32 s13, s13, s14
    s_add_u32 m0, s61, 26112
    s_nop 0
    buffer_load_dwordx4 v12, s[48:51], s13 offen lds
    s_add_u32 s13, s13, s14
    s_add_u32 m0, s61, 30464
    s_nop 0
    buffer_load_dwordx4 v12, s[48:51], s13 offen lds
    s_mul_i32 s63, s11, 1568
    v_lshlrev_b32 v5, 4, v0
    v_add_u32 v5, s63, v5
    s_lshl_b32 s63, s3, 10
    s_add_u32 m0, s63, 121856
    s_nop 0
    buffer_load_dwordx4 v5, s[52:55], 0 offen lds
    s_cmp_eq_u32 s3, 3
    s_cselect_b32 s64, 0, 4096
    s_add_u32 m0, m0, s64
    s_nop 0
    buffer_load_dwordx4 v5, s[52:55], s64 offen lds
    v_bfe_u32 v5, v1, 2, 2
    v_and_b32 v6, 3, v1
    v_mul_u32_u24 v7, 2176, v4
    v_mul_u32_u24 v8, 224, v5
    v_add_u32 v7, v7, v8
    v_mul_u32_u24 v8, 56, v6
    v_add_u32 v13, v7, v8
    v_add_u32 v14, 60928, v13
    v_lshrrev_b32 v7, 2, v3
    v_xor_b32 v7, v7, v4
    v_lshlrev_b32 v7, 4, v7
    v_lshl_add_u32 v7, v3, 6, v7
    v_add_u32 v2, s42, v7
    v_mov_b32 v8, 0
    v_mov_b32 v9, 0
    v_lshlrev_b32 v7, 3, v0
    v_add_u32 v7, 129024, v7
    ds_write_b64 v7, v[8:9]
    v_and_b32 v5, s12, v4
    v_mul_u32_u24 v5, 1568, v5
    v_bfe_u32 v6, v1, 2, 2
    v_mul_u32_u24 v6, 56, v6
    v_add_u32 v5, v5, v6
    v_add_u32 v5, 121856, v5
    v_mov_b32 v6, 129024
    v_and_b32 v7, 3, v1
    v_cmp_eq_u32 vcc, v7, v4
    s_nop 1
    v_cndmask_b32 v15, v6, v5, vcc
    v_mov_b32 v5, 0
    v_accvgpr_write_b32 a98, v5
    v_accvgpr_write_b32 a99, v5
    v_accvgpr_write_b32 a114, v5
    v_accvgpr_write_b32 a115, v5
    v_accvgpr_write_b32 a130, v5
    v_accvgpr_write_b32 a131, v5
    v_accvgpr_write_b32 a146, v5
    v_accvgpr_write_b32 a147, v5
    v_accvgpr_write_b32 a162, v5
    v_accvgpr_write_b32 a163, v5
    v_accvgpr_write_b32 a178, v5
    v_accvgpr_write_b32 a179, v5
    v_accvgpr_write_b32 a194, v5
    v_accvgpr_write_b32 a195, v5
    s_lshl_b32 s24, s2, 2
    s_add_u32 s24, s24, s3
    s_mov_b32 s92, s40
    s_mov_b32 s93, s41
    s_mov_b32 s94, 0x1c00000
    s_mov_b32 s95, 0x20000
    s_mov_b32 s91, 0x20000
    s_mov_b32 s19, 0
    s_cmp_lt_u32 s2, 98
    s_cbranch_scc0 k1_kernela_tk1
    s_mov_b32 s88, s32
    s_mov_b32 s89, s33
    s_mov_b32 s90, 0x188000
    s_mov_b32 s20, 896
    s_mov_b32 s34, 28672
    s_mov_b32 s17, 7168
    s_mov_b32 s21, 7
    s_mov_b32 s35, 56
    s_mov_b32 s69, 0x1800000
    s_sub_u32 s27, s24, 0
    s_mul_i32 s25, s27, 9363
    s_lshr_b32 s25, s25, 16
    s_mul_i32 s26, s25, 7
    s_sub_u32 s26, s27, s26
    s_branch k1_kernela_tk9
k1_kernela_tk1:
    s_cmp_lt_u32 s2, 196
    s_cbranch_scc0 k1_kernela_tk2
    s_mov_b32 s88, s30
    s_mov_b32 s89, s31
    s_mov_b32 s90, 0x188000
    s_mov_b32 s20, 3584
    s_mov_b32 s34, 114688
    s_mov_b32 s17, 28672
    s_mov_b32 s21, 7
    s_mov_b32 s35, 15
    s_mov_b32 s69, 0x1600000
    s_sub_u32 s27, s24, 392
    s_mul_i32 s25, s27, 2341
    s_lshr_b32 s25, s25, 16
    s_mul_i32 s26, s25, 28
    s_sub_u32 s26, s27, s26
    s_mul_i32 s19, s26, 61440
    s_add_u32 s19, s19, 0x160e000
    s_lshr_b32 s27, s25, 2
    s_lshl_b32 s27, s27, 9
    s_add_u32 s19, s19, s27
    s_and_b32 s27, s25, 3
    s_lshl_b32 s27, s27, 2
    s_add_u32 s19, s19, s27
    s_branch k1_kernela_tk9
k1_kernela_tk2:
    s_cmp_lt_u32 s2, 224
    s_cbranch_scc0 k1_kernela_tk3
    s_mov_b32 s88, s22
    s_mov_b32 s89, s23
    s_mov_b32 s90, 0x62000
    s_mov_b32 s20, 896
    s_mov_b32 s34, 25088
    s_mov_b32 s17, 6272
    s_mov_b32 s21, 6
    s_mov_b32 s35, 16
    s_mov_b32 s69, 0x1a00000
    s_sub_u32 s27, s24, 784
    s_mul_i32 s25, s27, 9363
    s_lshr_b32 s25, s25, 16
    s_mul_i32 s26, s25, 7
    s_sub_u32 s26, s27, s26
    s_branch k1_kernela_tk9
k1_kernela_tk3:
    s_mov_b32 s88, s28
    s_mov_b32 s89, s29
    s_mov_b32 s90, 0x62000
    s_mov_b32 s20, 896
    s_mov_b32 s34, 28672
    s_mov_b32 s17, 7168
    s_mov_b32 s21, 7
    s_mov_b32 s35, 0
    s_mov_b32 s69, 0x7f000000
    s_sub_u32 s27, s24, 896
    s_mul_i32 s25, s27, 9363
    s_lshr_b32 s25, s25, 16
    s_mul_i32 s26, s25, 7
    s_sub_u32 s26, s27, s26
k1_kernela_tk9:
    s_mul_i32 s16, s25, s34
    s_lshl_b32 s27, s26, 7
    s_add_u32 s16, s16, s27
    s_mul_i32 s18, s26, s35
    s_add_u32 s18, s18, s25
    s_lshl_b32 s18, s18, 12
    s_add_u32 s18, s18, s69
    v_lshrrev_b32 v200, 3, v1
    v_min_u32 v200, s21, v200
    v_mul_lo_u32 v200, v200, s20
    v_and_b32 v201, 7, v1
    v_lshl_add_u32 v200, v201, 4, v200
    s_lshl_b32 s28, s3, 12
    v_subrev_u32 v202, s42, v2
    v_add_u32 v202, s28, v202
    s_lshr_b32 s62, s7, 2
    s_cmp_eq_u32 s62, 1
    s_cbranch_scc1 wc_0
    s_mov_b32 s43, 1
    s_and_b32 s62, s7, 3
    s_lshl_b32 s62, s62, 2
    s_lshr_b32 s63, s2, 6
    s_add_u32 s62, s62, s63
    s_lshl_b32 s62, s62, 2
    s_add_u32 s62, s62, s3
    s_lshl_b32 s62, s62, 2
    s_add_u32 s64, s62, 12
wl_0:
    s_waitcnt lgkmcnt(0)
    s_getpc_b64 s[62:63]
    s_add_u32 s62, s62, s64
    s_addc_u32 s63, s63, 0
    s_setpc_b64 s[62:63]
    s_branch we_all_0
    s_branch we_all_1
    s_branch we_all_2
    s_branch we_all_3
    s_branch we_all_4
    s_branch we_all_5
    s_branch we_all_6
    s_branch we_all_7
    s_branch we_all_8
    s_branch we_all_9
    s_branch we_all_10
    s_branch we_all_11
    s_branch we_all_12
    s_branch we_all_13
    s_branch we_all_14
    s_branch we_all_15
    s_branch we_all_16
    s_branch we_all_17
    s_branch we_all_18
    s_branch we_all_19
    s_branch we_all_20
    s_branch we_all_21
    s_branch we_all_22
    s_branch we_all_23
    s_branch we_all_24
    s_branch we_all_25
    s_branch we_all_26
    s_branch we_all_27
    s_branch we_all_28
    s_branch we_all_29
    s_branch we_all_30
    s_branch we_all_31
    s_branch we_all_32
    s_branch we_all_33
    s_branch we_all_34
    s_branch we_all_35
    s_branch we_all_36
    s_branch we_all_37
    s_branch we_all_38
    s_branch we_all_39
    s_branch we_all_40
    s_branch we_all_41
    s_branch we_all_42
    s_branch we_all_43
    s_branch we_all_44
    s_branch we_all_45
    s_branch we_all_46
    s_branch we_all_47
    s_branch we_all_48
    s_branch we_all_49
    s_branch we_all_50
    s_branch we_all_51
    s_branch we_all_52
    s_branch we_all_53
    s_branch we_all_54
    s_branch we_all_55
    s_branch we_all_56
    s_branch we_all_57
    s_branch we_all_58
    s_branch we_all_59
    s_branch we_all_60
    s_branch we_all_61
    s_branch we_all_62
    s_branch we_all_63
    s_branch we_all_64
    s_branch we_all_65
    s_branch we_all_66
    s_branch we_all_67
    s_branch we_all_68
    s_branch we_all_69
    s_branch we_all_70
    s_branch we_all_71
    s_branch we_all_72
    s_branch we_all_73
    s_branch we_all_74
    s_branch we_all_75
    s_branch we_all_76
    s_branch we_all_77
    s_branch we_all_78
    s_branch we_all_79
    s_branch we_all_80
    s_branch we_all_81
    s_branch we_all_82
    s_branch we_all_83
    s_branch we_all_84
    s_branch we_all_85
    s_branch we_all_86
    s_branch we_all_87
    s_branch we_all_88
    s_branch we_all_89
    s_branch we_all_90
    s_branch we_all_91
    s_branch we_all_92
    s_branch we_all_93
    s_branch we_all_94
    s_branch we_all_95
    s_branch we_all_96
    s_branch we_all_97
    s_branch we_all_98
    s_branch we_all_99
    s_branch we_all_100
    s_branch we_all_101
    s_branch we_all_102
    s_branch we_all_103
    s_branch we_all_104
    s_branch we_all_105
    s_branch we_all_106
    s_branch we_all_107
    s_branch we_all_108
    s_branch we_all_109
    s_branch we_all_110
    s_branch we_all_111
    s_branch we_all_112
    s_branch we_all_113
    s_branch we_all_114
    s_branch we_all_115
    s_branch we_all_116
    s_branch we_all_117
    s_branch we_all_118
    s_branch we_all_119
    s_branch we_all_120
    s_branch we_all_121
    s_branch we_all_122
    s_branch we_all_123
    s_branch we_all_124
    s_branch we_all_125
    s_branch we_all_126
    s_branch we_all_127
    s_branch we_all_128
    s_branch we_all_129
    s_branch we_all_130
    s_branch we_all_131
    s_branch we_all_132
    s_branch we_all_133
    s_branch we_all_134
    s_branch we_all_135
    s_branch we_all_136
    s_branch we_all_137
    s_branch we_all_138
    s_branch we_all_139
    s_branch we_all_140
    s_branch we_all_141
    s_branch we_all_142
    s_branch we_all_143
    s_branch we_all_144
    s_branch we_all_145
    s_branch we_all_146
    s_branch we_all_147
    s_branch we_all_148
    s_branch we_all_149
    s_branch we_all_150
    s_branch we_all_151
    s_branch we_all_152
    s_branch we_all_153
    s_branch we_all_154
    s_branch we_all_155
    s_branch we_all_156
    s_branch we_all_157
    s_branch we_all_158
    s_branch we_all_159
    s_branch we_all_160
    s_branch we_all_161
    s_branch we_all_162
    s_branch we_all_163
    s_branch we_all_164
    s_branch we_all_165
    s_branch we_all_166
    s_branch we_all_167
    s_branch we_all_168
    s_branch we_all_169
    s_branch we_all_170
    s_branch we_all_171
    s_branch we_all_172
    s_branch we_all_173
    s_branch we_all_174
    s_branch we_all_175
    s_branch we_all_176
    s_branch we_all_177
    s_branch we_all_178
    s_branch we_all_179
    s_branch we_all_180
    s_branch we_all_181
    s_branch we_all_182
    s_branch we_all_183
    s_branch we_all_184
    s_branch we_all_185
    s_branch we_all_186
    s_branch we_all_187
    s_branch we_all_188
    s_branch we_all_189
    s_branch we_all_190
    s_branch we_all_191
    s_branch wc_0
wr_0:
    s_add_u32 s64, s64, 256
    s_min_u32 s64, s64, 780
    s_branch wl_0
wc_0:
    s_mov_b32 s43, 0
we_all_0:
we_all_187:
we_all_188:
we_all_189:
we_all_190:
we_all_191:
wp_all_0:
    s_cmp_eq_u32 s43, 1
    s_cbranch_scc1 wr_0
    s_waitcnt vmcnt(10)
    s_waitcnt lgkmcnt(0)
    s_barrier
    ds_read_b128 v[16:19], v2 offset:0
    ds_read_b128 v[72:75], v2 offset:2048
    ds_read_b64_tr_b16 a[0:1], v13 offset:0
    ds_read_b64_tr_b16 a[2:3], v13 offset:1088
    ds_read_b64_tr_b16 a[4:5], v13 offset:8
    ds_read_b64_tr_b16 a[6:7], v13 offset:1096
    ds_read_b64_tr_b16 a[8:9], v13 offset:16
    ds_read_b64_tr_b16 a[10:11], v13 offset:1104
    ds_read_b64_tr_b16 a[12:13], v13 offset:24
    ds_read_b64_tr_b16 a[14:15], v13 offset:1112
    ds_read_b64_tr_b16 a[16:17], v13 offset:32
    ds_read_b64_tr_b16 a[18:19], v13 offset:1120
    ds_read_b64_tr_b16 a[20:21], v13 offset:40
    ds_read_b64_tr_b16 a[22:23], v13 offset:1128
    ds_read_b64_tr_b16 a[24:25], v13 offset:48
    ds_read_b64_tr_b16 a[26:27], v13 offset:1136
    ds_read_b128 v[20:23], v2 offset:1024
    ds_read_b128 v[76:79], v2 offset:3072
    s_waitcnt lgkmcnt(14)
    v_mfma_f32_16x16x32_bf16 v[128:131], a[0:3], v[16:19], 0
    ds_read_b64_tr_b16 a[28:29], v13 offset:8704
    v_mfma_f32_16x16x32_bf16 v[156:159], a[0:3], v[72:75], 0
    ds_read_b64_tr_b16 a[30:31], v13 offset:9792
    s_waitcnt lgkmcnt(14)
    v_mfma_f32_16x16x32_bf16 v[132:135], a[4:7], v[16:19], 0
we_all_1:
wp_all_1:
    s_cmp_eq_u32 s43, 1
    s_cbranch_scc1 wr_0
    ds_read_b64_tr_b16 a[32:33], v13 offset:8712
    v_mfma_f32_16x16x32_bf16 v[160:163], a[4:7], v[72:75], 0
    ds_read_b64_tr_b16 a[34:35], v13 offset:9800
    s_waitcnt lgkmcnt(4)
    s_lshl_b32 s67, s60, 7
    s_add_u32 s60, s60, 1
    s_cmp_eq_u32 s60, 7
    s_cselect_b32 s60, 0, s60
    s_add_u32 m0, s42, 0
    s_nop 0
    buffer_load_dwordx4 v10, s[44:47], s67 offen offset:0 lds
    v_mfma_f32_16x16x32_bf16 v[136:139], a[8:11], v[16:19], 0
    ds_read_b64_tr_b16 a[36:37], v13 offset:8720
    v_mfma_f32_16x16x32_bf16 v[164:167], a[8:11], v[72:75], 0
    ds_read_b64_tr_b16 a[38:39], v13 offset:9808
    v_mfma_f32_16x16x32_bf16 v[140:143], a[12:15], v[16:19], 0
    ds_read_b64_tr_b16 a[40:41], v13 offset:8728
    s_add_u32 m0, s42, 960
    s_nop 0
    buffer_load_dwordx4 v10, s[44:47], s67 offen offset:64 lds
    v_mfma_f32_16x16x32_bf16 v[168:171], a[12:15], v[72:75], 0
    ds_read_b64_tr_b16 a[42:43], v13 offset:9816
    v_mfma_f32_16x16x32_bf16 v[144:147], a[16:19], v[16:19], 0
    ds_read_b64_tr_b16 a[44:45], v13 offset:8736
    v_mfma_f32_16x16x32_bf16 v[172:175], a[16:19], v[72:75], 0
    ds_read_b64_tr_b16 a[46:47], v13 offset:9824
    s_add_u32 m0, s42, 2048
    s_nop 0
    buffer_load_dwordx4 v11, s[44:47], s67 offen offset:0 lds
    v_mfma_f32_16x16x32_bf16 v[148:151], a[20:23], v[16:19], 0
    ds_read_b64_tr_b16 a[48:49], v13 offset:8744
    v_mfma_f32_16x16x32_bf16 v[176:179], a[20:23], v[72:75], 0
    ds_read_b64_tr_b16 a[50:51], v13 offset:9832
    v_mfma_f32_16x16x32_bf16 v[152:155], a[24:27], v[16:19], 0
    ds_read_b64_tr_b16 a[52:53], v13 offset:8752
we_all_2:
wp_all_2:
    s_cmp_eq_u32 s43, 1
    s_cbranch_scc1 wr_0
    s_add_u32 m0, s42, 3008
    s_nop 0
    buffer_load_dwordx4 v11, s[44:47], s67 offen offset:64 lds
    v_mfma_f32_16x16x32_bf16 v[180:183], a[24:27], v[72:75], 0
    ds_read_b64_tr_b16 a[54:55], v13 offset:9840
    s_waitcnt lgkmcnt(12)
    v_mfma_f32_16x16x32_bf16 v[128:131], a[28:31], v[20:23], v[128:131]
    s_lshl_b32 s13, s14, 2
    s_mul_i32 s13, s13, s15
    s_add_u32 s13, s13, s68
    s_add_u32 s15, s15, 1
    s_cmp_eq_u32 s15, 7
    s_cselect_b32 s15, 0, s15
    s_add_u32 m0, s61, 34816
    s_nop 0
    buffer_load_dwordx4 v12, s[48:51], s13 offen lds
    s_add_u32 s13, s13, s14
    v_mfma_f32_16x16x32_bf16 v[156:159], a[28:31], v[76:79], v[156:159]
    s_add_u32 m0, s61, 39168
    s_nop 0
    buffer_load_dwordx4 v12, s[48:51], s13 offen lds
    s_add_u32 s13, s13, s14
    s_waitcnt lgkmcnt(10)
    v_mfma_f32_16x16x32_bf16 v[132:135], a[32:35], v[20:23], v[132:135]
    v_mfma_f32_16x16x32_bf16 v[160:163], a[32:35], v[76:79], v[160:163]
    s_waitcnt lgkmcnt(8)
    v_mfma_f32_16x16x32_bf16 v[136:139], a[36:39], v[20:23], v[136:139]
    v_mfma_f32_16x16x32_bf16 v[164:167], a[36:39], v[76:79], v[164:167]
    s_add_u32 m0, s61, 43520
    s_nop 0
    buffer_load_dwordx4 v12, s[48:51], s13 offen lds
    s_add_u32 s13, s13, s14
    s_waitcnt vmcnt(9)
    s_barrier
    s_waitcnt lgkmcnt(6)
    v_mfma_f32_16x16x32_bf16 v[140:143], a[40:43], v[20:23], v[140:143]
    ds_read_b128 v[24:27], v2 offset:4096
    ds_read_b128 v[80:83], v2 offset:6144
    ds_read_b64_tr_b16 a[0:1], v13 offset:17408
    v_mfma_f32_16x16x32_bf16 v[168:171], a[40:43], v[76:79], v[168:171]
    ds_read_b64_tr_b16 a[2:3], v13 offset:18496
we_all_3:
wp_all_3:
    s_cmp_eq_u32 s43, 1
    s_cbranch_scc1 wr_0
    ds_read_b64_tr_b16 a[4:5], v13 offset:17416
    ds_read_b64_tr_b16 a[6:7], v13 offset:18504
    s_waitcnt lgkmcnt(10)
    v_mfma_f32_16x16x32_bf16 v[144:147], a[44:47], v[20:23], v[144:147]
    ds_read_b64_tr_b16 a[8:9], v13 offset:17424
    ds_read_b64_tr_b16 a[10:11], v13 offset:18512
    v_mfma_f32_16x16x32_bf16 v[172:175], a[44:47], v[76:79], v[172:175]
    ds_read_b64_tr_b16 a[12:13], v13 offset:17432
    ds_read_b64_tr_b16 a[14:15], v13 offset:18520
    s_add_u32 m0, s61, 47872
    s_nop 0
    buffer_load_dwordx4 v12, s[48:51], s13 offen lds
    s_waitcnt lgkmcnt(12)
    v_mfma_f32_16x16x32_bf16 v[148:151], a[48:51], v[20:23], v[148:151]
    ds_read_b64_tr_b16 a[16:17], v13 offset:17440
    ds_read_b64_tr_b16 a[18:19], v13 offset:18528
    v_mfma_f32_16x16x32_bf16 v[176:179], a[48:51], v[76:79], v[176:179]
    ds_read_b64_tr_b16 a[20:21], v13 offset:17448
    ds_read_b64_tr_b16 a[22:23], v13 offset:18536
    s_waitcnt lgkmcnt(14)
    v_mfma_f32_16x16x32_bf16 v[152:155], a[52:55], v[20:23], v[152:155]
    ds_read_b64_tr_b16 a[24:25], v13 offset:17456
    ds_read_b64_tr_b16 a[26:27], v13 offset:18544
    v_mfma_f32_16x16x32_bf16 v[180:183], a[52:55], v[76:79], v[180:183]
    ds_read_b128 v[28:31], v2 offset:5120
    ds_read_b128 v[84:87], v2 offset:7168
    s_waitcnt lgkmcnt(14)
    v_mfma_f32_16x16x32_bf16 v[128:131], a[0:3], v[24:27], v[128:131]
    ds_read_b64_tr_b16 a[28:29], v13 offset:26112
    v_mfma_f32_16x16x32_bf16 v[156:159], a[0:3], v[80:83], v[156:159]
    ds_read_b64_tr_b16 a[30:31], v13 offset:27200
    s_waitcnt lgkmcnt(14)
    v_mfma_f32_16x16x32_bf16 v[132:135], a[4:7], v[24:27], v[132:135]
    ds_read_b64_tr_b16 a[32:33], v13 offset:26120
we_all_4:
wp_all_4:
    s_cmp_eq_u32 s43, 1
    s_cbranch_scc1 wr_0
    v_mfma_f32_16x16x32_bf16 v[160:163], a[4:7], v[80:83], v[160:163]
    ds_read_b64_tr_b16 a[34:35], v13 offset:27208
    s_waitcnt lgkmcnt(4)
    s_lshl_b32 s67, s60, 7
    s_add_u32 s60, s60, 1
    s_cmp_eq_u32 s60, 7
    s_cselect_b32 s60, 0, s60
    s_add_u32 m0, s42, 4096
    s_nop 0
    buffer_load_dwordx4 v10, s[44:47], s67 offen offset:0 lds
    v_mfma_f32_16x16x32_bf16 v[136:139], a[8:11], v[24:27], v[136:139]
    ds_read_b64_tr_b16 a[36:37], v13 offset:26128
    v_mfma_f32_16x16x32_bf16 v[164:167], a[8:11], v[80:83], v[164:167]
    ds_read_b64_tr_b16 a[38:39], v13 offset:27216
    v_mfma_f32_16x16x32_bf16 v[140:143], a[12:15], v[24:27], v[140:143]
    ds_read_b64_tr_b16 a[40:41], v13 offset:26136
    s_add_u32 m0, s42, 5056
    s_nop 0
    buffer_load_dwordx4 v10, s[44:47], s67 offen offset:64 lds
    v_mfma_f32_16x16x32_bf16 v[168:171], a[12:15], v[80:83], v[168:171]
    ds_read_b64_tr_b16 a[42:43], v13 offset:27224
    v_mfma_f32_16x16x32_bf16 v[144:147], a[16:19], v[24:27], v[144:147]
    ds_read_b64_tr_b16 a[44:45], v13 offset:26144
    v_mfma_f32_16x16x32_bf16 v[172:175], a[16:19], v[80:83], v[172:175]
    ds_read_b64_tr_b16 a[46:47], v13 offset:27232
    s_add_u32 m0, s42, 6144
    s_nop 0
    buffer_load_dwordx4 v11, s[44:47], s67 offen offset:0 lds
    v_mfma_f32_16x16x32_bf16 v[148:151], a[20:23], v[24:27], v[148:151]
    ds_read_b64_tr_b16 a[48:49], v13 offset:26152
    v_mfma_f32_16x16x32_bf16 v[176:179], a[20:23], v[80:83], v[176:179]
    ds_read_b64_tr_b16 a[50:51], v13 offset:27240
    v_mfma_f32_16x16x32_bf16 v[152:155], a[24:27], v[24:27], v[152:155]
    ds_read_b64_tr_b16 a[52:53], v13 offset:26160
    s_add_u32 m0, s42, 7104
we_all_5:
wp_all_5:
    s_cmp_eq_u32 s43, 1
    s_cbranch_scc1 wr_0
    s_nop 0
    buffer_load_dwordx4 v11, s[44:47], s67 offen offset:64 lds
    v_mfma_f32_16x16x32_bf16 v[180:183], a[24:27], v[80:83], v[180:183]
    ds_read_b64_tr_b16 a[54:55], v13 offset:27248
    s_waitcnt lgkmcnt(12)
    v_mfma_f32_16x16x32_bf16 v[128:131], a[28:31], v[28:31], v[128:131]
    s_lshl_b32 s13, s14, 2
    s_mul_i32 s13, s13, s15
    s_add_u32 s13, s13, s68
    s_add_u32 s15, s15, 1
    s_cmp_eq_u32 s15, 7
    s_cselect_b32 s15, 0, s15
    s_add_u32 m0, s61, 52224
    s_nop 0
    buffer_load_dwordx4 v12, s[48:51], s13 offen lds
    s_add_u32 s13, s13, s14
    v_mfma_f32_16x16x32_bf16 v[156:159], a[28:31], v[84:87], v[156:159]
    s_add_u32 m0, s61, 56576
    s_nop 0
    buffer_load_dwordx4 v12, s[48:51], s13 offen lds
    s_add_u32 s13, s13, s14
    s_waitcnt lgkmcnt(10)
    v_mfma_f32_16x16x32_bf16 v[132:135], a[32:35], v[28:31], v[132:135]
    v_mfma_f32_16x16x32_bf16 v[160:163], a[32:35], v[84:87], v[160:163]
    s_waitcnt lgkmcnt(8)
    v_mfma_f32_16x16x32_bf16 v[136:139], a[36:39], v[28:31], v[136:139]
    v_mfma_f32_16x16x32_bf16 v[164:167], a[36:39], v[84:87], v[164:167]
    s_add_u32 m0, s61, 60928
    s_nop 0
    buffer_load_dwordx4 v12, s[48:51], s13 offen lds
    s_add_u32 s13, s13, s14
    s_waitcnt vmcnt(7)
    s_barrier
    s_waitcnt lgkmcnt(6)
    v_mfma_f32_16x16x32_bf16 v[140:143], a[40:43], v[28:31], v[140:143]
    ds_read_b128 v[32:35], v2 offset:0
    ds_read_b128 v[88:91], v2 offset:2048
    ds_read_b64_tr_b16 a[0:1], v13 offset:34816
    v_mfma_f32_16x16x32_bf16 v[168:171], a[40:43], v[84:87], v[168:171]
    ds_read_b64_tr_b16 a[2:3], v13 offset:35904
we_all_6:
wp_all_6:
    s_cmp_eq_u32 s43, 1
    s_cbranch_scc1 wr_0
    ds_read_b64_tr_b16 a[4:5], v13 offset:34824
    ds_read_b64_tr_b16 a[6:7], v13 offset:35912
    s_waitcnt lgkmcnt(10)
    v_mfma_f32_16x16x32_bf16 v[144:147], a[44:47], v[28:31], v[144:147]
    ds_read_b64_tr_b16 a[8:9], v13 offset:34832
    ds_read_b64_tr_b16 a[10:11], v13 offset:35920
    v_mfma_f32_16x16x32_bf16 v[172:175], a[44:47], v[84:87], v[172:175]
    ds_read_b64_tr_b16 a[12:13], v13 offset:34840
    ds_read_b64_tr_b16 a[14:15], v13 offset:35928
    s_add_u32 m0, s61, 65280
    s_nop 0
    buffer_load_dwordx4 v12, s[48:51], s13 offen lds
    s_waitcnt lgkmcnt(12)
    v_mfma_f32_16x16x32_bf16 v[148:151], a[48:51], v[28:31], v[148:151]
    ds_read_b64_tr_b16 a[16:17], v13 offset:34848
    ds_read_b64_tr_b16 a[18:19], v13 offset:35936
    v_mfma_f32_16x16x32_bf16 v[176:179], a[48:51], v[84:87], v[176:179]
    ds_read_b64_tr_b16 a[20:21], v13 offset:34856
    ds_read_b64_tr_b16 a[22:23], v13 offset:35944
    s_waitcnt lgkmcnt(14)
    v_mfma_f32_16x16x32_bf16 v[152:155], a[52:55], v[28:31], v[152:155]
    ds_read_b64_tr_b16 a[24:25], v13 offset:34864
    ds_read_b64_tr_b16 a[26:27], v13 offset:35952
    v_mfma_f32_16x16x32_bf16 v[180:183], a[52:55], v[84:87], v[180:183]
    ds_read_b128 v[36:39], v2 offset:1024
    ds_read_b128 v[92:95], v2 offset:3072
    s_waitcnt lgkmcnt(14)
    v_mfma_f32_16x16x32_bf16 v[128:131], a[0:3], v[32:35], v[128:131]
    ds_read_b64_tr_b16 a[28:29], v13 offset:43520
    s_waitcnt lgkmcnt(1)
    s_lshl_b32 s67, s60, 7
    s_add_u32 s60, s60, 1
    s_cmp_eq_u32 s60, 7
    s_cselect_b32 s60, 0, s60
    s_add_u32 m0, s42, 0
    s_nop 0
    buffer_load_dwordx4 v10, s[44:47], s67 offen offset:0 lds
we_all_7:
wp_all_7:
    s_cmp_eq_u32 s43, 1
    s_cbranch_scc1 wr_0
    v_mfma_f32_16x16x32_bf16 v[156:159], a[0:3], v[88:91], v[156:159]
    ds_read_b64_tr_b16 a[30:31], v13 offset:44608
    s_add_u32 m0, s42, 960
    s_nop 0
    buffer_load_dwordx4 v10, s[44:47], s67 offen offset:64 lds
    v_mfma_f32_16x16x32_bf16 v[132:135], a[4:7], v[32:35], v[132:135]
    ds_read_b64_tr_b16 a[32:33], v13 offset:43528
    v_mfma_f32_16x16x32_bf16 v[160:163], a[4:7], v[88:91], v[160:163]
    ds_read_b64_tr_b16 a[34:35], v13 offset:44616
    s_add_u32 m0, s42, 2048
    s_nop 0
    buffer_load_dwordx4 v11, s[44:47], s67 offen offset:0 lds
    v_mfma_f32_16x16x32_bf16 v[136:139], a[8:11], v[32:35], v[136:139]
    ds_read_b64_tr_b16 a[36:37], v13 offset:43536
    v_mfma_f32_16x16x32_bf16 v[164:167], a[8:11], v[88:91], v[164:167]
    ds_read_b64_tr_b16 a[38:39], v13 offset:44624
    s_add_u32 m0, s42, 3008
    s_nop 0
    buffer_load_dwordx4 v11, s[44:47], s67 offen offset:64 lds
    v_mfma_f32_16x16x32_bf16 v[140:143], a[12:15], v[32:35], v[140:143]
    ds_read_b64_tr_b16 a[40:41], v13 offset:43544
    v_mfma_f32_16x16x32_bf16 v[168:171], a[12:15], v[88:91], v[168:171]
    ds_read_b64_tr_b16 a[42:43], v13 offset:44632
    s_lshl_b32 s67, s60, 7
    s_add_u32 s60, s60, 1
    s_cmp_eq_u32 s60, 7
    s_cselect_b32 s60, 0, s60
    s_add_u32 m0, s28, 0
    s_nop 0
    buffer_load_dwordx4 v10, s[44:47], s67 offen offset:0 lds
    v_mfma_f32_16x16x32_bf16 v[144:147], a[16:19], v[32:35], v[144:147]
    ds_read_b64_tr_b16 a[44:45], v13 offset:43552
    v_mfma_f32_16x16x32_bf16 v[172:175], a[16:19], v[88:91], v[172:175]
    ds_read_b64_tr_b16 a[46:47], v13 offset:44640
    s_add_u32 m0, s28, 960
    s_nop 0
we_all_8:
wp_all_8:
    s_cmp_eq_u32 s43, 1
    s_cbranch_scc1 wr_0
    buffer_load_dwordx4 v10, s[44:47], s67 offen offset:64 lds
    v_mfma_f32_16x16x32_bf16 v[148:151], a[20:23], v[32:35], v[148:151]
    ds_read_b64_tr_b16 a[48:49], v13 offset:43560
    s_add_u32 m0, s28, 2048
    s_nop 0
    buffer_load_dwordx4 v11, s[44:47], s67 offen offset:0 lds
    v_mfma_f32_16x16x32_bf16 v[176:179], a[20:23], v[88:91], v[176:179]
    ds_read_b64_tr_b16 a[50:51], v13 offset:44648
    s_add_u32 m0, s28, 3008
    s_nop 0
    buffer_load_dwordx4 v11, s[44:47], s67 offen offset:64 lds
    v_mfma_f32_16x16x32_bf16 v[152:155], a[24:27], v[32:35], v[152:155]
    ds_read_b64_tr_b16 a[52:53], v13 offset:43568
    v_mfma_f32_16x16x32_bf16 v[180:183], a[24:27], v[88:91], v[180:183]
    ds_read_b64_tr_b16 a[54:55], v13 offset:44656
    s_waitcnt lgkmcnt(12)
    v_mfma_f32_16x16x32_bf16 v[128:131], a[28:31], v[36:39], v[128:131]
    s_lshl_b32 s13, s14, 2
    s_mul_i32 s13, s13, s15
    s_add_u32 s13, s13, s68
    s_add_u32 s15, s15, 1
    s_cmp_eq_u32 s15, 7
    s_cselect_b32 s15, 0, s15
    s_add_u32 m0, s61, 69632
    s_nop 0
    buffer_load_dwordx4 v12, s[48:51], s13 offen lds
    s_add_u32 s13, s13, s14
    v_mfma_f32_16x16x32_bf16 v[156:159], a[28:31], v[92:95], v[156:159]
    s_add_u32 m0, s61, 73984
    s_nop 0
    buffer_load_dwordx4 v12, s[48:51], s13 offen lds
    s_add_u32 s13, s13, s14
    s_waitcnt lgkmcnt(10)
    v_mfma_f32_16x16x32_bf16 v[132:135], a[32:35], v[36:39], v[132:135]
    v_mfma_f32_16x16x32_bf16 v[160:163], a[32:35], v[92:95], v[160:163]
    s_add_u32 m0, s61, 78336
    s_nop 0
    buffer_load_dwordx4 v12, s[48:51], s13 offen lds
    s_add_u32 s13, s13, s14
we_all_9:
wp_all_9:
    s_cmp_eq_u32 s43, 1
    s_cbranch_scc1 wr_0
    s_waitcnt lgkmcnt(8)
    v_mfma_f32_16x16x32_bf16 v[136:139], a[36:39], v[36:39], v[136:139]
    v_mfma_f32_16x16x32_bf16 v[164:167], a[36:39], v[92:95], v[164:167]
    s_add_u32 m0, s61, 82688
    s_nop 0
    buffer_load_dwordx4 v12, s[48:51], s13 offen lds
    s_waitcnt vmcnt(12)
    s_barrier
    s_waitcnt lgkmcnt(6)
    v_mfma_f32_16x16x32_bf16 v[140:143], a[40:43], v[36:39], v[140:143]
    ds_read_b128 v[40:43], v2 offset:4096
    ds_read_b128 v[96:99], v2 offset:6144
    ds_read_b64_tr_b16 a[0:1], v13 offset:52224
    ds_read_b64_tr_b16 a[2:3], v13 offset:53312
    ds_read_b64_tr_b16 a[4:5], v13 offset:52232
    ds_read_b64_tr_b16 a[6:7], v13 offset:53320
    ds_read_b64_tr_b16 a[8:9], v13 offset:52240
    ds_read_b64_tr_b16 a[10:11], v13 offset:53328
    ds_read_b64_tr_b16 a[12:13], v13 offset:52248
    v_mfma_f32_16x16x32_bf16 v[168:171], a[40:43], v[92:95], v[168:171]
    ds_read_b64_tr_b16 a[14:15], v13 offset:53336
    ds_read_b64_tr_b16 a[16:17], v13 offset:52256
    ds_read_b64_tr_b16 a[18:19], v13 offset:53344
    ds_read_b64_tr_b16 a[20:21], v13 offset:52264
    ds_read_b64_tr_b16 a[22:23], v13 offset:53352
    ds_read_b64_tr_b16 a[24:25], v13 offset:52272
    ds_read_b64_tr_b16 a[26:27], v13 offset:53360
    ds_read_b128 v[44:47], v2 offset:5120
    ds_read_b128 v[100:103], v2 offset:7168
    s_lshl_b32 s13, s14, 2
    s_mul_i32 s13, s13, s15
    s_add_u32 s13, s13, s68
    s_add_u32 s15, s15, 1
    s_cmp_eq_u32 s15, 7
    s_cselect_b32 s15, 0, s15
    s_add_u32 m0, s61, 87040
    s_nop 0
we_all_10:
wp_all_10:
    s_cmp_eq_u32 s43, 1
    s_cbranch_scc1 wr_0
    buffer_load_dwordx4 v12, s[48:51], s13 offen lds
    s_add_u32 s13, s13, s14
    s_waitcnt lgkmcnt(15)
    v_mfma_f32_16x16x32_bf16 v[144:147], a[44:47], v[36:39], v[144:147]
    ds_read_b64_tr_b16 a[84:85], v15 offset:0
    ds_read_b64_tr_b16 a[86:87], v15 offset:224
    ds_read_b64_tr_b16 a[88:89], v15 offset:448
    ds_read_b64_tr_b16 a[90:91], v15 offset:672
    ds_read_b64_tr_b16 a[92:93], v15 offset:896
    ds_read_b64_tr_b16 a[94:95], v15 offset:1120
    ds_read_b64_tr_b16 a[96:97], v15 offset:1344
    ds_read_b64_tr_b16 a[100:101], v15 offset:8
    ds_read_b64_tr_b16 a[102:103], v15 offset:232
    v_mfma_f32_16x16x32_bf16 v[172:175], a[44:47], v[92:95], v[172:175]
    ds_read_b64_tr_b16 a[104:105], v15 offset:456
    ds_read_b64_tr_b16 a[106:107], v15 offset:680
    ds_read_b64_tr_b16 a[108:109], v15 offset:904
    ds_read_b64_tr_b16 a[110:111], v15 offset:1128
    ds_read_b64_tr_b16 a[112:113], v15 offset:1352
    ds_read_b64_tr_b16 a[116:117], v15 offset:16
    ds_read_b64_tr_b16 a[118:119], v15 offset:240
    ds_read_b64_tr_b16 a[120:121], v15 offset:464
    s_add_u32 m0, s61, 91392
    s_nop 0
    buffer_load_dwordx4 v12, s[48:51], s13 offen lds
    s_add_u32 s13, s13, s14
    v_mfma_f32_16x16x32_bf16 v[148:151], a[48:51], v[36:39], v[148:151]
    ds_read_b64_tr_b16 a[122:123], v15 offset:688
    ds_read_b64_tr_b16 a[124:125], v15 offset:912
    ds_read_b64_tr_b16 a[126:127], v15 offset:1136
    ds_read_b64_tr_b16 a[128:129], v15 offset:1360
    ds_read_b64_tr_b16 a[132:133], v15 offset:24
    ds_read_b64_tr_b16 a[134:135], v15 offset:248
we_all_11:
wp_all_11:
    s_cmp_eq_u32 s43, 1
    s_cbranch_scc1 wr_0
    ds_read_b64_tr_b16 a[136:137], v15 offset:472
    ds_read_b64_tr_b16 a[138:139], v15 offset:696
    s_add_u32 m0, s61, 95744
    s_nop 0
    buffer_load_dwordx4 v12, s[48:51], s13 offen lds
    s_add_u32 s13, s13, s14
    v_mfma_f32_16x16x32_bf16 v[176:179], a[48:51], v[92:95], v[176:179]
    ds_read_b64_tr_b16 a[140:141], v15 offset:920
    ds_read_b64_tr_b16 a[142:143], v15 offset:1144
    ds_read_b64_tr_b16 a[144:145], v15 offset:1368
    ds_read_b64_tr_b16 a[148:149], v15 offset:32
    ds_read_b64_tr_b16 a[150:151], v15 offset:256
    ds_read_b64_tr_b16 a[152:153], v15 offset:480
    ds_read_b64_tr_b16 a[154:155], v15 offset:704
    ds_read_b64_tr_b16 a[156:157], v15 offset:928
    s_add_u32 m0, s61, 100096
    s_nop 0
    buffer_load_dwordx4 v12, s[48:51], s13 offen lds
    v_mfma_f32_16x16x32_bf16 v[152:155], a[52:55], v[36:39], v[152:155]
    ds_read_b64_tr_b16 a[158:159], v15 offset:1152
    ds_read_b64_tr_b16 a[160:161], v15 offset:1376
    ds_read_b64_tr_b16 a[164:165], v15 offset:40
    ds_read_b64_tr_b16 a[166:167], v15 offset:264
    ds_read_b64_tr_b16 a[168:169], v15 offset:488
    ds_read_b64_tr_b16 a[170:171], v15 offset:712
    ds_read_b64_tr_b16 a[172:173], v15 offset:936
    ds_read_b64_tr_b16 a[174:175], v15 offset:1160
    v_mfma_f32_16x16x32_bf16 v[180:183], a[52:55], v[92:95], v[180:183]
    ds_read_b64_tr_b16 a[176:177], v15 offset:1384
    ds_read_b64_tr_b16 a[180:181], v15 offset:48
    ds_read_b64_tr_b16 a[182:183], v15 offset:272
    ds_read_b64_tr_b16 a[184:185], v15 offset:496
    ds_read_b64_tr_b16 a[186:187], v15 offset:720
we_all_12:
wp_all_12:
    s_cmp_eq_u32 s43, 1
    s_cbranch_scc1 wr_0
    ds_read_b64_tr_b16 a[188:189], v15 offset:944
    ds_read_b64_tr_b16 a[190:191], v15 offset:1168
    ds_read_b64_tr_b16 a[192:193], v15 offset:1392
    s_waitcnt lgkmcnt(15)
    v_mfma_f32_16x16x32_bf16 v[128:131], a[0:3], v[40:43], v[128:131]
    ds_read_b64_tr_b16 a[28:29], v14 offset:0
    s_lshl_b32 s67, s60, 7
    s_add_u32 s60, s60, 1
    s_cmp_eq_u32 s60, 7
    s_cselect_b32 s60, 0, s60
    s_add_u32 m0, s28, 17408
    s_nop 0
    buffer_load_dwordx4 v10, s[44:47], s67 offen offset:0 lds
    v_mfma_f32_16x16x32_bf16 v[156:159], a[0:3], v[96:99], v[156:159]
    ds_read_b64_tr_b16 a[30:31], v14 offset:1088
    s_add_u32 m0, s28, 18368
    s_nop 0
    buffer_load_dwordx4 v10, s[44:47], s67 offen offset:64 lds
    v_mfma_f32_16x16x32_bf16 v[132:135], a[4:7], v[40:43], v[132:135]
    ds_read_b64_tr_b16 a[32:33], v14 offset:8
    v_mfma_f32_16x16x32_bf16 v[160:163], a[4:7], v[96:99], v[160:163]
    ds_read_b64_tr_b16 a[34:35], v14 offset:1096
    s_add_u32 m0, s28, 19456
    s_nop 0
    buffer_load_dwordx4 v11, s[44:47], s67 offen offset:0 lds
    v_mfma_f32_16x16x32_bf16 v[136:139], a[8:11], v[40:43], v[136:139]
    ds_read_b64_tr_b16 a[36:37], v14 offset:16
    v_mfma_f32_16x16x32_bf16 v[164:167], a[8:11], v[96:99], v[164:167]
    ds_read_b64_tr_b16 a[38:39], v14 offset:1104
    s_add_u32 m0, s28, 20416
    s_nop 0
    buffer_load_dwordx4 v11, s[44:47], s67 offen offset:64 lds
    v_mfma_f32_16x16x32_bf16 v[140:143], a[12:15], v[40:43], v[140:143]
    ds_read_b64_tr_b16 a[40:41], v14 offset:24
    v_mfma_f32_16x16x32_bf16 v[168:171], a[12:15], v[96:99], v[168:171]
we_all_13:
wp_all_13:
    s_cmp_eq_u32 s43, 1
    s_cbranch_scc1 wr_0
    ds_read_b64_tr_b16 a[42:43], v14 offset:1112
    s_lshl_b32 s13, s14, 2
    s_mul_i32 s13, s13, s15
    s_add_u32 s13, s13, s68
    s_add_u32 s15, s15, 1
    s_cmp_eq_u32 s15, 7
    s_cselect_b32 s15, 0, s15
    s_add_u32 m0, s61, 104448
    s_nop 0
    buffer_load_dwordx4 v12, s[48:51], s13 offen lds
    s_add_u32 s13, s13, s14
    v_mfma_f32_16x16x32_bf16 v[144:147], a[16:19], v[40:43], v[144:147]
    ds_read_b64_tr_b16 a[44:45], v14 offset:32
    v_mfma_f32_16x16x32_bf16 v[172:175], a[16:19], v[96:99], v[172:175]
    ds_read_b64_tr_b16 a[46:47], v14 offset:1120
    s_add_u32 m0, s61, 108800
    s_nop 0
    buffer_load_dwordx4 v12, s[48:51], s13 offen lds
    s_add_u32 s13, s13, s14
    v_mfma_f32_16x16x32_bf16 v[148:151], a[20:23], v[40:43], v[148:151]
    ds_read_b64_tr_b16 a[48:49], v14 offset:40
    s_add_u32 m0, s61, 113152
    s_nop 0
    buffer_load_dwordx4 v12, s[48:51], s13 offen lds
    s_add_u32 s13, s13, s14
    v_mfma_f32_16x16x32_bf16 v[176:179], a[20:23], v[96:99], v[176:179]
    ds_read_b64_tr_b16 a[50:51], v14 offset:1128
    s_add_u32 m0, s61, 117504
    s_nop 0
    buffer_load_dwordx4 v12, s[48:51], s13 offen lds
    v_mfma_f32_16x16x32_bf16 v[152:155], a[24:27], v[40:43], v[152:155]
    ds_read_b64_tr_b16 a[52:53], v14 offset:48
    v_mfma_f32_16x16x32_bf16 v[180:183], a[24:27], v[96:99], v[180:183]
    ds_read_b64_tr_b16 a[54:55], v14 offset:1136
    s_waitcnt lgkmcnt(12)
    v_mfma_f32_16x16x32_bf16 v[128:131], a[28:31], v[44:47], v[128:131]
    s_add_u32 m0, s42, 4096
    s_nop 0
    buffer_load_dwordx4 v200, s[88:91], s16 offen lds
we_all_14:
wp_all_14:
    s_cmp_eq_u32 s43, 1
    s_cbranch_scc1 wr_0
    s_add_u32 s16, s16, s17
    v_mfma_f32_16x16x32_bf16 v[156:159], a[28:31], v[100:103], v[156:159]
    s_add_u32 m0, s42, 5120
    s_nop 0
    buffer_load_dwordx4 v200, s[88:91], s16 offen lds
    s_add_u32 s16, s16, s17
    s_waitcnt lgkmcnt(10)
    v_mfma_f32_16x16x32_bf16 v[132:135], a[32:35], v[44:47], v[132:135]
    v_mfma_f32_16x16x32_bf16 v[160:163], a[32:35], v[100:103], v[160:163]
    s_waitcnt lgkmcnt(8)
    v_mfma_f32_16x16x32_bf16 v[136:139], a[36:39], v[44:47], v[136:139]
    v_mfma_f32_16x16x32_bf16 v[164:167], a[36:39], v[100:103], v[164:167]
    s_add_u32 m0, s42, 6144
    s_nop 0
    buffer_load_dwordx4 v200, s[88:91], s16 offen lds
    s_add_u32 s16, s16, s17
    s_waitcnt vmcnt(15)
    s_barrier
    s_waitcnt lgkmcnt(6)
    v_mfma_f32_16x16x32_bf16 v[140:143], a[40:43], v[44:47], v[140:143]
    ds_read_b128 v[48:51], v2 offset:0
    ds_read_b128 v[104:107], v2 offset:2048
    ds_read_b64_tr_b16 a[0:1], v14 offset:8704
    v_mfma_f32_16x16x32_bf16 v[168:171], a[40:43], v[100:103], v[168:171]
    ds_read_b64_tr_b16 a[2:3], v14 offset:9792
    ds_read_b64_tr_b16 a[4:5], v14 offset:8712
    ds_read_b64_tr_b16 a[6:7], v14 offset:9800
    s_waitcnt lgkmcnt(10)
    v_mfma_f32_16x16x32_bf16 v[144:147], a[44:47], v[44:47], v[144:147]
    ds_read_b64_tr_b16 a[8:9], v14 offset:8720
    ds_read_b64_tr_b16 a[10:11], v14 offset:9808
    v_mfma_f32_16x16x32_bf16 v[172:175], a[44:47], v[100:103], v[172:175]
    ds_read_b64_tr_b16 a[12:13], v14 offset:8728
    ds_read_b64_tr_b16 a[14:15], v14 offset:9816
    s_add_u32 m0, s42, 7168
    s_nop 0
    buffer_load_dwordx4 v200, s[88:91], s16 offen lds
we_all_15:
wp_all_15:
    s_cmp_eq_u32 s43, 1
    s_cbranch_scc1 wr_0
    s_waitcnt lgkmcnt(12)
    v_mfma_f32_16x16x32_bf16 v[148:151], a[48:51], v[44:47], v[148:151]
    ds_read_b64_tr_b16 a[16:17], v14 offset:8736
    ds_read_b64_tr_b16 a[18:19], v14 offset:9824
    v_mfma_f32_16x16x32_bf16 v[176:179], a[48:51], v[100:103], v[176:179]
    ds_read_b64_tr_b16 a[20:21], v14 offset:8744
    ds_read_b64_tr_b16 a[22:23], v14 offset:9832
    s_lshl_b32 s100, s2, 12
    s_add_u32 s100, s100, 0x1500000
    v_mov_b32 v8, s3
    v_lshlrev_b32 v8, 10, v8
    v_mov_b32 v196, 0
    v_mov_b32 v197, 0
    v_mov_b32 v198, 0
    v_mov_b32 v199, 0
    buffer_store_dwordx4 v[196:199], v8, s[92:95], s100 offen sc1
    s_waitcnt lgkmcnt(14)
    v_mfma_f32_16x16x32_bf16 v[152:155], a[52:55], v[44:47], v[152:155]
    ds_read_b64_tr_b16 a[24:25], v14 offset:8752
    ds_read_b64_tr_b16 a[26:27], v14 offset:9840
    v_mfma_f32_16x16x32_bf16 v[180:183], a[52:55], v[100:103], v[180:183]
    ds_read_b128 v[52:55], v2 offset:1024
    ds_read_b128 v[108:111], v2 offset:3072
    s_waitcnt lgkmcnt(14)
    v_mfma_f32_16x16x32_bf16 v[128:131], a[0:3], v[48:51], v[128:131]
    ds_read_b64_tr_b16 a[28:29], v14 offset:17408
    v_mfma_f32_16x16x32_bf16 v[156:159], a[0:3], v[104:107], v[156:159]
    ds_read_b64_tr_b16 a[30:31], v14 offset:18496
    s_waitcnt lgkmcnt(14)
    v_mfma_f32_16x16x32_bf16 v[132:135], a[4:7], v[48:51], v[132:135]
    ds_read_b64_tr_b16 a[32:33], v14 offset:17416
    v_mfma_f32_16x16x32_bf16 v[160:163], a[4:7], v[104:107], v[160:163]
    ds_read_b64_tr_b16 a[34:35], v14 offset:18504
    s_add_u32 s36, s40, 0x900000
    s_addc_u32 s37, s41, 0
    s_mov_b32 s38, 0x200000
    s_mov_b32 s39, 0x20000
we_all_16:
wp_all_16:
    s_cmp_eq_u32 s43, 1
    s_cbranch_scc1 wr_0
    s_lshl_b32 s101, s2, 2
    s_add_u32 s101, s101, s3
    s_mul_i32 s101, s101, 2048
    v_lshlrev_b32 v192, 4, v1
    v_add_u32 v192, s101, v192
    v_add_u32 v193, 4096, v192
    v_add_u32 v194, 8192, v192
    v_mov_b32 v195, -1
    v_accvgpr_write_b32 a240, v195
    v_accvgpr_write_b32 a241, v195
    v_accvgpr_write_b32 a242, v195
    v_accvgpr_write_b32 a243, v195
    buffer_store_dwordx4 a[240:243], v192, s[36:39], 0 offen offset:0 sc1
    s_waitcnt lgkmcnt(14)
    v_mfma_f32_16x16x32_bf16 v[136:139], a[8:11], v[48:51], v[136:139]
    ds_read_b64_tr_b16 a[36:37], v14 offset:17424
    v_mfma_f32_16x16x32_bf16 v[164:167], a[8:11], v[104:107], v[164:167]
    ds_read_b64_tr_b16 a[38:39], v14 offset:18512
    s_waitcnt lgkmcnt(14)
    v_mfma_f32_16x16x32_bf16 v[140:143], a[12:15], v[48:51], v[140:143]
    ds_read_b64_tr_b16 a[40:41], v14 offset:17432
    v_mfma_f32_16x16x32_bf16 v[168:171], a[12:15], v[104:107], v[168:171]
    ds_read_b64_tr_b16 a[42:43], v14 offset:18520
    s_waitcnt lgkmcnt(14)
    v_mfma_f32_16x16x32_bf16 v[144:147], a[16:19], v[48:51], v[144:147]
    ds_read_b64_tr_b16 a[44:45], v14 offset:17440
    v_mfma_f32_16x16x32_bf16 v[172:175], a[16:19], v[104:107], v[172:175]
    ds_read_b64_tr_b16 a[46:47], v14 offset:18528
    s_waitcnt lgkmcnt(14)
    v_mfma_f32_16x16x32_bf16 v[148:151], a[20:23], v[48:51], v[148:151]
    ds_read_b64_tr_b16 a[48:49], v14 offset:17448
    v_mfma_f32_16x16x32_bf16 v[176:179], a[20:23], v[104:107], v[176:179]
    ds_read_b64_tr_b16 a[50:51], v14 offset:18536
    s_waitcnt lgkmcnt(14)
    v_mfma_f32_16x16x32_bf16 v[152:155], a[24:27], v[48:51], v[152:155]
    ds_read_b64_tr_b16 a[52:53], v14 offset:17456
we_all_17:
wp_all_17:
    s_cmp_eq_u32 s43, 1
    s_cbranch_scc1 wr_0
    v_mfma_f32_16x16x32_bf16 v[180:183], a[24:27], v[104:107], v[180:183]
    ds_read_b64_tr_b16 a[54:55], v14 offset:18544
    s_waitcnt lgkmcnt(12)
    v_mfma_f32_16x16x32_bf16 v[128:131], a[28:31], v[52:55], v[128:131]
    buffer_store_dwordx4 a[240:243], v192, s[36:39], 0 offen offset:1024 sc1
    v_mfma_f32_16x16x32_bf16 v[156:159], a[28:31], v[108:111], v[156:159]
    s_waitcnt lgkmcnt(10)
    v_mfma_f32_16x16x32_bf16 v[132:135], a[32:35], v[52:55], v[132:135]
    v_mfma_f32_16x16x32_bf16 v[160:163], a[32:35], v[108:111], v[160:163]
    s_waitcnt lgkmcnt(8)
    v_mfma_f32_16x16x32_bf16 v[136:139], a[36:39], v[52:55], v[136:139]
    v_mfma_f32_16x16x32_bf16 v[164:167], a[36:39], v[108:111], v[164:167]
    s_waitcnt vmcnt(15)
    s_barrier
    s_waitcnt lgkmcnt(6)
    v_mfma_f32_16x16x32_bf16 v[140:143], a[40:43], v[52:55], v[140:143]
    ds_read_b128 v[56:59], v202 offset:0
    ds_read_b128 v[112:115], v202 offset:2048
    ds_read_b64_tr_b16 a[0:1], v14 offset:26112
    v_mfma_f32_16x16x32_bf16 v[168:171], a[40:43], v[108:111], v[168:171]
    ds_read_b64_tr_b16 a[2:3], v14 offset:27200
    ds_read_b64_tr_b16 a[4:5], v14 offset:26120
    ds_read_b64_tr_b16 a[6:7], v14 offset:27208
    s_waitcnt lgkmcnt(10)
    v_mfma_f32_16x16x32_bf16 v[144:147], a[44:47], v[52:55], v[144:147]
    ds_read_b64_tr_b16 a[8:9], v14 offset:26128
    ds_read_b64_tr_b16 a[10:11], v14 offset:27216
    v_mfma_f32_16x16x32_bf16 v[172:175], a[44:47], v[108:111], v[172:175]
    ds_read_b64_tr_b16 a[12:13], v14 offset:26136
    ds_read_b64_tr_b16 a[14:15], v14 offset:27224
    s_waitcnt lgkmcnt(12)
    v_mfma_f32_16x16x32_bf16 v[148:151], a[48:51], v[52:55], v[148:151]
    ds_read_b64_tr_b16 a[16:17], v14 offset:26144
    ds_read_b64_tr_b16 a[18:19], v14 offset:27232
    v_mfma_f32_16x16x32_bf16 v[176:179], a[48:51], v[108:111], v[176:179]
we_all_18:
wp_all_18:
    s_cmp_eq_u32 s43, 1
    s_cbranch_scc1 wr_0
    ds_read_b64_tr_b16 a[20:21], v14 offset:26152
    ds_read_b64_tr_b16 a[22:23], v14 offset:27240
    s_waitcnt lgkmcnt(14)
    v_mfma_f32_16x16x32_bf16 v[152:155], a[52:55], v[52:55], v[152:155]
    ds_read_b64_tr_b16 a[24:25], v14 offset:26160
    ds_read_b64_tr_b16 a[26:27], v14 offset:27248
    v_mfma_f32_16x16x32_bf16 v[180:183], a[52:55], v[108:111], v[180:183]
    ds_read_b128 v[60:63], v202 offset:1024
    ds_read_b128 v[116:119], v202 offset:3072
    s_waitcnt lgkmcnt(14)
    v_mfma_f32_16x16x32_bf16 v[128:131], a[0:3], v[56:59], v[128:131]
    ds_read_b64_tr_b16 a[28:29], v14 offset:34816
    v_mfma_f32_16x16x32_bf16 v[156:159], a[0:3], v[112:115], v[156:159]
    ds_read_b64_tr_b16 a[30:31], v14 offset:35904
    s_waitcnt lgkmcnt(14)
    v_mfma_f32_16x16x32_bf16 v[132:135], a[4:7], v[56:59], v[132:135]
    ds_read_b64_tr_b16 a[32:33], v14 offset:34824
    v_mfma_f32_16x16x32_bf16 v[160:163], a[4:7], v[112:115], v[160:163]
    ds_read_b64_tr_b16 a[34:35], v14 offset:35912
    s_waitcnt lgkmcnt(14)
    v_mfma_f32_16x16x32_bf16 v[136:139], a[8:11], v[56:59], v[136:139]
    ds_read_b64_tr_b16 a[36:37], v14 offset:34832
    v_mfma_f32_16x16x32_bf16 v[164:167], a[8:11], v[112:115], v[164:167]
    ds_read_b64_tr_b16 a[38:39], v14 offset:35920
    s_waitcnt lgkmcnt(14)
    v_mfma_f32_16x16x32_bf16 v[140:143], a[12:15], v[56:59], v[140:143]
    ds_read_b64_tr_b16 a[40:41], v14 offset:34840
    v_mfma_f32_16x16x32_bf16 v[168:171], a[12:15], v[112:115], v[168:171]
    ds_read_b64_tr_b16 a[42:43], v14 offset:35928
    s_waitcnt lgkmcnt(14)
    v_mfma_f32_16x16x32_bf16 v[144:147], a[16:19], v[56:59], v[144:147]
    ds_read_b64_tr_b16 a[44:45], v14 offset:34848
    v_mfma_f32_16x16x32_bf16 v[172:175], a[16:19], v[112:115], v[172:175]
    ds_read_b64_tr_b16 a[46:47], v14 offset:35936
we_all_19:
wp_all_19:
    s_cmp_eq_u32 s43, 1
    s_cbranch_scc1 wr_0
    s_waitcnt lgkmcnt(14)
    v_mfma_f32_16x16x32_bf16 v[148:151], a[20:23], v[56:59], v[148:151]
    ds_read_b64_tr_b16 a[48:49], v14 offset:34856
    v_mfma_f32_16x16x32_bf16 v[176:179], a[20:23], v[112:115], v[176:179]
    ds_read_b64_tr_b16 a[50:51], v14 offset:35944
    s_waitcnt lgkmcnt(14)
    v_mfma_f32_16x16x32_bf16 v[152:155], a[24:27], v[56:59], v[152:155]
    ds_read_b64_tr_b16 a[52:53], v14 offset:34864
    v_mfma_f32_16x16x32_bf16 v[180:183], a[24:27], v[112:115], v[180:183]
    ds_read_b64_tr_b16 a[54:55], v14 offset:35952
    s_waitcnt lgkmcnt(12)
    v_mfma_f32_16x16x32_bf16 v[128:131], a[28:31], v[60:63], v[128:131]
    v_mfma_f32_16x16x32_bf16 v[156:159], a[28:31], v[116:119], v[156:159]
    s_waitcnt lgkmcnt(10)
    v_mfma_f32_16x16x32_bf16 v[132:135], a[32:35], v[60:63], v[132:135]
    v_mfma_f32_16x16x32_bf16 v[160:163], a[32:35], v[116:119], v[160:163]
    s_waitcnt lgkmcnt(8)
    v_mfma_f32_16x16x32_bf16 v[136:139], a[36:39], v[60:63], v[136:139]
    v_mfma_f32_16x16x32_bf16 v[164:167], a[36:39], v[116:119], v[164:167]
    s_waitcnt vmcnt(7)
    s_barrier
    s_waitcnt lgkmcnt(6)
    v_mfma_f32_16x16x32_bf16 v[140:143], a[40:43], v[60:63], v[140:143]
    ds_read_b128 v[64:67], v202 offset:17408
    ds_read_b128 v[120:123], v202 offset:19456
    ds_read_b64_tr_b16 a[0:1], v14 offset:43520
    v_mfma_f32_16x16x32_bf16 v[168:171], a[40:43], v[116:119], v[168:171]
    ds_read_b64_tr_b16 a[2:3], v14 offset:44608
    ds_read_b64_tr_b16 a[4:5], v14 offset:43528
    ds_read_b64_tr_b16 a[6:7], v14 offset:44616
    s_waitcnt lgkmcnt(10)
    v_mfma_f32_16x16x32_bf16 v[144:147], a[44:47], v[60:63], v[144:147]
    ds_read_b64_tr_b16 a[8:9], v14 offset:43536
    ds_read_b64_tr_b16 a[10:11], v14 offset:44624
    v_mfma_f32_16x16x32_bf16 v[172:175], a[44:47], v[116:119], v[172:175]
we_all_20:
wp_all_20:
    s_cmp_eq_u32 s43, 1
    s_cbranch_scc1 wr_0
    ds_read_b64_tr_b16 a[12:13], v14 offset:43544
    ds_read_b64_tr_b16 a[14:15], v14 offset:44632
    s_waitcnt lgkmcnt(12)
    v_mfma_f32_16x16x32_bf16 v[148:151], a[48:51], v[60:63], v[148:151]
    ds_read_b64_tr_b16 a[16:17], v14 offset:43552
    ds_read_b64_tr_b16 a[18:19], v14 offset:44640
    v_mfma_f32_16x16x32_bf16 v[176:179], a[48:51], v[116:119], v[176:179]
    ds_read_b64_tr_b16 a[20:21], v14 offset:43560
    ds_read_b64_tr_b16 a[22:23], v14 offset:44648
    s_waitcnt lgkmcnt(14)
    v_mfma_f32_16x16x32_bf16 v[152:155], a[52:55], v[60:63], v[152:155]
    ds_read_b64_tr_b16 a[24:25], v14 offset:43568
    ds_read_b64_tr_b16 a[26:27], v14 offset:44656
    v_mfma_f32_16x16x32_bf16 v[180:183], a[52:55], v[116:119], v[180:183]
    ds_read_b128 v[68:71], v202 offset:18432
    ds_read_b128 v[124:127], v202 offset:20480
    s_waitcnt lgkmcnt(14)
    v_mfma_f32_16x16x32_bf16 v[128:131], a[0:3], v[64:67], v[128:131]
    ds_read_b64_tr_b16 a[28:29], v14 offset:52224
    v_mfma_f32_16x16x32_bf16 v[156:159], a[0:3], v[120:123], v[156:159]
    ds_read_b64_tr_b16 a[30:31], v14 offset:53312
    s_waitcnt lgkmcnt(14)
    v_mfma_f32_16x16x32_bf16 v[132:135], a[4:7], v[64:67], v[132:135]
    ds_read_b64_tr_b16 a[32:33], v14 offset:52232
    v_mfma_f32_16x16x32_bf16 v[160:163], a[4:7], v[120:123], v[160:163]
    ds_read_b64_tr_b16 a[34:35], v14 offset:53320
    s_waitcnt lgkmcnt(14)
    v_mfma_f32_16x16x32_bf16 v[136:139], a[8:11], v[64:67], v[136:139]
    ds_read_b64_tr_b16 a[36:37], v14 offset:52240
    v_mfma_f32_16x16x32_bf16 v[164:167], a[8:11], v[120:123], v[164:167]
    ds_read_b64_tr_b16 a[38:39], v14 offset:53328
    s_waitcnt lgkmcnt(14)
    v_mfma_f32_16x16x32_bf16 v[140:143], a[12:15], v[64:67], v[140:143]
    ds_read_b64_tr_b16 a[40:41], v14 offset:52248
we_all_21:
wp_all_21:
    s_cmp_eq_u32 s43, 1
    s_cbranch_scc1 wr_0
    v_mfma_f32_16x16x32_bf16 v[168:171], a[12:15], v[120:123], v[168:171]
    ds_read_b64_tr_b16 a[42:43], v14 offset:53336
    s_waitcnt lgkmcnt(14)
    v_mfma_f32_16x16x32_bf16 v[144:147], a[16:19], v[64:67], v[144:147]
    ds_read_b64_tr_b16 a[44:45], v14 offset:52256
    v_mfma_f32_16x16x32_bf16 v[172:175], a[16:19], v[120:123], v[172:175]
    ds_read_b64_tr_b16 a[46:47], v14 offset:53344
    s_waitcnt lgkmcnt(14)
    v_mfma_f32_16x16x32_bf16 v[148:151], a[20:23], v[64:67], v[148:151]
    ds_read_b64_tr_b16 a[48:49], v14 offset:52264
    v_mfma_f32_16x16x32_bf16 v[176:179], a[20:23], v[120:123], v[176:179]
    ds_read_b64_tr_b16 a[50:51], v14 offset:53352
    s_waitcnt lgkmcnt(14)
    v_mfma_f32_16x16x32_bf16 v[152:155], a[24:27], v[64:67], v[152:155]
    ds_read_b64_tr_b16 a[52:53], v14 offset:52272
    v_mfma_f32_16x16x32_bf16 v[180:183], a[24:27], v[120:123], v[180:183]
    ds_read_b64_tr_b16 a[54:55], v14 offset:53360
    s_waitcnt lgkmcnt(12)
    v_mfma_f32_16x16x32_bf16 v[128:131], a[28:31], v[68:71], v[128:131]
    v_mfma_f32_16x16x32_bf16 v[156:159], a[28:31], v[124:127], v[156:159]
    s_waitcnt lgkmcnt(10)
    v_mfma_f32_16x16x32_bf16 v[132:135], a[32:35], v[68:71], v[132:135]
    v_mfma_f32_16x16x32_bf16 v[160:163], a[32:35], v[124:127], v[160:163]
    s_waitcnt lgkmcnt(8)
    v_mfma_f32_16x16x32_bf16 v[136:139], a[36:39], v[68:71], v[136:139]
    v_mfma_f32_16x16x32_bf16 v[164:167], a[36:39], v[124:127], v[164:167]
    s_waitcnt lgkmcnt(6)
    v_mfma_f32_16x16x32_bf16 v[140:143], a[40:43], v[68:71], v[140:143]
    v_mfma_f32_16x16x32_bf16 v[168:171], a[40:43], v[124:127], v[168:171]
    s_waitcnt lgkmcnt(4)
    v_mfma_f32_16x16x32_bf16 v[144:147], a[44:47], v[68:71], v[144:147]
    v_mfma_f32_16x16x32_bf16 v[172:175], a[44:47], v[124:127], v[172:175]
    s_waitcnt lgkmcnt(2)
    v_mfma_f32_16x16x32_bf16 v[148:151], a[48:51], v[68:71], v[148:151]
    v_mfma_f32_16x16x32_bf16 v[176:179], a[48:51], v[124:127], v[176:179]
    s_waitcnt lgkmcnt(0)
we_all_22:
wp_all_22:
    s_cmp_eq_u32 s43, 1
    s_cbranch_scc1 wr_0
    v_mfma_f32_16x16x32_bf16 v[152:155], a[52:55], v[68:71], v[152:155]
    v_mfma_f32_16x16x32_bf16 v[180:183], a[52:55], v[124:127], v[180:183]
    s_cmp_lt_u32 s7, 4
    s_nop 6
    s_cbranch_scc0 k1_kernel_kv
    s_add_u32 s56, s40, 0x200000
    s_addc_u32 s57, s41, 0
    s_mov_b32 s58, 0x400000
    s_mov_b32 s59, 0x20000
    s_lshl_b32 s62, s6, 3
    s_lshl_b32 s63, s3, 1
    s_add_u32 s62, s62, s63
    s_lshl_b32 s62, s62, 4
    s_add_u32 s62, s62, s11
    v_add_u32 v8, s62, v4
    v_lshlrev_b32 v8, 11, v8
    v_lshl_add_u32 v8, v3, 4, v8
    v_add_u32 v9, 32768, v8
    v_mov_b32 v30, 0
    v_mov_b32 v31, 0
    v_cvt_pk_bf16_f32 v16, v128, v129
    v_cvt_pk_bf16_f32 v17, v130, v131
    v_cvt_pk_bf16_f32 v18, v132, v133
    v_cvt_pk_bf16_f32 v19, v134, v135
    v_cvt_pk_bf16_f32 v20, v136, v137
    v_cvt_pk_bf16_f32 v21, v138, v139
    v_cvt_pk_bf16_f32 v22, v140, v141
    v_cvt_pk_bf16_f32 v23, v142, v143
    v_cvt_pk_bf16_f32 v24, v144, v145
    v_cvt_pk_bf16_f32 v25, v146, v147
    v_cvt_pk_bf16_f32 v26, v148, v149
    v_cvt_pk_bf16_f32 v27, v150, v151
    v_cvt_pk_bf16_f32 v28, v152, v153
    v_cvt_pk_bf16_f32 v29, v154, v155
    v_mfma_f32_16x16x32_bf16 v[32:35], a[84:87], v[16:19], 0
    v_mfma_f32_16x16x32_bf16 v[36:39], a[100:103], v[16:19], 0
    v_mfma_f32_16x16x32_bf16 v[40:43], a[116:119], v[16:19], 0
    v_mfma_f32_16x16x32_bf16 v[44:47], a[132:135], v[16:19], 0
we_all_23:
wp_all_23:
    s_cmp_eq_u32 s43, 1
    s_cbranch_scc1 wr_0
    v_mfma_f32_16x16x32_bf16 v[48:51], a[148:151], v[16:19], 0
    v_mfma_f32_16x16x32_bf16 v[52:55], a[164:167], v[16:19], 0
    v_mfma_f32_16x16x32_bf16 v[56:59], a[180:183], v[16:19], 0
    v_mfma_f32_16x16x32_bf16 v[32:35], a[88:91], v[20:23], v[32:35]
    v_mfma_f32_16x16x32_bf16 v[36:39], a[104:107], v[20:23], v[36:39]
    v_mfma_f32_16x16x32_bf16 v[40:43], a[120:123], v[20:23], v[40:43]
    v_mfma_f32_16x16x32_bf16 v[44:47], a[136:139], v[20:23], v[44:47]
    v_mfma_f32_16x16x32_bf16 v[48:51], a[152:155], v[20:23], v[48:51]
    v_mfma_f32_16x16x32_bf16 v[52:55], a[168:171], v[20:23], v[52:55]
    v_mfma_f32_16x16x32_bf16 v[56:59], a[184:187], v[20:23], v[56:59]
    v_mfma_f32_16x16x32_bf16 v[32:35], a[92:95], v[24:27], v[32:35]
    v_mfma_f32_16x16x32_bf16 v[36:39], a[108:111], v[24:27], v[36:39]
    v_mfma_f32_16x16x32_bf16 v[40:43], a[124:127], v[24:27], v[40:43]
    v_mfma_f32_16x16x32_bf16 v[44:47], a[140:143], v[24:27], v[44:47]
    v_mfma_f32_16x16x32_bf16 v[48:51], a[156:159], v[24:27], v[48:51]
    v_mfma_f32_16x16x32_bf16 v[52:55], a[172:175], v[24:27], v[52:55]
    v_mfma_f32_16x16x32_bf16 v[56:59], a[188:191], v[24:27], v[56:59]
    v_mfma_f32_16x16x32_bf16 v[32:35], a[96:99], v[28:31], v[32:35]
    v_mfma_f32_16x16x32_bf16 v[36:39], a[112:115], v[28:31], v[36:39]
    v_mfma_f32_16x16x32_bf16 v[40:43], a[128:131], v[28:31], v[40:43]
    v_mfma_f32_16x16x32_bf16 v[44:47], a[144:147], v[28:31], v[44:47]
    v_mfma_f32_16x16x32_bf16 v[48:51], a[160:163], v[28:31], v[48:51]
    v_mfma_f32_16x16x32_bf16 v[52:55], a[176:179], v[28:31], v[52:55]
    v_mfma_f32_16x16x32_bf16 v[56:59], a[192:195], v[28:31], v[56:59]
    v_cvt_pk_bf16_f32 v60, v32, v33
    v_cvt_pk_bf16_f32 v61, v34, v35
    v_cvt_pk_bf16_f32 v62, v36, v37
    v_cvt_pk_bf16_f32 v63, v38, v39
    v_cvt_pk_bf16_f32 v64, v40, v41
    v_cvt_pk_bf16_f32 v65, v42, v43
    v_cvt_pk_bf16_f32 v66, v44, v45
we_all_24:
wp_all_24:
    s_cmp_eq_u32 s43, 1
    s_cbranch_scc1 wr_0
    v_cvt_pk_bf16_f32 v67, v46, v47
    v_cvt_pk_bf16_f32 v68, v48, v49
    v_cvt_pk_bf16_f32 v69, v50, v51
    v_cvt_pk_bf16_f32 v70, v52, v53
    v_cvt_pk_bf16_f32 v71, v54, v55
    v_cvt_pk_bf16_f32 v72, v56, v57
    v_cvt_pk_bf16_f32 v73, v58, v59
    v_lshlrev_b32 v32, 16, v60
    v_and_b32 v33, 0xffff0000, v60
    v_lshlrev_b32 v34, 16, v61
    v_and_b32 v35, 0xffff0000, v61
    v_lshlrev_b32 v36, 16, v62
    v_and_b32 v37, 0xffff0000, v62
    v_lshlrev_b32 v38, 16, v63
    v_and_b32 v39, 0xffff0000, v63
    v_lshlrev_b32 v40, 16, v64
    v_and_b32 v41, 0xffff0000, v64
    v_lshlrev_b32 v42, 16, v65
    v_and_b32 v43, 0xffff0000, v65
    v_lshlrev_b32 v44, 16, v66
    v_and_b32 v45, 0xffff0000, v66
    v_lshlrev_b32 v46, 16, v67
    v_and_b32 v47, 0xffff0000, v67
    v_lshlrev_b32 v48, 16, v68
    v_and_b32 v49, 0xffff0000, v68
    v_lshlrev_b32 v50, 16, v69
    v_and_b32 v51, 0xffff0000, v69
    v_lshlrev_b32 v52, 16, v70
    v_and_b32 v53, 0xffff0000, v70
    v_lshlrev_b32 v54, 16, v71
    v_and_b32 v55, 0xffff0000, v71
    v_lshlrev_b32 v56, 16, v72
    v_and_b32 v57, 0xffff0000, v72
    v_lshlrev_b32 v58, 16, v73
    v_and_b32 v59, 0xffff0000, v73
    v_max3_f32 v116, v32, v33, v34
    v_min3_f32 v118, v32, v33, v34
    v_max3_f32 v116, v116, v35, v36
we_all_25:
wp_all_25:
    s_cmp_eq_u32 s43, 1
    s_cbranch_scc1 wr_0
    v_min3_f32 v118, v118, v35, v36
    v_max3_f32 v116, v116, v37, v38
    v_min3_f32 v118, v118, v37, v38
    v_max3_f32 v116, v116, v39, v40
    v_min3_f32 v118, v118, v39, v40
    v_max3_f32 v116, v116, v41, v42
    v_min3_f32 v118, v118, v41, v42
    v_max3_f32 v116, v116, v43, v44
    v_min3_f32 v118, v118, v43, v44
    v_max3_f32 v116, v116, v45, v46
    v_min3_f32 v118, v118, v45, v46
    v_max3_f32 v116, v116, v47, v48
    v_min3_f32 v118, v118, v47, v48
    v_max3_f32 v116, v116, v49, v50
    v_min3_f32 v118, v118, v49, v50
    v_max3_f32 v116, v116, v51, v52
    v_min3_f32 v118, v118, v51, v52
    v_max3_f32 v116, v116, v53, v54
    v_min3_f32 v118, v118, v53, v54
    v_max3_f32 v116, v116, v55, v56
    v_min3_f32 v118, v118, v55, v56
    v_max3_f32 v116, v116, v57, v58
    v_min3_f32 v118, v118, v57, v58
    v_max_f32 v116, v116, v59
    v_min_f32 v118, v118, v59
    v_mul_f32 v116, 0xbfb8aa3b, v116
    v_mul_f32 v118, 0x3fb8aa3b, v118
    v_mov_b32 v117, v116
    v_mov_b32 v119, v118
    v_mov_b32 v120, 0x3fb8aa3b
    v_mov_b32 v121, 0x3fb8aa3b
    v_mov_b32 v122, 0xbfb8aa3b
    v_mov_b32 v123, 0xbfb8aa3b
we_all_26:
wp_all_26:
    s_cmp_eq_u32 s43, 1
    s_cbranch_scc1 wr_0
    v_pk_fma_f32 v[60:61], v[32:33], v[120:121], v[116:117]
    v_pk_fma_f32 v[88:89], v[32:33], v[122:123], v[118:119]
    v_pk_fma_f32 v[62:63], v[34:35], v[120:121], v[116:117]
    v_pk_fma_f32 v[90:91], v[34:35], v[122:123], v[118:119]
    v_pk_fma_f32 v[64:65], v[36:37], v[120:121], v[116:117]
    v_pk_fma_f32 v[92:93], v[36:37], v[122:123], v[118:119]
    v_pk_fma_f32 v[66:67], v[38:39], v[120:121], v[116:117]
    v_pk_fma_f32 v[94:95], v[38:39], v[122:123], v[118:119]
    v_pk_fma_f32 v[68:69], v[40:41], v[120:121], v[116:117]
    v_pk_fma_f32 v[96:97], v[40:41], v[122:123], v[118:119]
    v_pk_fma_f32 v[70:71], v[42:43], v[120:121], v[116:117]
    v_pk_fma_f32 v[98:99], v[42:43], v[122:123], v[118:119]
    v_pk_fma_f32 v[72:73], v[44:45], v[120:121], v[116:117]
    v_pk_fma_f32 v[100:101], v[44:45], v[122:123], v[118:119]
    v_pk_fma_f32 v[74:75], v[46:47], v[120:121], v[116:117]
    v_pk_fma_f32 v[102:103], v[46:47], v[122:123], v[118:119]
    v_pk_fma_f32 v[76:77], v[48:49], v[120:121], v[116:117]
    v_pk_fma_f32 v[104:105], v[48:49], v[122:123], v[118:119]
    v_pk_fma_f32 v[78:79], v[50:51], v[120:121], v[116:117]
    v_pk_fma_f32 v[106:107], v[50:51], v[122:123], v[118:119]
    v_pk_fma_f32 v[80:81], v[52:53], v[120:121], v[116:117]
    v_pk_fma_f32 v[108:109], v[52:53], v[122:123], v[118:119]
    v_pk_fma_f32 v[82:83], v[54:55], v[120:121], v[116:117]
    v_pk_fma_f32 v[110:111], v[54:55], v[122:123], v[118:119]
    v_pk_fma_f32 v[84:85], v[56:57], v[120:121], v[116:117]
    v_pk_fma_f32 v[112:113], v[56:57], v[122:123], v[118:119]
    v_pk_fma_f32 v[86:87], v[58:59], v[120:121], v[116:117]
    v_pk_fma_f32 v[114:115], v[58:59], v[122:123], v[118:119]
    v_exp_f32 v60, v60
    v_exp_f32 v61, v61
    v_exp_f32 v62, v62
    v_exp_f32 v63, v63
    v_exp_f32 v64, v64
we_all_27:
wp_all_27:
    s_cmp_eq_u32 s43, 1
    s_cbranch_scc1 wr_0
    v_exp_f32 v65, v65
    v_exp_f32 v66, v66
    v_exp_f32 v67, v67
    v_exp_f32 v68, v68
    v_exp_f32 v69, v69
    v_exp_f32 v70, v70
    v_exp_f32 v71, v71
    v_exp_f32 v72, v72
    v_exp_f32 v73, v73
    v_exp_f32 v74, v74
    v_exp_f32 v75, v75
    v_exp_f32 v76, v76
    v_exp_f32 v77, v77
    v_exp_f32 v78, v78
    v_exp_f32 v79, v79
    v_exp_f32 v80, v80
    v_exp_f32 v81, v81
    v_exp_f32 v82, v82
    v_exp_f32 v83, v83
    v_exp_f32 v84, v84
    v_exp_f32 v85, v85
    v_exp_f32 v86, v86
    v_exp_f32 v87, v87
    v_exp_f32 v88, v88
    v_exp_f32 v89, v89
    v_exp_f32 v90, v90
    v_exp_f32 v91, v91
    v_exp_f32 v92, v92
    v_exp_f32 v93, v93
    v_exp_f32 v94, v94
    v_exp_f32 v95, v95
    v_exp_f32 v96, v96
    v_exp_f32 v97, v97
    v_exp_f32 v98, v98
    v_exp_f32 v99, v99
    v_exp_f32 v100, v100
    v_exp_f32 v101, v101
    v_exp_f32 v102, v102
    v_exp_f32 v103, v103
    v_exp_f32 v104, v104
    v_exp_f32 v105, v105
    v_exp_f32 v106, v106
    v_exp_f32 v107, v107
    v_exp_f32 v108, v108
    v_exp_f32 v109, v109
    v_exp_f32 v110, v110
    v_exp_f32 v111, v111
    v_exp_f32 v112, v112
    v_exp_f32 v113, v113
    v_exp_f32 v114, v114
    v_exp_f32 v115, v115
    v_pk_add_f32 v[124:125], v[60:61], v[62:63]
    v_pk_add_f32 v[126:127], v[88:89], v[90:91]
    v_pk_add_f32 v[124:125], v[124:125], v[64:65]
    v_pk_add_f32 v[126:127], v[126:127], v[92:93]
    v_pk_add_f32 v[124:125], v[124:125], v[66:67]
    v_pk_add_f32 v[126:127], v[126:127], v[94:95]
we_all_28:
wp_all_28:
    s_cmp_eq_u32 s43, 1
    s_cbranch_scc1 wr_0
    v_pk_add_f32 v[124:125], v[124:125], v[68:69]
    v_pk_add_f32 v[126:127], v[126:127], v[96:97]
    v_pk_add_f32 v[124:125], v[124:125], v[70:71]
    v_pk_add_f32 v[126:127], v[126:127], v[98:99]
    v_pk_add_f32 v[124:125], v[124:125], v[72:73]
    v_pk_add_f32 v[126:127], v[126:127], v[100:101]
    v_pk_add_f32 v[124:125], v[124:125], v[74:75]
    v_pk_add_f32 v[126:127], v[126:127], v[102:103]
    v_pk_add_f32 v[124:125], v[124:125], v[76:77]
    v_pk_add_f32 v[126:127], v[126:127], v[104:105]
    v_pk_add_f32 v[124:125], v[124:125], v[78:79]
    v_pk_add_f32 v[126:127], v[126:127], v[106:107]
    v_pk_add_f32 v[124:125], v[124:125], v[80:81]
    v_pk_add_f32 v[126:127], v[126:127], v[108:109]
    v_pk_add_f32 v[124:125], v[124:125], v[82:83]
    v_pk_add_f32 v[126:127], v[126:127], v[110:111]
    v_pk_add_f32 v[124:125], v[124:125], v[84:85]
    v_pk_add_f32 v[126:127], v[126:127], v[112:113]
    v_pk_add_f32 v[124:125], v[124:125], v[86:87]
    v_pk_add_f32 v[126:127], v[126:127], v[114:115]
    v_add_f32 v124, v124, v125
    v_add_f32 v126, v126, v127
    v_rcp_f32 v124, v124
    v_rcp_f32 v126, v126
    v_mov_b32 v125, v124
    v_mov_b32 v127, v126
    v_pk_mul_f32 v[60:61], v[60:61], v[124:125]
    v_pk_mul_f32 v[88:89], v[88:89], v[126:127]
    v_pk_mul_f32 v[62:63], v[62:63], v[124:125]
    v_pk_mul_f32 v[90:91], v[90:91], v[126:127]
    v_pk_mul_f32 v[64:65], v[64:65], v[124:125]
    v_pk_mul_f32 v[92:93], v[92:93], v[126:127]
    v_pk_mul_f32 v[66:67], v[66:67], v[124:125]
    v_pk_mul_f32 v[94:95], v[94:95], v[126:127]
we_all_29:
wp_all_29:
    s_cmp_eq_u32 s43, 1
    s_cbranch_scc1 wr_0
    v_pk_mul_f32 v[68:69], v[68:69], v[124:125]
    v_pk_mul_f32 v[96:97], v[96:97], v[126:127]
    v_pk_mul_f32 v[70:71], v[70:71], v[124:125]
    v_pk_mul_f32 v[98:99], v[98:99], v[126:127]
    v_pk_mul_f32 v[72:73], v[72:73], v[124:125]
    v_pk_mul_f32 v[100:101], v[100:101], v[126:127]
    v_pk_mul_f32 v[74:75], v[74:75], v[124:125]
    v_pk_mul_f32 v[102:103], v[102:103], v[126:127]
    v_pk_mul_f32 v[76:77], v[76:77], v[124:125]
    v_pk_mul_f32 v[104:105], v[104:105], v[126:127]
    v_pk_mul_f32 v[78:79], v[78:79], v[124:125]
    v_pk_mul_f32 v[106:107], v[106:107], v[126:127]
    v_pk_mul_f32 v[80:81], v[80:81], v[124:125]
    v_pk_mul_f32 v[108:109], v[108:109], v[126:127]
    v_pk_mul_f32 v[82:83], v[82:83], v[124:125]
    v_pk_mul_f32 v[110:111], v[110:111], v[126:127]
    v_pk_mul_f32 v[84:85], v[84:85], v[124:125]
    v_pk_mul_f32 v[112:113], v[112:113], v[126:127]
    v_pk_mul_f32 v[86:87], v[86:87], v[124:125]
    v_pk_mul_f32 v[114:115], v[114:115], v[126:127]
    v_cvt_pk_bf16_f32 v192, v60, v61
    v_cvt_pk_bf16_f32 v193, v62, v63
    v_cvt_pk_bf16_f32 v194, v64, v65
    v_cvt_pk_bf16_f32 v195, v66, v67
    v_cvt_pk_bf16_f32 v196, v68, v69
    v_cvt_pk_bf16_f32 v197, v70, v71
    v_cvt_pk_bf16_f32 v198, v72, v73
    v_cvt_pk_bf16_f32 v199, v74, v75
    v_cvt_pk_bf16_f32 v200, v76, v77
    v_cvt_pk_bf16_f32 v201, v78, v79
    v_cvt_pk_bf16_f32 v202, v80, v81
we_all_30:
wp_all_30:
    s_cmp_eq_u32 s43, 1
    s_cbranch_scc1 wr_0
    v_cvt_pk_bf16_f32 v203, v82, v83
    v_cvt_pk_bf16_f32 v204, v84, v85
    v_cvt_pk_bf16_f32 v205, v86, v87
    v_cvt_pk_bf16_f32 v206, v88, v89
    v_cvt_pk_bf16_f32 v207, v90, v91
    v_cvt_pk_bf16_f32 v208, v92, v93
    v_cvt_pk_bf16_f32 v209, v94, v95
    v_cvt_pk_bf16_f32 v210, v96, v97
    v_cvt_pk_bf16_f32 v211, v98, v99
    v_cvt_pk_bf16_f32 v212, v100, v101
    v_cvt_pk_bf16_f32 v213, v102, v103
    v_cvt_pk_bf16_f32 v214, v104, v105
    v_cvt_pk_bf16_f32 v215, v106, v107
    v_cvt_pk_bf16_f32 v216, v108, v109
    v_cvt_pk_bf16_f32 v217, v110, v111
    v_cvt_pk_bf16_f32 v218, v112, v113
    v_cvt_pk_bf16_f32 v219, v114, v115
    buffer_store_dwordx4 v[192:195], v8, s[56:59], 0 offen offset:0 sc1
    buffer_store_dwordx4 v[196:199], v8, s[56:59], 0 offen offset:256 sc1
    buffer_store_dwordx4 v[200:203], v8, s[56:59], 0 offen offset:512 sc1
    buffer_store_dwordx4 v[204:207], v8, s[56:59], 0 offen offset:768 sc1
    buffer_store_dwordx4 v[208:211], v8, s[56:59], 0 offen offset:1024 sc1
    buffer_store_dwordx4 v[212:215], v8, s[56:59], 0 offen offset:1280 sc1
    buffer_store_dwordx4 v[216:219], v8, s[56:59], 0 offen offset:1536 sc1
    v_bfe_u32 v128, v1, 2, 2
    v_lshl_add_u32 v128, v4, 3, v128
    v_lshlrev_b32 v128, 7, v128
    v_and_b32 v129, 1, v1
    v_lshl_add_u32 v128, v129, 4, v128
    v_and_b32 v129, 2, v1
    v_lshl_add_u32 v128, v129, 2, v128
    v_add_u32 v128, s42, v128
    v_lshlrev_b32 v130, 4, v3
we_all_31:
wp_all_31:
    s_cmp_eq_u32 s43, 1
    s_cbranch_scc1 wr_0
    v_lshl_add_u32 v129, v4, 9, v130
    s_waitcnt vmcnt(10)
    ds_read_b64_tr_b16 a[212:213], v128 offset:4096
    ds_read_b64_tr_b16 a[214:215], v128 offset:4608
    ds_read_b64_tr_b16 a[216:217], v128 offset:4128
    ds_read_b64_tr_b16 a[218:219], v128 offset:4640
    ds_read_b64_tr_b16 a[220:221], v128 offset:4160
    ds_read_b64_tr_b16 a[222:223], v128 offset:4672
    ds_read_b64_tr_b16 a[224:225], v128 offset:4192
    ds_read_b64_tr_b16 a[226:227], v128 offset:4704
    s_waitcnt lgkmcnt(0)
    buffer_store_dwordx4 a[212:215], v129, s[92:95], s18 offen offset:0 sc1
    buffer_store_dwordx4 a[216:219], v129, s[92:95], s18 offen offset:256 sc1
    buffer_store_dwordx4 a[220:223], v129, s[92:95], s18 offen offset:2048 sc1
    buffer_store_dwordx4 a[224:227], v129, s[92:95], s18 offen offset:2304 sc1
    s_cmp_eq_u32 s19, 0
    s_nop 0
    s_cbranch_scc1 k1_kernelq_tkf
    v_mov_b32 v132, 0x3f803f80
    v_mov_b32 v133, 0x3f803f80
    v_mov_b32 v134, 0x3f803f80
    v_mov_b32 v135, 0x3f803f80
    s_nop 1
    v_mfma_f32_16x16x32_bf16 v[136:139], v[132:135], a[212:215], 0
    v_mfma_f32_16x16x32_bf16 v[140:143], v[132:135], a[216:219], 0
    v_mfma_f32_16x16x32_bf16 v[144:147], v[132:135], a[220:223], 0
    v_mfma_f32_16x16x32_bf16 v[148:151], v[132:135], a[224:227], 0
    v_lshrrev_b32 v152, 1, v4
    v_lshl_add_u32 v130, v152, 11, v130
    v_and_b32 v152, 1, v4
    v_lshl_add_u32 v130, v152, 8, v130
    v_mov_b32 v154, 0
    s_and_b32 s27, s19, 0x600
    s_cmp_eq_u32 s27, 0x600
    s_cselect_b32 s27, s19, 0x7f000000
    v_cmp_eq_u32 vcc, 1, v4
we_all_32:
wp_all_32:
    s_cmp_eq_u32 s43, 1
    s_cbranch_scc1 wr_0
    s_nop 1
    v_cndmask_b32 v136, v136, v140, vcc
    v_cmp_eq_u32 vcc, 2, v4
    s_nop 1
    v_cndmask_b32 v136, v136, v144, vcc
    v_cmp_eq_u32 vcc, 3, v4
    s_nop 1
    v_cndmask_b32 v136, v136, v148, vcc
    v_cvt_pk_bf16_f32 v152, v136, v136
    v_lshlrev_b32 v152, 16, v152
    v_sub_f32 v153, v136, v152
    v_cvt_pk_bf16_f32 v152, v152, v153
    buffer_store_dword v152, v130, s[92:95], s19 offen sc1
    buffer_store_dword v154, v130, s[92:95], s27 offen offset:8 sc1
k1_kernelq_tkf:
    v_cvt_pk_bf16_f32 v16, v156, v157
    v_cvt_pk_bf16_f32 v17, v158, v159
    v_cvt_pk_bf16_f32 v18, v160, v161
    v_cvt_pk_bf16_f32 v19, v162, v163
    v_cvt_pk_bf16_f32 v20, v164, v165
    v_cvt_pk_bf16_f32 v21, v166, v167
    v_cvt_pk_bf16_f32 v22, v168, v169
    v_cvt_pk_bf16_f32 v23, v170, v171
    v_cvt_pk_bf16_f32 v24, v172, v173
    v_cvt_pk_bf16_f32 v25, v174, v175
    v_cvt_pk_bf16_f32 v26, v176, v177
    v_cvt_pk_bf16_f32 v27, v178, v179
    v_cvt_pk_bf16_f32 v28, v180, v181
    v_cvt_pk_bf16_f32 v29, v182, v183
    v_mfma_f32_16x16x32_bf16 v[32:35], a[84:87], v[16:19], 0
    v_mfma_f32_16x16x32_bf16 v[36:39], a[100:103], v[16:19], 0
    v_mfma_f32_16x16x32_bf16 v[40:43], a[116:119], v[16:19], 0
    v_mfma_f32_16x16x32_bf16 v[44:47], a[132:135], v[16:19], 0
    v_mfma_f32_16x16x32_bf16 v[48:51], a[148:151], v[16:19], 0
    v_mfma_f32_16x16x32_bf16 v[52:55], a[164:167], v[16:19], 0
    v_mfma_f32_16x16x32_bf16 v[56:59], a[180:183], v[16:19], 0
    v_mfma_f32_16x16x32_bf16 v[32:35], a[88:91], v[20:23], v[32:35]
we_all_33:
wp_all_33:
    s_cmp_eq_u32 s43, 1
    s_cbranch_scc1 wr_0
    v_mfma_f32_16x16x32_bf16 v[36:39], a[104:107], v[20:23], v[36:39]
    v_mfma_f32_16x16x32_bf16 v[40:43], a[120:123], v[20:23], v[40:43]
    v_mfma_f32_16x16x32_bf16 v[44:47], a[136:139], v[20:23], v[44:47]
    v_mfma_f32_16x16x32_bf16 v[48:51], a[152:155], v[20:23], v[48:51]
    v_mfma_f32_16x16x32_bf16 v[52:55], a[168:171], v[20:23], v[52:55]
    v_mfma_f32_16x16x32_bf16 v[56:59], a[184:187], v[20:23], v[56:59]
    v_mfma_f32_16x16x32_bf16 v[32:35], a[92:95], v[24:27], v[32:35]
    v_mfma_f32_16x16x32_bf16 v[36:39], a[108:111], v[24:27], v[36:39]
    v_mfma_f32_16x16x32_bf16 v[40:43], a[124:127], v[24:27], v[40:43]
    v_mfma_f32_16x16x32_bf16 v[44:47], a[140:143], v[24:27], v[44:47]
    v_mfma_f32_16x16x32_bf16 v[48:51], a[156:159], v[24:27], v[48:51]
    v_mfma_f32_16x16x32_bf16 v[52:55], a[172:175], v[24:27], v[52:55]
    v_mfma_f32_16x16x32_bf16 v[56:59], a[188:191], v[24:27], v[56:59]
    v_mfma_f32_16x16x32_bf16 v[32:35], a[96:99], v[28:31], v[32:35]
    v_mfma_f32_16x16x32_bf16 v[36:39], a[112:115], v[28:31], v[36:39]
    v_mfma_f32_16x16x32_bf16 v[40:43], a[128:131], v[28:31], v[40:43]
    v_mfma_f32_16x16x32_bf16 v[44:47], a[144:147], v[28:31], v[44:47]
    v_mfma_f32_16x16x32_bf16 v[48:51], a[160:163], v[28:31], v[48:51]
    v_mfma_f32_16x16x32_bf16 v[52:55], a[176:179], v[28:31], v[52:55]
    v_mfma_f32_16x16x32_bf16 v[56:59], a[192:195], v[28:31], v[56:59]
    v_cvt_pk_bf16_f32 v60, v32, v33
    v_cvt_pk_bf16_f32 v61, v34, v35
    v_cvt_pk_bf16_f32 v62, v36, v37
    v_cvt_pk_bf16_f32 v63, v38, v39
    v_cvt_pk_bf16_f32 v64, v40, v41
    v_cvt_pk_bf16_f32 v65, v42, v43
    v_cvt_pk_bf16_f32 v66, v44, v45
    v_cvt_pk_bf16_f32 v67, v46, v47
    v_cvt_pk_bf16_f32 v68, v48, v49
    v_cvt_pk_bf16_f32 v69, v50, v51
    v_cvt_pk_bf16_f32 v70, v52, v53
we_all_34:
wp_all_34:
    s_cmp_eq_u32 s43, 1
    s_cbranch_scc1 wr_0
    v_cvt_pk_bf16_f32 v71, v54, v55
    v_cvt_pk_bf16_f32 v72, v56, v57
    v_cvt_pk_bf16_f32 v73, v58, v59
    v_lshlrev_b32 v32, 16, v60
    v_and_b32 v33, 0xffff0000, v60
    v_lshlrev_b32 v34, 16, v61
    v_and_b32 v35, 0xffff0000, v61
    v_lshlrev_b32 v36, 16, v62
    v_and_b32 v37, 0xffff0000, v62
    v_lshlrev_b32 v38, 16, v63
    v_and_b32 v39, 0xffff0000, v63
    v_lshlrev_b32 v40, 16, v64
    v_and_b32 v41, 0xffff0000, v64
    v_lshlrev_b32 v42, 16, v65
    v_and_b32 v43, 0xffff0000, v65
    v_lshlrev_b32 v44, 16, v66
    v_and_b32 v45, 0xffff0000, v66
    v_lshlrev_b32 v46, 16, v67
    v_and_b32 v47, 0xffff0000, v67
    v_lshlrev_b32 v48, 16, v68
    v_and_b32 v49, 0xffff0000, v68
    v_lshlrev_b32 v50, 16, v69
    v_and_b32 v51, 0xffff0000, v69
    v_lshlrev_b32 v52, 16, v70
    v_and_b32 v53, 0xffff0000, v70
    v_lshlrev_b32 v54, 16, v71
    v_and_b32 v55, 0xffff0000, v71
    v_lshlrev_b32 v56, 16, v72
    v_and_b32 v57, 0xffff0000, v72
    v_lshlrev_b32 v58, 16, v73
    v_and_b32 v59, 0xffff0000, v73
    v_max3_f32 v116, v32, v33, v34
    v_min3_f32 v118, v32, v33, v34
    v_max3_f32 v116, v116, v35, v36
    v_min3_f32 v118, v118, v35, v36
    v_max3_f32 v116, v116, v37, v38
    v_min3_f32 v118, v118, v37, v38
    v_max3_f32 v116, v116, v39, v40
we_all_35:
wp_all_35:
    s_cmp_eq_u32 s43, 1
    s_cbranch_scc1 wr_0
    v_min3_f32 v118, v118, v39, v40
    v_max3_f32 v116, v116, v41, v42
    v_min3_f32 v118, v118, v41, v42
    v_max3_f32 v116, v116, v43, v44
    v_min3_f32 v118, v118, v43, v44
    v_max3_f32 v116, v116, v45, v46
    v_min3_f32 v118, v118, v45, v46
    v_max3_f32 v116, v116, v47, v48
    v_min3_f32 v118, v118, v47, v48
    v_max3_f32 v116, v116, v49, v50
    v_min3_f32 v118, v118, v49, v50
    v_max3_f32 v116, v116, v51, v52
    v_min3_f32 v118, v118, v51, v52
    v_max3_f32 v116, v116, v53, v54
    v_min3_f32 v118, v118, v53, v54
    v_max3_f32 v116, v116, v55, v56
    v_min3_f32 v118, v118, v55, v56
    v_max3_f32 v116, v116, v57, v58
    v_min3_f32 v118, v118, v57, v58
    v_max_f32 v116, v116, v59
    v_min_f32 v118, v118, v59
    v_mul_f32 v116, 0xbfb8aa3b, v116
    v_mul_f32 v118, 0x3fb8aa3b, v118
    v_mov_b32 v117, v116
    v_mov_b32 v119, v118
    v_mov_b32 v120, 0x3fb8aa3b
    v_mov_b32 v121, 0x3fb8aa3b
    v_mov_b32 v122, 0xbfb8aa3b
    v_mov_b32 v123, 0xbfb8aa3b
    v_pk_fma_f32 v[60:61], v[32:33], v[120:121], v[116:117]
    v_pk_fma_f32 v[88:89], v[32:33], v[122:123], v[118:119]
    v_pk_fma_f32 v[62:63], v[34:35], v[120:121], v[116:117]
    v_pk_fma_f32 v[90:91], v[34:35], v[122:123], v[118:119]
we_all_36:
wp_all_36:
    s_cmp_eq_u32 s43, 1
    s_cbranch_scc1 wr_0
    v_pk_fma_f32 v[64:65], v[36:37], v[120:121], v[116:117]
    v_pk_fma_f32 v[92:93], v[36:37], v[122:123], v[118:119]
    v_pk_fma_f32 v[66:67], v[38:39], v[120:121], v[116:117]
    v_pk_fma_f32 v[94:95], v[38:39], v[122:123], v[118:119]
    v_pk_fma_f32 v[68:69], v[40:41], v[120:121], v[116:117]
    v_pk_fma_f32 v[96:97], v[40:41], v[122:123], v[118:119]
    v_pk_fma_f32 v[70:71], v[42:43], v[120:121], v[116:117]
    v_pk_fma_f32 v[98:99], v[42:43], v[122:123], v[118:119]
    v_pk_fma_f32 v[72:73], v[44:45], v[120:121], v[116:117]
    v_pk_fma_f32 v[100:101], v[44:45], v[122:123], v[118:119]
    v_pk_fma_f32 v[74:75], v[46:47], v[120:121], v[116:117]
    v_pk_fma_f32 v[102:103], v[46:47], v[122:123], v[118:119]
    v_pk_fma_f32 v[76:77], v[48:49], v[120:121], v[116:117]
    v_pk_fma_f32 v[104:105], v[48:49], v[122:123], v[118:119]
    v_pk_fma_f32 v[78:79], v[50:51], v[120:121], v[116:117]
    v_pk_fma_f32 v[106:107], v[50:51], v[122:123], v[118:119]
    v_pk_fma_f32 v[80:81], v[52:53], v[120:121], v[116:117]
    v_pk_fma_f32 v[108:109], v[52:53], v[122:123], v[118:119]
    v_pk_fma_f32 v[82:83], v[54:55], v[120:121], v[116:117]
    v_pk_fma_f32 v[110:111], v[54:55], v[122:123], v[118:119]
    v_pk_fma_f32 v[84:85], v[56:57], v[120:121], v[116:117]
    v_pk_fma_f32 v[112:113], v[56:57], v[122:123], v[118:119]
    v_pk_fma_f32 v[86:87], v[58:59], v[120:121], v[116:117]
    v_pk_fma_f32 v[114:115], v[58:59], v[122:123], v[118:119]
    v_exp_f32 v60, v60
    v_exp_f32 v61, v61
    v_exp_f32 v62, v62
    v_exp_f32 v63, v63
    v_exp_f32 v64, v64
    v_exp_f32 v65, v65
    v_exp_f32 v66, v66
    v_exp_f32 v67, v67
    v_exp_f32 v68, v68
    v_exp_f32 v69, v69
    v_exp_f32 v70, v70
    v_exp_f32 v71, v71
    v_exp_f32 v72, v72
    v_exp_f32 v73, v73
we_all_37:
wp_all_37:
    s_cmp_eq_u32 s43, 1
    s_cbranch_scc1 wr_0
    v_exp_f32 v74, v74
    v_exp_f32 v75, v75
    v_exp_f32 v76, v76
    v_exp_f32 v77, v77
    v_exp_f32 v78, v78
    v_exp_f32 v79, v79
    v_exp_f32 v80, v80
    v_exp_f32 v81, v81
    v_exp_f32 v82, v82
    v_exp_f32 v83, v83
    v_exp_f32 v84, v84
    v_exp_f32 v85, v85
    v_exp_f32 v86, v86
    v_exp_f32 v87, v87
    v_exp_f32 v88, v88
    v_exp_f32 v89, v89
    v_exp_f32 v90, v90
    v_exp_f32 v91, v91
    v_exp_f32 v92, v92
    v_exp_f32 v93, v93
    v_exp_f32 v94, v94
    v_exp_f32 v95, v95
    v_exp_f32 v96, v96
    v_exp_f32 v97, v97
    v_exp_f32 v98, v98
    v_exp_f32 v99, v99
    v_exp_f32 v100, v100
    v_exp_f32 v101, v101
    v_exp_f32 v102, v102
    v_exp_f32 v103, v103
    v_exp_f32 v104, v104
    v_exp_f32 v105, v105
    v_exp_f32 v106, v106
    v_exp_f32 v107, v107
    v_exp_f32 v108, v108
    v_exp_f32 v109, v109
    v_exp_f32 v110, v110
    v_exp_f32 v111, v111
    v_exp_f32 v112, v112
    v_exp_f32 v113, v113
    v_exp_f32 v114, v114
    v_exp_f32 v115, v115
    v_pk_add_f32 v[124:125], v[60:61], v[62:63]
    v_pk_add_f32 v[126:127], v[88:89], v[90:91]
    v_pk_add_f32 v[124:125], v[124:125], v[64:65]
    v_pk_add_f32 v[126:127], v[126:127], v[92:93]
    v_pk_add_f32 v[124:125], v[124:125], v[66:67]
    v_pk_add_f32 v[126:127], v[126:127], v[94:95]
    v_pk_add_f32 v[124:125], v[124:125], v[68:69]
    v_pk_add_f32 v[126:127], v[126:127], v[96:97]
    v_pk_add_f32 v[124:125], v[124:125], v[70:71]
    v_pk_add_f32 v[126:127], v[126:127], v[98:99]
we_all_38:
wp_all_38:
    s_cmp_eq_u32 s43, 1
    s_cbranch_scc1 wr_0
    v_pk_add_f32 v[124:125], v[124:125], v[72:73]
    v_pk_add_f32 v[126:127], v[126:127], v[100:101]
    v_pk_add_f32 v[124:125], v[124:125], v[74:75]
    v_pk_add_f32 v[126:127], v[126:127], v[102:103]
    v_pk_add_f32 v[124:125], v[124:125], v[76:77]
    v_pk_add_f32 v[126:127], v[126:127], v[104:105]
    v_pk_add_f32 v[124:125], v[124:125], v[78:79]
    v_pk_add_f32 v[126:127], v[126:127], v[106:107]
    v_pk_add_f32 v[124:125], v[124:125], v[80:81]
    v_pk_add_f32 v[126:127], v[126:127], v[108:109]
    v_pk_add_f32 v[124:125], v[124:125], v[82:83]
    v_pk_add_f32 v[126:127], v[126:127], v[110:111]
    v_pk_add_f32 v[124:125], v[124:125], v[84:85]
    v_pk_add_f32 v[126:127], v[126:127], v[112:113]
    v_pk_add_f32 v[124:125], v[124:125], v[86:87]
    v_pk_add_f32 v[126:127], v[126:127], v[114:115]
    v_add_f32 v124, v124, v125
    v_add_f32 v126, v126, v127
    v_rcp_f32 v124, v124
    v_rcp_f32 v126, v126
    v_mov_b32 v125, v124
    v_mov_b32 v127, v126
    v_pk_mul_f32 v[60:61], v[60:61], v[124:125]
    v_pk_mul_f32 v[88:89], v[88:89], v[126:127]
    v_pk_mul_f32 v[62:63], v[62:63], v[124:125]
    v_pk_mul_f32 v[90:91], v[90:91], v[126:127]
    v_pk_mul_f32 v[64:65], v[64:65], v[124:125]
    v_pk_mul_f32 v[92:93], v[92:93], v[126:127]
    v_pk_mul_f32 v[66:67], v[66:67], v[124:125]
    v_pk_mul_f32 v[94:95], v[94:95], v[126:127]
    v_pk_mul_f32 v[68:69], v[68:69], v[124:125]
    v_pk_mul_f32 v[96:97], v[96:97], v[126:127]
    v_pk_mul_f32 v[70:71], v[70:71], v[124:125]
    v_pk_mul_f32 v[98:99], v[98:99], v[126:127]
we_all_39:
wp_all_39:
    s_cmp_eq_u32 s43, 1
    s_cbranch_scc1 wr_0
    v_pk_mul_f32 v[72:73], v[72:73], v[124:125]
    v_pk_mul_f32 v[100:101], v[100:101], v[126:127]
    v_pk_mul_f32 v[74:75], v[74:75], v[124:125]
    v_pk_mul_f32 v[102:103], v[102:103], v[126:127]
    v_pk_mul_f32 v[76:77], v[76:77], v[124:125]
    v_pk_mul_f32 v[104:105], v[104:105], v[126:127]
    v_pk_mul_f32 v[78:79], v[78:79], v[124:125]
    v_pk_mul_f32 v[106:107], v[106:107], v[126:127]
    v_pk_mul_f32 v[80:81], v[80:81], v[124:125]
    v_pk_mul_f32 v[108:109], v[108:109], v[126:127]
    v_pk_mul_f32 v[82:83], v[82:83], v[124:125]
    v_pk_mul_f32 v[110:111], v[110:111], v[126:127]
    v_pk_mul_f32 v[84:85], v[84:85], v[124:125]
    v_pk_mul_f32 v[112:113], v[112:113], v[126:127]
    v_pk_mul_f32 v[86:87], v[86:87], v[124:125]
    v_pk_mul_f32 v[114:115], v[114:115], v[126:127]
    v_cvt_pk_bf16_f32 v220, v60, v61
    v_cvt_pk_bf16_f32 v221, v62, v63
    v_cvt_pk_bf16_f32 v222, v64, v65
    v_cvt_pk_bf16_f32 v223, v66, v67
    v_cvt_pk_bf16_f32 v224, v68, v69
    v_cvt_pk_bf16_f32 v225, v70, v71
    v_cvt_pk_bf16_f32 v226, v72, v73
    v_cvt_pk_bf16_f32 v227, v74, v75
    v_cvt_pk_bf16_f32 v228, v76, v77
    v_cvt_pk_bf16_f32 v229, v78, v79
    v_cvt_pk_bf16_f32 v230, v80, v81
    v_cvt_pk_bf16_f32 v231, v82, v83
    v_cvt_pk_bf16_f32 v232, v84, v85
    v_cvt_pk_bf16_f32 v233, v86, v87
    v_cvt_pk_bf16_f32 v234, v88, v89
we_all_40:
wp_all_40:
    s_cmp_eq_u32 s43, 1
    s_cbranch_scc1 wr_0
    v_cvt_pk_bf16_f32 v235, v90, v91
    v_cvt_pk_bf16_f32 v236, v92, v93
    v_cvt_pk_bf16_f32 v237, v94, v95
    v_cvt_pk_bf16_f32 v238, v96, v97
    v_cvt_pk_bf16_f32 v239, v98, v99
    v_cvt_pk_bf16_f32 v240, v100, v101
    v_cvt_pk_bf16_f32 v241, v102, v103
    v_cvt_pk_bf16_f32 v242, v104, v105
    v_cvt_pk_bf16_f32 v243, v106, v107
    v_cvt_pk_bf16_f32 v244, v108, v109
    v_cvt_pk_bf16_f32 v245, v110, v111
    v_cvt_pk_bf16_f32 v246, v112, v113
    v_cvt_pk_bf16_f32 v247, v114, v115
    buffer_store_dwordx4 v[220:223], v9, s[56:59], 0 offen offset:0 sc1
    buffer_store_dwordx4 v[224:227], v9, s[56:59], 0 offen offset:256 sc1
    buffer_store_dwordx4 v[228:231], v9, s[56:59], 0 offen offset:512 sc1
    buffer_store_dwordx4 v[232:235], v9, s[56:59], 0 offen offset:768 sc1
    buffer_store_dwordx4 v[236:239], v9, s[56:59], 0 offen offset:1024 sc1
    buffer_store_dwordx4 v[240:243], v9, s[56:59], 0 offen offset:1280 sc1
    buffer_store_dwordx4 v[244:247], v9, s[56:59], 0 offen offset:1536 sc1
    s_endpgm
k1_kernel_kv:
we_all_41:
wp_all_41:
    s_cmp_eq_u32 s43, 1
    s_cbranch_scc1 wr_0
    s_add_u32 s56, s40, 0x600000
    s_addc_u32 s57, s41, 0
    s_mov_b32 s58, 0x200000
    s_mov_b32 s59, 0x20000
    v_bfe_u32 v204, v1, 2, 2
    v_lshl_add_u32 v204, v4, 3, v204
    v_lshlrev_b32 v204, 7, v204
    v_and_b32 v205, 1, v1
    v_lshl_add_u32 v204, v205, 4, v204
    v_and_b32 v205, 2, v1
    v_lshl_add_u32 v204, v205, 2, v204
    v_add_u32 v204, s42, v204
we_all_42:
wp_all_42:
    s_cmp_eq_u32 s43, 1
    s_cbranch_scc1 wr_0
    v_lshlrev_b32 v206, 4, v3
    v_lshl_add_u32 v205, v4, 9, v206
    s_waitcnt vmcnt(3)
    ds_read_b64_tr_b16 a[212:213], v204 offset:4096
    ds_read_b64_tr_b16 a[214:215], v204 offset:4608
    ds_read_b64_tr_b16 a[216:217], v204 offset:4128
    ds_read_b64_tr_b16 a[218:219], v204 offset:4640
    ds_read_b64_tr_b16 a[220:221], v204 offset:4160
    ds_read_b64_tr_b16 a[222:223], v204 offset:4672
    ds_read_b64_tr_b16 a[224:225], v204 offset:4192
    ds_read_b64_tr_b16 a[226:227], v204 offset:4704
    s_waitcnt lgkmcnt(0)
    buffer_store_dwordx4 a[212:215], v205, s[92:95], s18 offen offset:0 sc1
    buffer_store_dwordx4 a[216:219], v205, s[92:95], s18 offen offset:256 sc1
    buffer_store_dwordx4 a[220:223], v205, s[92:95], s18 offen offset:2048 sc1
    buffer_store_dwordx4 a[224:227], v205, s[92:95], s18 offen offset:2304 sc1
    s_cmp_eq_u32 s19, 0
    s_nop 0
    s_cbranch_scc1 k1_kernelk_tkf
    v_mov_b32 v208, 0x3f803f80
    v_mov_b32 v209, 0x3f803f80
    v_mov_b32 v210, 0x3f803f80
    v_mov_b32 v211, 0x3f803f80
    s_nop 1
    v_mfma_f32_16x16x32_bf16 v[212:215], v[208:211], a[212:215], 0
    v_mfma_f32_16x16x32_bf16 v[216:219], v[208:211], a[216:219], 0
    v_mfma_f32_16x16x32_bf16 v[220:223], v[208:211], a[220:223], 0
    v_mfma_f32_16x16x32_bf16 v[224:227], v[208:211], a[224:227], 0
    v_lshrrev_b32 v228, 1, v4
    v_lshl_add_u32 v206, v228, 11, v206
    v_and_b32 v228, 1, v4
    v_lshl_add_u32 v206, v228, 8, v206
    v_mov_b32 v230, 0
    s_and_b32 s27, s19, 0x600
    s_cmp_eq_u32 s27, 0x600
    s_cselect_b32 s27, s19, 0x7f000000
we_all_43:
wp_all_43:
    s_cmp_eq_u32 s43, 1
    s_cbranch_scc1 wr_0
    v_cmp_eq_u32 vcc, 1, v4
    s_nop 1
    v_cndmask_b32 v212, v212, v216, vcc
    v_cmp_eq_u32 vcc, 2, v4
    s_nop 1
    v_cndmask_b32 v212, v212, v220, vcc
    v_cmp_eq_u32 vcc, 3, v4
    s_nop 1
    v_cndmask_b32 v212, v212, v224, vcc
    v_cvt_pk_bf16_f32 v228, v212, v212
    v_lshlrev_b32 v228, 16, v228
    v_sub_f32 v229, v212, v228
    v_cvt_pk_bf16_f32 v228, v228, v229
    buffer_store_dword v228, v206, s[92:95], s19 offen sc1
    buffer_store_dword v230, v206, s[92:95], s27 offen offset:8 sc1
k1_kernelk_tkf:
    v_cvt_pk_bf16_f32 v16, v128, v129
    v_cvt_pk_bf16_f32 v224, v156, v157
    v_cvt_pk_bf16_f32 v17, v130, v131
    v_cvt_pk_bf16_f32 v225, v158, v159
    v_cvt_pk_bf16_f32 v18, v132, v133
    v_cvt_pk_bf16_f32 v226, v160, v161
    v_cvt_pk_bf16_f32 v19, v134, v135
    v_cvt_pk_bf16_f32 v227, v162, v163
    v_cvt_pk_bf16_f32 v20, v136, v137
    v_cvt_pk_bf16_f32 v228, v164, v165
    v_cvt_pk_bf16_f32 v21, v138, v139
    v_cvt_pk_bf16_f32 v229, v166, v167
    v_cvt_pk_bf16_f32 v22, v140, v141
    v_cvt_pk_bf16_f32 v230, v168, v169
    v_cvt_pk_bf16_f32 v23, v142, v143
    v_cvt_pk_bf16_f32 v231, v170, v171
    v_cvt_pk_bf16_f32 v24, v144, v145
    v_cvt_pk_bf16_f32 v232, v172, v173
    v_cvt_pk_bf16_f32 v25, v146, v147
    v_cvt_pk_bf16_f32 v233, v174, v175
    v_cvt_pk_bf16_f32 v26, v148, v149
    v_cvt_pk_bf16_f32 v234, v176, v177
we_all_44:
wp_all_44:
    s_cmp_eq_u32 s43, 1
    s_cbranch_scc1 wr_0
    v_cvt_pk_bf16_f32 v27, v150, v151
    v_cvt_pk_bf16_f32 v235, v178, v179
    v_cvt_pk_bf16_f32 v28, v152, v153
    v_cvt_pk_bf16_f32 v236, v180, v181
    v_cvt_pk_bf16_f32 v29, v154, v155
    v_cvt_pk_bf16_f32 v237, v182, v183
    v_mov_b32 v30, 0
    v_mov_b32 v31, 0
    v_permlane32_swap_b32 v16, v224
    v_permlane32_swap_b32 v17, v225
    v_permlane32_swap_b32 v18, v226
    v_permlane32_swap_b32 v19, v227
    v_permlane32_swap_b32 v20, v228
    v_permlane32_swap_b32 v21, v229
    v_permlane32_swap_b32 v22, v230
    v_permlane32_swap_b32 v23, v231
    v_permlane32_swap_b32 v24, v232
    v_permlane32_swap_b32 v25, v233
    v_permlane32_swap_b32 v26, v234
    v_permlane32_swap_b32 v27, v235
    v_permlane32_swap_b32 v28, v236
    v_permlane32_swap_b32 v29, v237
    s_barrier
    s_lshl_b32 s62, s3, 5
    v_add_u32 v8, s62, v3
    v_mul_u32_u24 v8, 96, v8
    v_and_b32 v9, 1, v4
    v_mul_u32_u24 v9, 12288, v9
    v_add_u32 v8, v8, v9
    v_and_b32 v9, 4, v3
    v_lshl_add_u32 v8, v9, 2, v8
    v_mov_b32 v9, 1.0
    v_cvt_pk_bf16_f32 v224, v128, v129
    v_cvt_pk_bf16_f32 v225, v130, v131
    v_cvt_pk_bf16_f32 v232, v132, v133
    v_cvt_pk_bf16_f32 v233, v134, v9
    v_cvt_pk_bf16_f32 v226, v135, v136
    v_cvt_pk_bf16_f32 v227, v137, v138
    v_cvt_pk_bf16_f32 v234, v139, v140
    v_cvt_pk_bf16_f32 v235, v141, v9
    v_cvt_pk_bf16_f32 v228, v142, v143
    v_cvt_pk_bf16_f32 v229, v144, v145
we_all_45:
wp_all_45:
    s_cmp_eq_u32 s43, 1
    s_cbranch_scc1 wr_0
    v_cvt_pk_bf16_f32 v236, v146, v147
    v_cvt_pk_bf16_f32 v237, v148, v9
    v_cvt_pk_bf16_f32 v230, v149, v150
    v_cvt_pk_bf16_f32 v231, v151, v152
    v_cvt_pk_bf16_f32 v238, v153, v154
    v_cvt_pk_bf16_f32 v239, v155, v9
    v_cvt_pk_bf16_f32 v240, v156, v157
    v_cvt_pk_bf16_f32 v241, v158, v159
    v_cvt_pk_bf16_f32 v248, v160, v161
    v_cvt_pk_bf16_f32 v249, v162, v9
    v_cvt_pk_bf16_f32 v242, v163, v164
    v_cvt_pk_bf16_f32 v243, v165, v166
    v_cvt_pk_bf16_f32 v250, v167, v168
    v_cvt_pk_bf16_f32 v251, v169, v9
    v_cvt_pk_bf16_f32 v244, v170, v171
    v_cvt_pk_bf16_f32 v245, v172, v173
    v_cvt_pk_bf16_f32 v252, v174, v175
    v_cvt_pk_bf16_f32 v253, v176, v9
    v_cvt_pk_bf16_f32 v246, v177, v178
    v_cvt_pk_bf16_f32 v247, v179, v180
    v_cvt_pk_bf16_f32 v254, v181, v182
    v_cvt_pk_bf16_f32 v255, v183, v9
    s_mov_b32 s62, 0
    s_mov_b32 s63, -1
    s_mov_b64 exec, s[62:63]
    ds_write_b128 v8, v[224:227] offset:40960
    ds_write_b128 v8, v[228:231] offset:40976
    ds_write_b128 v8, v[232:235] offset:40992
    ds_write_b128 v8, v[236:239] offset:41008
    ds_write_b128 v8, v[240:243] offset:42496
    ds_write_b128 v8, v[244:247] offset:42512
    ds_write_b128 v8, v[248:251] offset:42528
    ds_write_b128 v8, v[252:255] offset:42544
we_all_46:
wp_all_46:
    s_cmp_eq_u32 s43, 1
    s_cbranch_scc1 wr_0
    s_mov_b64 exec, -1
    v_mfma_f32_16x16x32_bf16 v[32:35], a[84:87], v[16:19], 0
    v_mfma_f32_16x16x32_bf16 v[36:39], a[100:103], v[16:19], 0
    v_mfma_f32_16x16x32_bf16 v[40:43], a[116:119], v[16:19], 0
    v_mfma_f32_16x16x32_bf16 v[44:47], a[132:135], v[16:19], 0
    v_mfma_f32_16x16x32_bf16 v[48:51], a[148:151], v[16:19], 0
    v_mfma_f32_16x16x32_bf16 v[52:55], a[164:167], v[16:19], 0
    v_mfma_f32_16x16x32_bf16 v[56:59], a[180:183], v[16:19], 0
    v_mfma_f32_16x16x32_bf16 v[32:35], a[88:91], v[20:23], v[32:35]
    v_mfma_f32_16x16x32_bf16 v[36:39], a[104:107], v[20:23], v[36:39]
    v_mfma_f32_16x16x32_bf16 v[40:43], a[120:123], v[20:23], v[40:43]
    v_mfma_f32_16x16x32_bf16 v[44:47], a[136:139], v[20:23], v[44:47]
    v_mfma_f32_16x16x32_bf16 v[48:51], a[152:155], v[20:23], v[48:51]
    v_mfma_f32_16x16x32_bf16 v[52:55], a[168:171], v[20:23], v[52:55]
    v_mfma_f32_16x16x32_bf16 v[56:59], a[184:187], v[20:23], v[56:59]
    v_mfma_f32_16x16x32_bf16 v[32:35], a[92:95], v[24:27], v[32:35]
    v_mfma_f32_16x16x32_bf16 v[36:39], a[108:111], v[24:27], v[36:39]
    v_mfma_f32_16x16x32_bf16 v[40:43], a[124:127], v[24:27], v[40:43]
    v_mfma_f32_16x16x32_bf16 v[44:47], a[140:143], v[24:27], v[44:47]
    v_mfma_f32_16x16x32_bf16 v[48:51], a[156:159], v[24:27], v[48:51]
    v_mfma_f32_16x16x32_bf16 v[52:55], a[172:175], v[24:27], v[52:55]
    v_mfma_f32_16x16x32_bf16 v[56:59], a[188:191], v[24:27], v[56:59]
    v_mfma_f32_16x16x32_bf16 v[32:35], a[96:99], v[28:31], v[32:35]
    v_mfma_f32_16x16x32_bf16 v[36:39], a[112:115], v[28:31], v[36:39]
    v_mfma_f32_16x16x32_bf16 v[40:43], a[128:131], v[28:31], v[40:43]
    v_mfma_f32_16x16x32_bf16 v[44:47], a[144:147], v[28:31], v[44:47]
    v_mfma_f32_16x16x32_bf16 v[48:51], a[160:163], v[28:31], v[48:51]
    v_mfma_f32_16x16x32_bf16 v[52:55], a[176:179], v[28:31], v[52:55]
    v_mfma_f32_16x16x32_bf16 v[56:59], a[192:195], v[28:31], v[56:59]
    v_cvt_pk_bf16_f32 v60, v32, v33
    v_cvt_pk_bf16_f32 v61, v34, v35
we_all_47:
wp_all_47:
    s_cmp_eq_u32 s43, 1
    s_cbranch_scc1 wr_0
    v_cvt_pk_bf16_f32 v62, v36, v37
    v_cvt_pk_bf16_f32 v63, v38, v39
    v_cvt_pk_bf16_f32 v64, v40, v41
    v_cvt_pk_bf16_f32 v65, v42, v43
    v_cvt_pk_bf16_f32 v66, v44, v45
    v_cvt_pk_bf16_f32 v67, v46, v47
    v_cvt_pk_bf16_f32 v68, v48, v49
    v_cvt_pk_bf16_f32 v69, v50, v51
    v_cvt_pk_bf16_f32 v70, v52, v53
    v_cvt_pk_bf16_f32 v71, v54, v55
    v_cvt_pk_bf16_f32 v72, v56, v57
    v_cvt_pk_bf16_f32 v73, v58, v59
    v_lshlrev_b32 v32, 16, v60
    v_and_b32 v33, 0xffff0000, v60
    v_lshlrev_b32 v34, 16, v61
    v_and_b32 v35, 0xffff0000, v61
    v_lshlrev_b32 v36, 16, v62
    v_and_b32 v37, 0xffff0000, v62
    v_lshlrev_b32 v38, 16, v63
    v_and_b32 v39, 0xffff0000, v63
    v_lshlrev_b32 v40, 16, v64
    v_and_b32 v41, 0xffff0000, v64
    v_lshlrev_b32 v42, 16, v65
    v_and_b32 v43, 0xffff0000, v65
    v_lshlrev_b32 v44, 16, v66
    v_and_b32 v45, 0xffff0000, v66
    v_lshlrev_b32 v46, 16, v67
    v_and_b32 v47, 0xffff0000, v67
    v_lshlrev_b32 v48, 16, v68
    v_and_b32 v49, 0xffff0000, v68
    v_lshlrev_b32 v50, 16, v69
    v_and_b32 v51, 0xffff0000, v69
    v_lshlrev_b32 v52, 16, v70
    v_and_b32 v53, 0xffff0000, v70
    v_lshlrev_b32 v54, 16, v71
    v_and_b32 v55, 0xffff0000, v71
    v_lshlrev_b32 v56, 16, v72
    v_and_b32 v57, 0xffff0000, v72
we_all_48:
wp_all_48:
    s_cmp_eq_u32 s43, 1
    s_cbranch_scc1 wr_0
    v_lshlrev_b32 v58, 16, v73
    v_and_b32 v59, 0xffff0000, v73
    v_max3_f32 v116, v32, v33, v34
    v_min3_f32 v118, v32, v33, v34
    v_max3_f32 v116, v116, v35, v36
    v_min3_f32 v118, v118, v35, v36
    v_max3_f32 v116, v116, v37, v38
    v_min3_f32 v118, v118, v37, v38
    v_max3_f32 v116, v116, v39, v40
    v_min3_f32 v118, v118, v39, v40
    v_max3_f32 v116, v116, v41, v42
    v_min3_f32 v118, v118, v41, v42
    v_max3_f32 v116, v116, v43, v44
    v_min3_f32 v118, v118, v43, v44
    v_max3_f32 v116, v116, v45, v46
    v_min3_f32 v118, v118, v45, v46
    v_max3_f32 v116, v116, v47, v48
    v_min3_f32 v118, v118, v47, v48
    v_max3_f32 v116, v116, v49, v50
    v_min3_f32 v118, v118, v49, v50
    v_max3_f32 v116, v116, v51, v52
    v_min3_f32 v118, v118, v51, v52
    v_max3_f32 v116, v116, v53, v54
    v_min3_f32 v118, v118, v53, v54
    v_max3_f32 v116, v116, v55, v56
    v_min3_f32 v118, v118, v55, v56
    v_max3_f32 v116, v116, v57, v58
    v_min3_f32 v118, v118, v57, v58
    v_max_f32 v116, v116, v59
    v_min_f32 v118, v118, v59
    v_mul_f32 v116, 0xbfb8aa3b, v116
    v_mul_f32 v118, 0x3fb8aa3b, v118
we_all_49:
wp_all_49:
    s_cmp_eq_u32 s43, 1
    s_cbranch_scc1 wr_0
    v_mov_b32 v117, v116
    v_mov_b32 v119, v118
    v_mov_b32 v120, 0x3fb8aa3b
    v_mov_b32 v121, 0x3fb8aa3b
    v_mov_b32 v122, 0xbfb8aa3b
    v_mov_b32 v123, 0xbfb8aa3b
    v_pk_fma_f32 v[60:61], v[32:33], v[120:121], v[116:117]
    v_pk_fma_f32 v[88:89], v[32:33], v[122:123], v[118:119]
    v_pk_fma_f32 v[62:63], v[34:35], v[120:121], v[116:117]
    v_pk_fma_f32 v[90:91], v[34:35], v[122:123], v[118:119]
    v_pk_fma_f32 v[64:65], v[36:37], v[120:121], v[116:117]
    v_pk_fma_f32 v[92:93], v[36:37], v[122:123], v[118:119]
    v_pk_fma_f32 v[66:67], v[38:39], v[120:121], v[116:117]
    v_pk_fma_f32 v[94:95], v[38:39], v[122:123], v[118:119]
    v_pk_fma_f32 v[68:69], v[40:41], v[120:121], v[116:117]
    v_pk_fma_f32 v[96:97], v[40:41], v[122:123], v[118:119]
    v_pk_fma_f32 v[70:71], v[42:43], v[120:121], v[116:117]
    v_pk_fma_f32 v[98:99], v[42:43], v[122:123], v[118:119]
    v_pk_fma_f32 v[72:73], v[44:45], v[120:121], v[116:117]
    v_pk_fma_f32 v[100:101], v[44:45], v[122:123], v[118:119]
    v_pk_fma_f32 v[74:75], v[46:47], v[120:121], v[116:117]
    v_pk_fma_f32 v[102:103], v[46:47], v[122:123], v[118:119]
    v_pk_fma_f32 v[76:77], v[48:49], v[120:121], v[116:117]
    v_pk_fma_f32 v[104:105], v[48:49], v[122:123], v[118:119]
    v_pk_fma_f32 v[78:79], v[50:51], v[120:121], v[116:117]
    v_pk_fma_f32 v[106:107], v[50:51], v[122:123], v[118:119]
    v_pk_fma_f32 v[80:81], v[52:53], v[120:121], v[116:117]
    v_pk_fma_f32 v[108:109], v[52:53], v[122:123], v[118:119]
    v_pk_fma_f32 v[82:83], v[54:55], v[120:121], v[116:117]
    v_pk_fma_f32 v[110:111], v[54:55], v[122:123], v[118:119]
    v_pk_fma_f32 v[84:85], v[56:57], v[120:121], v[116:117]
    v_pk_fma_f32 v[112:113], v[56:57], v[122:123], v[118:119]
we_all_50:
wp_all_50:
    s_cmp_eq_u32 s43, 1
    s_cbranch_scc1 wr_0
    v_pk_fma_f32 v[86:87], v[58:59], v[120:121], v[116:117]
    v_pk_fma_f32 v[114:115], v[58:59], v[122:123], v[118:119]
    v_exp_f32 v60, v60
    v_exp_f32 v61, v61
    v_exp_f32 v62, v62
    v_exp_f32 v63, v63
    v_exp_f32 v64, v64
    v_exp_f32 v65, v65
    v_exp_f32 v66, v66
    v_exp_f32 v67, v67
    v_exp_f32 v68, v68
    v_exp_f32 v69, v69
    v_exp_f32 v70, v70
    v_exp_f32 v71, v71
    v_exp_f32 v72, v72
    v_exp_f32 v73, v73
    v_exp_f32 v74, v74
    v_exp_f32 v75, v75
    v_exp_f32 v76, v76
    v_exp_f32 v77, v77
    v_exp_f32 v78, v78
    v_exp_f32 v79, v79
    v_exp_f32 v80, v80
    v_exp_f32 v81, v81
    v_exp_f32 v82, v82
    v_exp_f32 v83, v83
    v_exp_f32 v84, v84
    v_exp_f32 v85, v85
    v_exp_f32 v86, v86
    v_exp_f32 v87, v87
    v_exp_f32 v88, v88
    v_exp_f32 v89, v89
    v_exp_f32 v90, v90
    v_exp_f32 v91, v91
    v_exp_f32 v92, v92
    v_exp_f32 v93, v93
    v_exp_f32 v94, v94
    v_exp_f32 v95, v95
    v_exp_f32 v96, v96
    v_exp_f32 v97, v97
    v_exp_f32 v98, v98
    v_exp_f32 v99, v99
    v_exp_f32 v100, v100
    v_exp_f32 v101, v101
    v_exp_f32 v102, v102
    v_exp_f32 v103, v103
    v_exp_f32 v104, v104
    v_exp_f32 v105, v105
    v_exp_f32 v106, v106
    v_exp_f32 v107, v107
    v_exp_f32 v108, v108
    v_exp_f32 v109, v109
    v_exp_f32 v110, v110
    v_exp_f32 v111, v111
    v_exp_f32 v112, v112
    v_exp_f32 v113, v113
    v_exp_f32 v114, v114
    v_exp_f32 v115, v115
    v_pk_add_f32 v[124:125], v[60:61], v[62:63]
we_all_51:
wp_all_51:
    s_cmp_eq_u32 s43, 1
    s_cbranch_scc1 wr_0
    v_pk_add_f32 v[126:127], v[88:89], v[90:91]
    v_pk_add_f32 v[124:125], v[124:125], v[64:65]
    v_pk_add_f32 v[126:127], v[126:127], v[92:93]
    v_pk_add_f32 v[124:125], v[124:125], v[66:67]
    v_pk_add_f32 v[126:127], v[126:127], v[94:95]
    v_pk_add_f32 v[124:125], v[124:125], v[68:69]
    v_pk_add_f32 v[126:127], v[126:127], v[96:97]
    v_pk_add_f32 v[124:125], v[124:125], v[70:71]
    v_pk_add_f32 v[126:127], v[126:127], v[98:99]
    v_pk_add_f32 v[124:125], v[124:125], v[72:73]
    v_pk_add_f32 v[126:127], v[126:127], v[100:101]
    v_pk_add_f32 v[124:125], v[124:125], v[74:75]
    v_pk_add_f32 v[126:127], v[126:127], v[102:103]
    v_pk_add_f32 v[124:125], v[124:125], v[76:77]
    v_pk_add_f32 v[126:127], v[126:127], v[104:105]
    v_pk_add_f32 v[124:125], v[124:125], v[78:79]
    v_pk_add_f32 v[126:127], v[126:127], v[106:107]
    v_pk_add_f32 v[124:125], v[124:125], v[80:81]
    v_pk_add_f32 v[126:127], v[126:127], v[108:109]
    v_pk_add_f32 v[124:125], v[124:125], v[82:83]
    v_pk_add_f32 v[126:127], v[126:127], v[110:111]
    v_pk_add_f32 v[124:125], v[124:125], v[84:85]
    v_pk_add_f32 v[126:127], v[126:127], v[112:113]
    v_pk_add_f32 v[124:125], v[124:125], v[86:87]
    v_pk_add_f32 v[126:127], v[126:127], v[114:115]
    v_add_f32 v124, v124, v125
    v_add_f32 v126, v126, v127
    v_rcp_f32 v124, v124
    v_rcp_f32 v126, v126
    v_mov_b32 v125, v124
    v_mov_b32 v127, v126
    v_pk_mul_f32 v[60:61], v[60:61], v[124:125]
    v_pk_mul_f32 v[88:89], v[88:89], v[126:127]
    v_pk_mul_f32 v[62:63], v[62:63], v[124:125]
we_all_52:
wp_all_52:
    s_cmp_eq_u32 s43, 1
    s_cbranch_scc1 wr_0
    v_pk_mul_f32 v[90:91], v[90:91], v[126:127]
    v_pk_mul_f32 v[64:65], v[64:65], v[124:125]
    v_pk_mul_f32 v[92:93], v[92:93], v[126:127]
    v_pk_mul_f32 v[66:67], v[66:67], v[124:125]
    v_pk_mul_f32 v[94:95], v[94:95], v[126:127]
    v_pk_mul_f32 v[68:69], v[68:69], v[124:125]
    v_pk_mul_f32 v[96:97], v[96:97], v[126:127]
    v_pk_mul_f32 v[70:71], v[70:71], v[124:125]
    v_pk_mul_f32 v[98:99], v[98:99], v[126:127]
    v_pk_mul_f32 v[72:73], v[72:73], v[124:125]
    v_pk_mul_f32 v[100:101], v[100:101], v[126:127]
    v_pk_mul_f32 v[74:75], v[74:75], v[124:125]
    v_pk_mul_f32 v[102:103], v[102:103], v[126:127]
    v_pk_mul_f32 v[76:77], v[76:77], v[124:125]
    v_pk_mul_f32 v[104:105], v[104:105], v[126:127]
    v_pk_mul_f32 v[78:79], v[78:79], v[124:125]
    v_pk_mul_f32 v[106:107], v[106:107], v[126:127]
    v_pk_mul_f32 v[80:81], v[80:81], v[124:125]
    v_pk_mul_f32 v[108:109], v[108:109], v[126:127]
    v_pk_mul_f32 v[82:83], v[82:83], v[124:125]
    v_pk_mul_f32 v[110:111], v[110:111], v[126:127]
    v_pk_mul_f32 v[84:85], v[84:85], v[124:125]
    v_pk_mul_f32 v[112:113], v[112:113], v[126:127]
    v_pk_mul_f32 v[86:87], v[86:87], v[124:125]
    v_pk_mul_f32 v[114:115], v[114:115], v[126:127]
    v_cvt_pk_bf16_f32 v192, v60, v61
    v_cvt_pk_bf16_f32 v193, v62, v63
    v_cvt_pk_bf16_f32 v200, v64, v65
    v_cvt_pk_bf16_f32 v201, v66, v67
    v_cvt_pk_bf16_f32 v194, v68, v69
    v_cvt_pk_bf16_f32 v195, v70, v71
we_all_53:
wp_all_53:
    s_cmp_eq_u32 s43, 1
    s_cbranch_scc1 wr_0
    v_cvt_pk_bf16_f32 v202, v72, v73
    v_cvt_pk_bf16_f32 v203, v74, v75
    v_cvt_pk_bf16_f32 v196, v76, v77
    v_cvt_pk_bf16_f32 v197, v78, v79
    v_cvt_pk_bf16_f32 v204, v80, v81
    v_cvt_pk_bf16_f32 v205, v82, v83
    v_cvt_pk_bf16_f32 v198, v84, v85
    v_cvt_pk_bf16_f32 v199, v86, v87
    v_cvt_pk_bf16_f32 v206, v88, v89
    v_cvt_pk_bf16_f32 v207, v90, v91
    v_cvt_pk_bf16_f32 v208, v92, v93
    v_cvt_pk_bf16_f32 v209, v94, v95
    v_cvt_pk_bf16_f32 v216, v96, v97
    v_cvt_pk_bf16_f32 v217, v98, v99
    v_cvt_pk_bf16_f32 v210, v100, v101
    v_cvt_pk_bf16_f32 v211, v102, v103
    v_cvt_pk_bf16_f32 v218, v104, v105
    v_cvt_pk_bf16_f32 v219, v106, v107
    v_cvt_pk_bf16_f32 v212, v108, v109
    v_cvt_pk_bf16_f32 v213, v110, v111
    v_cvt_pk_bf16_f32 v220, v112, v113
    v_cvt_pk_bf16_f32 v221, v114, v115
    s_lshl_b32 s62, s3, 5
    v_lshrrev_b32 v8, 1, v4
    v_lshlrev_b32 v8, 4, v8
    v_add3_u32 v8, v8, v3, s62
    v_and_b32 v9, 1, v4
    v_lshl_add_u32 v8, v9, 7, v8
    v_mul_u32_u24 v8, 160, v8
    v_and_b32 v9, 4, v3
    v_lshl_add_u32 v8, v9, 2, v8
    ds_write_b128 v8, v[192:195] offset:0
    ds_write_b128 v8, v[196:199] offset:16
    ds_write_b128 v8, v[200:203] offset:32
we_all_54:
wp_all_54:
    s_cmp_eq_u32 s43, 1
    s_cbranch_scc1 wr_0
    ds_write_b128 v8, v[204:207] offset:48
    ds_write_b128 v8, v[208:211] offset:64
    ds_write_b64 v8, v[212:213] offset:80
    ds_write_b128 v8, v[216:219] offset:96
    ds_write_b64 v8, v[220:221] offset:112
    v_bfe_u32 v5, v1, 2, 2
    v_lshl_add_u32 v5, v4, 3, v5
    v_and_b32 v6, 3, v1
    s_lshr_b32 s62, s3, 1
    s_and_b32 s63, s3, 1
    s_mul_i32 s64, s62, 20480
    s_mul_i32 s65, s62, 12288
    s_lshl_b32 s66, s63, 6
    s_add_u32 s64, s64, s66
    v_mul_u32_u24 v7, 160, v5
    v_lshl_add_u32 v7, v6, 3, v7
    v_add_u32 v8, s64, v7
    v_mul_u32_u24 v7, 96, v5
    v_lshl_add_u32 v7, v6, 3, v7
    v_add_u32 v9, s65, v7
    s_lshl_b32 s64, s6, 4
    s_add_u32 s64, s64, s11
    s_add_u32 s64, s64, s62
    s_lshl_b32 s64, s64, 2
    s_add_u32 s64, s64, s63
    s_lshl_b32 s64, s64, 11
    v_lshlrev_b32 v7, 4, v1
    s_cmp_eq_u32 s63, 1
    s_cselect_b32 s66, 3, 7
    v_mov_b32 v6, 0x7f000000
    v_cmp_eq_u32 vcc, s66, v4
    s_nop 1
    v_cndmask_b32 v7, v7, v6, vcc
    s_waitcnt lgkmcnt(0)
    s_barrier
    ds_read_b64_tr_b16 v[128:129], v9 offset:40960
    ds_read_b64_tr_b16 v[130:131], v9 offset:41360
    ds_read_b64_tr_b16 v[32:33], v8 offset:0
    ds_read_b64_tr_b16 v[34:35], v8 offset:656
    ds_read_b64_tr_b16 v[132:133], v9 offset:40992
    ds_read_b64_tr_b16 v[134:135], v9 offset:41392
we_all_55:
wp_all_55:
    s_cmp_eq_u32 s43, 1
    s_cbranch_scc1 wr_0
    ds_read_b64_tr_b16 v[36:37], v8 offset:32
    ds_read_b64_tr_b16 v[38:39], v8 offset:688
    ds_read_b64_tr_b16 v[136:137], v9 offset:44032
    ds_read_b64_tr_b16 v[138:139], v9 offset:44432
    ds_read_b64_tr_b16 v[40:41], v8 offset:5120
    ds_read_b64_tr_b16 v[42:43], v8 offset:5776
    ds_read_b64_tr_b16 v[140:141], v9 offset:44064
    ds_read_b64_tr_b16 v[142:143], v9 offset:44464
    ds_read_b64_tr_b16 v[44:45], v8 offset:5152
    ds_read_b64_tr_b16 v[46:47], v8 offset:5808
    ds_read_b64_tr_b16 v[144:145], v9 offset:47104
    ds_read_b64_tr_b16 v[146:147], v9 offset:47504
    ds_read_b64_tr_b16 v[48:49], v8 offset:10240
    ds_read_b64_tr_b16 v[50:51], v8 offset:10896
    ds_read_b64_tr_b16 v[148:149], v9 offset:47136
    ds_read_b64_tr_b16 v[150:151], v9 offset:47536
    ds_read_b64_tr_b16 v[52:53], v8 offset:10272
    ds_read_b64_tr_b16 v[54:55], v8 offset:10928
    ds_read_b64_tr_b16 v[152:153], v9 offset:50176
    ds_read_b64_tr_b16 v[154:155], v9 offset:50576
    ds_read_b64_tr_b16 v[56:57], v8 offset:15360
    ds_read_b64_tr_b16 v[58:59], v8 offset:16016
    ds_read_b64_tr_b16 v[156:157], v9 offset:50208
    ds_read_b64_tr_b16 v[158:159], v9 offset:50608
    ds_read_b64_tr_b16 v[60:61], v8 offset:15392
    ds_read_b64_tr_b16 v[62:63], v8 offset:16048
    s_waitcnt lgkmcnt(15)
    v_mfma_f32_16x16x32_bf16 v[96:99], v[32:35], v[128:131], 0
    v_mfma_f32_16x16x32_bf16 v[100:103], v[36:39], v[128:131], 0
    v_mfma_f32_16x16x32_bf16 v[104:107], v[32:35], v[132:135], 0
    v_mfma_f32_16x16x32_bf16 v[108:111], v[36:39], v[132:135], 0
    v_mfma_f32_16x16x32_bf16 v[96:99], v[40:43], v[136:139], v[96:99]
we_all_56:
wp_all_56:
    s_cmp_eq_u32 s43, 1
    s_cbranch_scc1 wr_0
    v_mfma_f32_16x16x32_bf16 v[100:103], v[44:47], v[136:139], v[100:103]
    v_mfma_f32_16x16x32_bf16 v[104:107], v[40:43], v[140:143], v[104:107]
    v_mfma_f32_16x16x32_bf16 v[108:111], v[44:47], v[140:143], v[108:111]
    s_waitcnt lgkmcnt(12)
    v_mfma_f32_16x16x32_bf16 v[96:99], v[48:51], v[144:147], v[96:99]
    s_waitcnt lgkmcnt(8)
    v_mfma_f32_16x16x32_bf16 v[100:103], v[52:55], v[144:147], v[100:103]
    v_mfma_f32_16x16x32_bf16 v[104:107], v[48:51], v[148:151], v[104:107]
    v_mfma_f32_16x16x32_bf16 v[108:111], v[52:55], v[148:151], v[108:111]
    s_waitcnt lgkmcnt(4)
    v_mfma_f32_16x16x32_bf16 v[96:99], v[56:59], v[152:155], v[96:99]
    s_waitcnt lgkmcnt(0)
    v_mfma_f32_16x16x32_bf16 v[100:103], v[60:63], v[152:155], v[100:103]
    v_mfma_f32_16x16x32_bf16 v[104:107], v[56:59], v[156:159], v[104:107]
    v_mfma_f32_16x16x32_bf16 v[108:111], v[60:63], v[156:159], v[108:111]
    v_cvt_pk_f16_f32 v112, v96, v97
    v_cvt_pk_f16_f32 v113, v98, v99
    s_nop 1
    v_cvt_pk_f16_f32 v114, v100, v101
    v_cvt_pk_f16_f32 v115, v102, v103
    buffer_store_dwordx4 v[112:115], v7, s[56:59], s64 offen sc1
    v_cvt_pk_f16_f32 v116, v104, v105
    v_cvt_pk_f16_f32 v117, v106, v107
    v_cvt_pk_f16_f32 v118, v108, v109
    v_cvt_pk_f16_f32 v119, v110, v111
    s_add_u32 s64, s64, 4096
    buffer_store_dwordx4 v[116:119], v7, s[56:59], s64 offen sc1
    s_endpgm
k1_kernel_w1:
    s_mov_b32 s8, 896
    s_sub_u32 s62, s7, 12
    s_mul_i32 s9, s62, 224
    s_mov_b32 s48, s26
    s_mov_b32 s49, s27
    s_mov_b32 s50, 0x62000
    s_mov_b32 s51, 0x20000
    s_mov_b32 s56, s40
    s_mov_b32 s57, s41
    s_mov_b32 s58, 0x200000
    s_mov_b32 s59, 0x20000
    v_mul_lo_u32 v7, v5, s8
    v_lshl_add_u32 v7, v6, 4, v7
    v_add_u32 v7, s9, v7
    v_add_u32 v8, s10, v7
    v_cmp_lt_u32 vcc, 6, v6
    s_nop 1
    v_cndmask_b32 v7, v7, v8, vcc
    v_mov_b32 v8, 0x80000000
    v_cmp_lt_u32 vcc, 55, v1
    s_nop 1
    v_cndmask_b32 v12, v7, v8, vcc
    s_lshl_b32 s14, s8, 2
    s_mul_i32 s13, s14, s3
    s_lshl_b32 s14, s14, 2
    s_mov_b32 s68, s13
    s_lshl_b32 s13, s14, 2
    s_mul_i32 s13, s13, s15
    s_add_u32 s13, s13, s68
    s_add_u32 s15, s15, 1
    s_cmp_eq_u32 s15, 7
    s_cselect_b32 s15, 0, s15
    s_add_u32 m0, s61, 0
    s_nop 0
    buffer_load_dwordx4 v12, s[48:51], s13 offen lds
    s_add_u32 s13, s13, s14
    s_add_u32 m0, s61, 4352
    s_nop 0
    buffer_load_dwordx4 v12, s[48:51], s13 offen lds
    s_add_u32 s13, s13, s14
    s_add_u32 m0, s61, 8704
    s_nop 0
    buffer_load_dwordx4 v12, s[48:51], s13 offen lds
    s_add_u32 s13, s13, s14
    s_add_u32 m0, s61, 13056
    s_nop 0
    buffer_load_dwordx4 v12, s[48:51], s13 offen lds
    s_lshl_b32 s67, s60, 7
    s_add_u32 s60, s60, 1
    s_cmp_eq_u32 s60, 7
    s_cselect_b32 s60, 0, s60
    s_add_u32 m0, s42, 4096
    s_nop 0
    buffer_load_dwordx4 v10, s[44:47], s67 offen offset:0 lds
    s_add_u32 m0, s42, 5056
    s_nop 0
    buffer_load_dwordx4 v10, s[44:47], s67 offen offset:64 lds
    s_add_u32 m0, s42, 6144
    s_nop 0
    buffer_load_dwordx4 v11, s[44:47], s67 offen offset:0 lds
    s_add_u32 m0, s42, 7104
    s_nop 0
    buffer_load_dwordx4 v11, s[44:47], s67 offen offset:64 lds
    s_lshl_b32 s13, s14, 2
    s_mul_i32 s13, s13, s15
    s_add_u32 s13, s13, s68
    s_add_u32 s15, s15, 1
    s_cmp_eq_u32 s15, 7
    s_cselect_b32 s15, 0, s15
    s_add_u32 m0, s61, 17408
    s_nop 0
    buffer_load_dwordx4 v12, s[48:51], s13 offen lds
    s_add_u32 s13, s13, s14
    s_add_u32 m0, s61, 21760
    s_nop 0
    buffer_load_dwordx4 v12, s[48:51], s13 offen lds
    s_add_u32 s13, s13, s14
    s_add_u32 m0, s61, 26112
    s_nop 0
    buffer_load_dwordx4 v12, s[48:51], s13 offen lds
    s_add_u32 s13, s13, s14
    s_add_u32 m0, s61, 30464
    s_nop 0
    buffer_load_dwordx4 v12, s[48:51], s13 offen lds
    v_bfe_u32 v5, v1, 2, 2
    v_and_b32 v6, 3, v1
    v_mul_u32_u24 v7, 2176, v4
    v_mul_u32_u24 v8, 224, v5
    v_add_u32 v7, v7, v8
    v_mul_u32_u24 v8, 56, v6
    v_add_u32 v13, v7, v8
    v_add_u32 v14, 60928, v13
    v_lshrrev_b32 v7, 2, v3
    v_xor_b32 v7, v7, v4
    v_lshlrev_b32 v7, 4, v7
    v_lshl_add_u32 v7, v3, 6, v7
    v_add_u32 v2, s42, v7
    v_mov_b32 v8, 0
    v_mov_b32 v9, 0
    v_lshlrev_b32 v7, 3, v0
    v_add_u32 v7, 129024, v7
    ds_write_b64 v7, v[8:9]
    v_mov_b32 v188, 0x3f803f80
    v_mov_b32 v189, 0x3f803f80
    v_mov_b32 v190, 0x3f803f80
    v_mov_b32 v191, 0x3f803f80
    v_lshlrev_b32 v255, 2, v4
    v_sub_u32 v255, v3, v255
    v_cmp_eq_u32 vcc, 0, v255
    s_nop 1
    v_cndmask_b32_e64 v252, 0, 1.0, vcc
    v_cmp_eq_u32 vcc, 1, v255
    s_nop 1
    v_cndmask_b32_e64 v253, 0, 1.0, vcc
    v_cmp_eq_u32 vcc, 2, v255
    s_nop 1
    v_cndmask_b32_e64 v254, 0, 1.0, vcc
    v_cmp_eq_u32 vcc, 3, v255
    s_nop 1
    v_cndmask_b32_e64 v255, 0, 1.0, vcc
    s_lshl_b32 s24, s2, 2
    s_add_u32 s24, s24, s3
    s_mov_b32 s92, s40
    s_mov_b32 s93, s41
    s_mov_b32 s94, 0x1c00000
    s_mov_b32 s95, 0x20000
    s_mov_b32 s91, 0x20000
    s_mov_b32 s19, 0
    s_cmp_lt_u32 s2, 98
    s_cbranch_scc0 k1_kernelb_tk1
    s_mov_b32 s88, s32
    s_mov_b32 s89, s33
    s_mov_b32 s90, 0x188000
    s_mov_b32 s20, 896
    s_mov_b32 s34, 28672
    s_mov_b32 s17, 7168
    s_mov_b32 s21, 7
    s_mov_b32 s35, 56
    s_mov_b32 s69, 0x1800000
    s_sub_u32 s27, s24, 0
    s_mul_i32 s25, s27, 9363
    s_lshr_b32 s25, s25, 16
    s_mul_i32 s26, s25, 7
    s_sub_u32 s26, s27, s26
    s_branch k1_kernelb_tk9
k1_kernelb_tk1:
    s_cmp_lt_u32 s2, 196
    s_cbranch_scc0 k1_kernelb_tk2
    s_mov_b32 s88, s30
    s_mov_b32 s89, s31
    s_mov_b32 s90, 0x188000
    s_mov_b32 s20, 3584
    s_mov_b32 s34, 114688
    s_mov_b32 s17, 28672
    s_mov_b32 s21, 7
    s_mov_b32 s35, 15
    s_mov_b32 s69, 0x1600000
    s_sub_u32 s27, s24, 392
    s_mul_i32 s25, s27, 2341
    s_lshr_b32 s25, s25, 16
    s_mul_i32 s26, s25, 28
    s_sub_u32 s26, s27, s26
    s_mul_i32 s19, s26, 61440
    s_add_u32 s19, s19, 0x160e000
    s_lshr_b32 s27, s25, 2
    s_lshl_b32 s27, s27, 9
    s_add_u32 s19, s19, s27
    s_and_b32 s27, s25, 3
    s_lshl_b32 s27, s27, 2
    s_add_u32 s19, s19, s27
    s_branch k1_kernelb_tk9
k1_kernelb_tk2:
    s_cmp_lt_u32 s2, 224
    s_cbranch_scc0 k1_kernelb_tk3
    s_mov_b32 s88, s22
    s_mov_b32 s89, s23
    s_mov_b32 s90, 0x62000
    s_mov_b32 s20, 896
    s_mov_b32 s34, 25088
    s_mov_b32 s17, 6272
    s_mov_b32 s21, 6
    s_mov_b32 s35, 16
    s_mov_b32 s69, 0x1a00000
    s_sub_u32 s27, s24, 784
    s_mul_i32 s25, s27, 9363
    s_lshr_b32 s25, s25, 16
    s_mul_i32 s26, s25, 7
    s_sub_u32 s26, s27, s26
    s_branch k1_kernelb_tk9
k1_kernelb_tk3:
    s_mov_b32 s88, s28
    s_mov_b32 s89, s29
    s_mov_b32 s90, 0x62000
    s_mov_b32 s20, 896
    s_mov_b32 s34, 28672
    s_mov_b32 s17, 7168
    s_mov_b32 s21, 7
    s_mov_b32 s35, 0
    s_mov_b32 s69, 0x7f000000
    s_sub_u32 s27, s24, 896
    s_mul_i32 s25, s27, 9363
    s_lshr_b32 s25, s25, 16
    s_mul_i32 s26, s25, 7
    s_sub_u32 s26, s27, s26
k1_kernelb_tk9:
    s_mul_i32 s16, s25, s34
    s_lshl_b32 s27, s26, 7
    s_add_u32 s16, s16, s27
    s_mul_i32 s18, s26, s35
    s_add_u32 s18, s18, s25
    s_lshl_b32 s18, s18, 12
    s_add_u32 s18, s18, s69
    v_lshrrev_b32 v200, 3, v1
    v_min_u32 v200, s21, v200
    v_mul_lo_u32 v200, v200, s20
    v_and_b32 v201, 7, v1
    v_lshl_add_u32 v200, v201, 4, v200
    s_lshl_b32 s28, s3, 12
    v_subrev_u32 v202, s42, v2
    v_add_u32 v202, s28, v202
we_all_57:
wp_all_57:
    s_cmp_eq_u32 s43, 1
    s_cbranch_scc1 wr_0
    s_waitcnt vmcnt(8)
    s_waitcnt lgkmcnt(0)
    s_barrier
    ds_read_b128 v[16:19], v2 offset:0
    ds_read_b128 v[72:75], v2 offset:2048
    ds_read_b64_tr_b16 a[0:1], v13 offset:0
    ds_read_b64_tr_b16 a[2:3], v13 offset:1088
    ds_read_b64_tr_b16 a[4:5], v13 offset:8
    ds_read_b64_tr_b16 a[6:7], v13 offset:1096
    ds_read_b64_tr_b16 a[8:9], v13 offset:16
    ds_read_b64_tr_b16 a[10:11], v13 offset:1104
    ds_read_b64_tr_b16 a[12:13], v13 offset:24
    ds_read_b64_tr_b16 a[14:15], v13 offset:1112
    ds_read_b64_tr_b16 a[16:17], v13 offset:32
    ds_read_b64_tr_b16 a[18:19], v13 offset:1120
    ds_read_b64_tr_b16 a[20:21], v13 offset:40
we_all_58:
wp_all_58:
    s_cmp_eq_u32 s43, 1
    s_cbranch_scc1 wr_0
    ds_read_b64_tr_b16 a[22:23], v13 offset:1128
    ds_read_b64_tr_b16 a[24:25], v13 offset:48
    ds_read_b64_tr_b16 a[26:27], v13 offset:1136
    ds_read_b128 v[20:23], v2 offset:1024
    ds_read_b128 v[76:79], v2 offset:3072
    s_waitcnt lgkmcnt(14)
    v_mfma_f32_16x16x32_bf16 v[128:131], a[0:3], v[16:19], 0
    ds_read_b64_tr_b16 a[28:29], v13 offset:8704
    v_mfma_f32_16x16x32_bf16 v[156:159], a[0:3], v[72:75], 0
    ds_read_b64_tr_b16 a[30:31], v13 offset:9792
    v_mfma_f32_16x16x32_bf16 v[224:227], a[0:3], v[188:191], 0
    s_waitcnt lgkmcnt(14)
    v_mfma_f32_16x16x32_bf16 v[132:135], a[4:7], v[16:19], 0
    ds_read_b64_tr_b16 a[32:33], v13 offset:8712
    v_mfma_f32_16x16x32_bf16 v[160:163], a[4:7], v[72:75], 0
    ds_read_b64_tr_b16 a[34:35], v13 offset:9800
    s_waitcnt lgkmcnt(4)
    s_lshl_b32 s67, s60, 7
    s_add_u32 s60, s60, 1
    s_cmp_eq_u32 s60, 7
    s_cselect_b32 s60, 0, s60
    s_add_u32 m0, s42, 0
    s_nop 0
    buffer_load_dwordx4 v10, s[44:47], s67 offen offset:0 lds
    v_mfma_f32_16x16x32_bf16 v[228:231], a[4:7], v[188:191], 0
    v_mfma_f32_16x16x32_bf16 v[136:139], a[8:11], v[16:19], 0
    ds_read_b64_tr_b16 a[36:37], v13 offset:8720
    v_mfma_f32_16x16x32_bf16 v[164:167], a[8:11], v[72:75], 0
    ds_read_b64_tr_b16 a[38:39], v13 offset:9808
    v_mfma_f32_16x16x32_bf16 v[232:235], a[8:11], v[188:191], 0
    v_mfma_f32_16x16x32_bf16 v[140:143], a[12:15], v[16:19], 0
    ds_read_b64_tr_b16 a[40:41], v13 offset:8728
    s_add_u32 m0, s42, 960
    s_nop 0
    buffer_load_dwordx4 v10, s[44:47], s67 offen offset:64 lds
    v_mfma_f32_16x16x32_bf16 v[168:171], a[12:15], v[72:75], 0
we_all_59:
wp_all_59:
    s_cmp_eq_u32 s43, 1
    s_cbranch_scc1 wr_0
    ds_read_b64_tr_b16 a[42:43], v13 offset:9816
    v_mfma_f32_16x16x32_bf16 v[236:239], a[12:15], v[188:191], 0
    v_mfma_f32_16x16x32_bf16 v[144:147], a[16:19], v[16:19], 0
    ds_read_b64_tr_b16 a[44:45], v13 offset:8736
    v_mfma_f32_16x16x32_bf16 v[172:175], a[16:19], v[72:75], 0
    ds_read_b64_tr_b16 a[46:47], v13 offset:9824
    s_add_u32 m0, s42, 2048
    s_nop 0
    buffer_load_dwordx4 v11, s[44:47], s67 offen offset:0 lds
    v_mfma_f32_16x16x32_bf16 v[240:243], a[16:19], v[188:191], 0
    v_mfma_f32_16x16x32_bf16 v[148:151], a[20:23], v[16:19], 0
    ds_read_b64_tr_b16 a[48:49], v13 offset:8744
    v_mfma_f32_16x16x32_bf16 v[176:179], a[20:23], v[72:75], 0
    ds_read_b64_tr_b16 a[50:51], v13 offset:9832
    v_mfma_f32_16x16x32_bf16 v[244:247], a[20:23], v[188:191], 0
    v_mfma_f32_16x16x32_bf16 v[152:155], a[24:27], v[16:19], 0
    ds_read_b64_tr_b16 a[52:53], v13 offset:8752
    s_add_u32 m0, s42, 3008
    s_nop 0
    buffer_load_dwordx4 v11, s[44:47], s67 offen offset:64 lds
    v_mfma_f32_16x16x32_bf16 v[180:183], a[24:27], v[72:75], 0
    ds_read_b64_tr_b16 a[54:55], v13 offset:9840
    v_mfma_f32_16x16x32_bf16 v[248:251], a[24:27], v[188:191], 0
    v_mfma_f32_16x16x32_bf16 v[204:207], v[188:191], v[16:19], 0
    v_mfma_f32_16x16x32_bf16 v[208:211], v[16:19], v[16:19], 0
    v_mfma_f32_16x16x32_bf16 v[212:215], v[188:191], v[72:75], 0
    v_mfma_f32_16x16x32_bf16 v[216:219], v[72:75], v[72:75], 0
    s_waitcnt lgkmcnt(12)
    v_mfma_f32_16x16x32_bf16 v[128:131], a[28:31], v[20:23], v[128:131]
    s_lshl_b32 s13, s14, 2
    s_mul_i32 s13, s13, s15
    s_add_u32 s13, s13, s68
    s_add_u32 s15, s15, 1
    s_cmp_eq_u32 s15, 7
    s_cselect_b32 s15, 0, s15
    s_add_u32 m0, s61, 34816
we_all_60:
wp_all_60:
    s_cmp_eq_u32 s43, 1
    s_cbranch_scc1 wr_0
    s_nop 0
    buffer_load_dwordx4 v12, s[48:51], s13 offen lds
    s_add_u32 s13, s13, s14
    v_mfma_f32_16x16x32_bf16 v[156:159], a[28:31], v[76:79], v[156:159]
    s_add_u32 m0, s61, 39168
    s_nop 0
    buffer_load_dwordx4 v12, s[48:51], s13 offen lds
    s_add_u32 s13, s13, s14
    v_mfma_f32_16x16x32_bf16 v[224:227], a[28:31], v[188:191], v[224:227]
    s_waitcnt lgkmcnt(10)
    v_mfma_f32_16x16x32_bf16 v[132:135], a[32:35], v[20:23], v[132:135]
    v_mfma_f32_16x16x32_bf16 v[160:163], a[32:35], v[76:79], v[160:163]
    v_mfma_f32_16x16x32_bf16 v[228:231], a[32:35], v[188:191], v[228:231]
    s_waitcnt lgkmcnt(8)
    v_mfma_f32_16x16x32_bf16 v[136:139], a[36:39], v[20:23], v[136:139]
    v_mfma_f32_16x16x32_bf16 v[164:167], a[36:39], v[76:79], v[164:167]
    s_add_u32 m0, s61, 43520
    s_nop 0
    buffer_load_dwordx4 v12, s[48:51], s13 offen lds
    s_add_u32 s13, s13, s14
    v_mfma_f32_16x16x32_bf16 v[232:235], a[36:39], v[188:191], v[232:235]
    s_waitcnt vmcnt(7)
    s_barrier
    s_waitcnt lgkmcnt(6)
    v_mfma_f32_16x16x32_bf16 v[140:143], a[40:43], v[20:23], v[140:143]
    ds_read_b128 v[24:27], v2 offset:4096
    ds_read_b128 v[80:83], v2 offset:6144
    ds_read_b64_tr_b16 a[0:1], v13 offset:17408
    v_mfma_f32_16x16x32_bf16 v[168:171], a[40:43], v[76:79], v[168:171]
    ds_read_b64_tr_b16 a[2:3], v13 offset:18496
    ds_read_b64_tr_b16 a[4:5], v13 offset:17416
    ds_read_b64_tr_b16 a[6:7], v13 offset:18504
    v_mfma_f32_16x16x32_bf16 v[236:239], a[40:43], v[188:191], v[236:239]
    s_waitcnt lgkmcnt(10)
    v_mfma_f32_16x16x32_bf16 v[144:147], a[44:47], v[20:23], v[144:147]
    ds_read_b64_tr_b16 a[8:9], v13 offset:17424
    ds_read_b64_tr_b16 a[10:11], v13 offset:18512
we_all_61:
wp_all_61:
    s_cmp_eq_u32 s43, 1
    s_cbranch_scc1 wr_0
    v_mfma_f32_16x16x32_bf16 v[172:175], a[44:47], v[76:79], v[172:175]
    ds_read_b64_tr_b16 a[12:13], v13 offset:17432
    ds_read_b64_tr_b16 a[14:15], v13 offset:18520
    s_add_u32 m0, s61, 47872
    s_nop 0
    buffer_load_dwordx4 v12, s[48:51], s13 offen lds
    v_mfma_f32_16x16x32_bf16 v[240:243], a[44:47], v[188:191], v[240:243]
    s_waitcnt lgkmcnt(12)
    v_mfma_f32_16x16x32_bf16 v[148:151], a[48:51], v[20:23], v[148:151]
    ds_read_b64_tr_b16 a[16:17], v13 offset:17440
    ds_read_b64_tr_b16 a[18:19], v13 offset:18528
    v_mfma_f32_16x16x32_bf16 v[176:179], a[48:51], v[76:79], v[176:179]
    ds_read_b64_tr_b16 a[20:21], v13 offset:17448
    ds_read_b64_tr_b16 a[22:23], v13 offset:18536
    v_mfma_f32_16x16x32_bf16 v[244:247], a[48:51], v[188:191], v[244:247]
    s_waitcnt lgkmcnt(14)
    v_mfma_f32_16x16x32_bf16 v[152:155], a[52:55], v[20:23], v[152:155]
    ds_read_b64_tr_b16 a[24:25], v13 offset:17456
    ds_read_b64_tr_b16 a[26:27], v13 offset:18544
    v_mfma_f32_16x16x32_bf16 v[180:183], a[52:55], v[76:79], v[180:183]
    ds_read_b128 v[28:31], v2 offset:5120
    ds_read_b128 v[84:87], v2 offset:7168
    v_mfma_f32_16x16x32_bf16 v[248:251], a[52:55], v[188:191], v[248:251]
    v_mfma_f32_16x16x32_bf16 v[204:207], v[188:191], v[20:23], v[204:207]
    v_mfma_f32_16x16x32_bf16 v[208:211], v[20:23], v[20:23], v[208:211]
    v_mfma_f32_16x16x32_bf16 v[212:215], v[188:191], v[76:79], v[212:215]
    v_mfma_f32_16x16x32_bf16 v[216:219], v[76:79], v[76:79], v[216:219]
    s_waitcnt lgkmcnt(14)
    v_mfma_f32_16x16x32_bf16 v[128:131], a[0:3], v[24:27], v[128:131]
    ds_read_b64_tr_b16 a[28:29], v13 offset:26112
    v_mfma_f32_16x16x32_bf16 v[156:159], a[0:3], v[80:83], v[156:159]
    ds_read_b64_tr_b16 a[30:31], v13 offset:27200
    v_mfma_f32_16x16x32_bf16 v[224:227], a[0:3], v[188:191], v[224:227]
we_all_62:
wp_all_62:
    s_cmp_eq_u32 s43, 1
    s_cbranch_scc1 wr_0
    s_waitcnt lgkmcnt(14)
    v_mfma_f32_16x16x32_bf16 v[132:135], a[4:7], v[24:27], v[132:135]
    ds_read_b64_tr_b16 a[32:33], v13 offset:26120
    v_mfma_f32_16x16x32_bf16 v[160:163], a[4:7], v[80:83], v[160:163]
    ds_read_b64_tr_b16 a[34:35], v13 offset:27208
    s_waitcnt lgkmcnt(4)
    s_lshl_b32 s67, s60, 7
    s_add_u32 s60, s60, 1
    s_cmp_eq_u32 s60, 7
    s_cselect_b32 s60, 0, s60
    s_add_u32 m0, s42, 4096
    s_nop 0
    buffer_load_dwordx4 v10, s[44:47], s67 offen offset:0 lds
    v_mfma_f32_16x16x32_bf16 v[228:231], a[4:7], v[188:191], v[228:231]
    v_mfma_f32_16x16x32_bf16 v[136:139], a[8:11], v[24:27], v[136:139]
    ds_read_b64_tr_b16 a[36:37], v13 offset:26128
    v_mfma_f32_16x16x32_bf16 v[164:167], a[8:11], v[80:83], v[164:167]
    ds_read_b64_tr_b16 a[38:39], v13 offset:27216
    v_mfma_f32_16x16x32_bf16 v[232:235], a[8:11], v[188:191], v[232:235]
    v_mfma_f32_16x16x32_bf16 v[140:143], a[12:15], v[24:27], v[140:143]
    ds_read_b64_tr_b16 a[40:41], v13 offset:26136
    s_add_u32 m0, s42, 5056
    s_nop 0
    buffer_load_dwordx4 v10, s[44:47], s67 offen offset:64 lds
    v_mfma_f32_16x16x32_bf16 v[168:171], a[12:15], v[80:83], v[168:171]
    ds_read_b64_tr_b16 a[42:43], v13 offset:27224
    v_mfma_f32_16x16x32_bf16 v[236:239], a[12:15], v[188:191], v[236:239]
    v_mfma_f32_16x16x32_bf16 v[144:147], a[16:19], v[24:27], v[144:147]
    ds_read_b64_tr_b16 a[44:45], v13 offset:26144
    v_mfma_f32_16x16x32_bf16 v[172:175], a[16:19], v[80:83], v[172:175]
    ds_read_b64_tr_b16 a[46:47], v13 offset:27232
    s_add_u32 m0, s42, 6144
    s_nop 0
    buffer_load_dwordx4 v11, s[44:47], s67 offen offset:0 lds
    v_mfma_f32_16x16x32_bf16 v[240:243], a[16:19], v[188:191], v[240:243]
we_all_63:
wp_all_63:
    s_cmp_eq_u32 s43, 1
    s_cbranch_scc1 wr_0
    v_mfma_f32_16x16x32_bf16 v[148:151], a[20:23], v[24:27], v[148:151]
    ds_read_b64_tr_b16 a[48:49], v13 offset:26152
    v_mfma_f32_16x16x32_bf16 v[176:179], a[20:23], v[80:83], v[176:179]
    ds_read_b64_tr_b16 a[50:51], v13 offset:27240
    v_mfma_f32_16x16x32_bf16 v[244:247], a[20:23], v[188:191], v[244:247]
    v_mfma_f32_16x16x32_bf16 v[152:155], a[24:27], v[24:27], v[152:155]
    ds_read_b64_tr_b16 a[52:53], v13 offset:26160
    s_add_u32 m0, s42, 7104
    s_nop 0
    buffer_load_dwordx4 v11, s[44:47], s67 offen offset:64 lds
    v_mfma_f32_16x16x32_bf16 v[180:183], a[24:27], v[80:83], v[180:183]
    ds_read_b64_tr_b16 a[54:55], v13 offset:27248
    v_mfma_f32_16x16x32_bf16 v[248:251], a[24:27], v[188:191], v[248:251]
    v_mfma_f32_16x16x32_bf16 v[204:207], v[188:191], v[24:27], v[204:207]
    v_mfma_f32_16x16x32_bf16 v[208:211], v[24:27], v[24:27], v[208:211]
    v_mfma_f32_16x16x32_bf16 v[212:215], v[188:191], v[80:83], v[212:215]
    v_mfma_f32_16x16x32_bf16 v[216:219], v[80:83], v[80:83], v[216:219]
    s_waitcnt lgkmcnt(12)
    v_mfma_f32_16x16x32_bf16 v[128:131], a[28:31], v[28:31], v[128:131]
    s_lshl_b32 s13, s14, 2
    s_mul_i32 s13, s13, s15
    s_add_u32 s13, s13, s68
    s_add_u32 s15, s15, 1
    s_cmp_eq_u32 s15, 7
    s_cselect_b32 s15, 0, s15
    s_add_u32 m0, s61, 52224
    s_nop 0
    buffer_load_dwordx4 v12, s[48:51], s13 offen lds
    s_add_u32 s13, s13, s14
    v_mfma_f32_16x16x32_bf16 v[156:159], a[28:31], v[84:87], v[156:159]
    s_add_u32 m0, s61, 56576
    s_nop 0
    buffer_load_dwordx4 v12, s[48:51], s13 offen lds
    s_add_u32 s13, s13, s14
    v_mfma_f32_16x16x32_bf16 v[224:227], a[28:31], v[188:191], v[224:227]
    s_waitcnt lgkmcnt(10)
    v_mfma_f32_16x16x32_bf16 v[132:135], a[32:35], v[28:31], v[132:135]
    v_mfma_f32_16x16x32_bf16 v[160:163], a[32:35], v[84:87], v[160:163]
we_all_64:
wp_all_64:
    s_cmp_eq_u32 s43, 1
    s_cbranch_scc1 wr_0
    v_mfma_f32_16x16x32_bf16 v[228:231], a[32:35], v[188:191], v[228:231]
    s_waitcnt lgkmcnt(8)
    v_mfma_f32_16x16x32_bf16 v[136:139], a[36:39], v[28:31], v[136:139]
    v_mfma_f32_16x16x32_bf16 v[164:167], a[36:39], v[84:87], v[164:167]
    s_add_u32 m0, s61, 60928
    s_nop 0
    buffer_load_dwordx4 v12, s[48:51], s13 offen lds
    s_add_u32 s13, s13, s14
    v_mfma_f32_16x16x32_bf16 v[232:235], a[36:39], v[188:191], v[232:235]
    s_waitcnt vmcnt(7)
    s_barrier
    s_waitcnt lgkmcnt(6)
    v_mfma_f32_16x16x32_bf16 v[140:143], a[40:43], v[28:31], v[140:143]
    ds_read_b128 v[32:35], v2 offset:0
    ds_read_b128 v[88:91], v2 offset:2048
    ds_read_b64_tr_b16 a[0:1], v13 offset:34816
    v_mfma_f32_16x16x32_bf16 v[168:171], a[40:43], v[84:87], v[168:171]
    ds_read_b64_tr_b16 a[2:3], v13 offset:35904
    ds_read_b64_tr_b16 a[4:5], v13 offset:34824
    ds_read_b64_tr_b16 a[6:7], v13 offset:35912
    v_mfma_f32_16x16x32_bf16 v[236:239], a[40:43], v[188:191], v[236:239]
    s_waitcnt lgkmcnt(10)
    v_mfma_f32_16x16x32_bf16 v[144:147], a[44:47], v[28:31], v[144:147]
    ds_read_b64_tr_b16 a[8:9], v13 offset:34832
    ds_read_b64_tr_b16 a[10:11], v13 offset:35920
    v_mfma_f32_16x16x32_bf16 v[172:175], a[44:47], v[84:87], v[172:175]
    ds_read_b64_tr_b16 a[12:13], v13 offset:34840
    ds_read_b64_tr_b16 a[14:15], v13 offset:35928
    s_add_u32 m0, s61, 65280
    s_nop 0
    buffer_load_dwordx4 v12, s[48:51], s13 offen lds
    v_mfma_f32_16x16x32_bf16 v[240:243], a[44:47], v[188:191], v[240:243]
    s_waitcnt lgkmcnt(12)
    v_mfma_f32_16x16x32_bf16 v[148:151], a[48:51], v[28:31], v[148:151]
    ds_read_b64_tr_b16 a[16:17], v13 offset:34848
we_all_65:
wp_all_65:
    s_cmp_eq_u32 s43, 1
    s_cbranch_scc1 wr_0
    ds_read_b64_tr_b16 a[18:19], v13 offset:35936
    v_mfma_f32_16x16x32_bf16 v[176:179], a[48:51], v[84:87], v[176:179]
    ds_read_b64_tr_b16 a[20:21], v13 offset:34856
    ds_read_b64_tr_b16 a[22:23], v13 offset:35944
    v_mfma_f32_16x16x32_bf16 v[244:247], a[48:51], v[188:191], v[244:247]
    s_waitcnt lgkmcnt(14)
    v_mfma_f32_16x16x32_bf16 v[152:155], a[52:55], v[28:31], v[152:155]
    ds_read_b64_tr_b16 a[24:25], v13 offset:34864
    ds_read_b64_tr_b16 a[26:27], v13 offset:35952
    v_mfma_f32_16x16x32_bf16 v[180:183], a[52:55], v[84:87], v[180:183]
    ds_read_b128 v[36:39], v2 offset:1024
    ds_read_b128 v[92:95], v2 offset:3072
    v_mfma_f32_16x16x32_bf16 v[248:251], a[52:55], v[188:191], v[248:251]
    v_mfma_f32_16x16x32_bf16 v[204:207], v[188:191], v[28:31], v[204:207]
    v_mfma_f32_16x16x32_bf16 v[208:211], v[28:31], v[28:31], v[208:211]
    v_mfma_f32_16x16x32_bf16 v[212:215], v[188:191], v[84:87], v[212:215]
    v_mfma_f32_16x16x32_bf16 v[216:219], v[84:87], v[84:87], v[216:219]
    s_waitcnt lgkmcnt(14)
    v_mfma_f32_16x16x32_bf16 v[128:131], a[0:3], v[32:35], v[128:131]
    ds_read_b64_tr_b16 a[28:29], v13 offset:43520
    s_waitcnt lgkmcnt(1)
    s_lshl_b32 s67, s60, 7
    s_add_u32 s60, s60, 1
    s_cmp_eq_u32 s60, 7
    s_cselect_b32 s60, 0, s60
    s_add_u32 m0, s42, 0
    s_nop 0
    buffer_load_dwordx4 v10, s[44:47], s67 offen offset:0 lds
    v_mfma_f32_16x16x32_bf16 v[156:159], a[0:3], v[88:91], v[156:159]
    ds_read_b64_tr_b16 a[30:31], v13 offset:44608
    s_add_u32 m0, s42, 960
    s_nop 0
    buffer_load_dwordx4 v10, s[44:47], s67 offen offset:64 lds
    v_mfma_f32_16x16x32_bf16 v[224:227], a[0:3], v[188:191], v[224:227]
    v_mfma_f32_16x16x32_bf16 v[132:135], a[4:7], v[32:35], v[132:135]
    ds_read_b64_tr_b16 a[32:33], v13 offset:43528
we_all_66:
wp_all_66:
    s_cmp_eq_u32 s43, 1
    s_cbranch_scc1 wr_0
    v_mfma_f32_16x16x32_bf16 v[160:163], a[4:7], v[88:91], v[160:163]
    ds_read_b64_tr_b16 a[34:35], v13 offset:44616
    s_add_u32 m0, s42, 2048
    s_nop 0
    buffer_load_dwordx4 v11, s[44:47], s67 offen offset:0 lds
    v_mfma_f32_16x16x32_bf16 v[228:231], a[4:7], v[188:191], v[228:231]
    v_mfma_f32_16x16x32_bf16 v[136:139], a[8:11], v[32:35], v[136:139]
    ds_read_b64_tr_b16 a[36:37], v13 offset:43536
    v_mfma_f32_16x16x32_bf16 v[164:167], a[8:11], v[88:91], v[164:167]
    ds_read_b64_tr_b16 a[38:39], v13 offset:44624
    s_add_u32 m0, s42, 3008
    s_nop 0
    buffer_load_dwordx4 v11, s[44:47], s67 offen offset:64 lds
    v_mfma_f32_16x16x32_bf16 v[232:235], a[8:11], v[188:191], v[232:235]
    v_mfma_f32_16x16x32_bf16 v[140:143], a[12:15], v[32:35], v[140:143]
    ds_read_b64_tr_b16 a[40:41], v13 offset:43544
    v_mfma_f32_16x16x32_bf16 v[168:171], a[12:15], v[88:91], v[168:171]
    ds_read_b64_tr_b16 a[42:43], v13 offset:44632
    s_lshl_b32 s67, s60, 7
    s_add_u32 s60, s60, 1
    s_cmp_eq_u32 s60, 7
    s_cselect_b32 s60, 0, s60
    s_add_u32 m0, s28, 0
    s_nop 0
    buffer_load_dwordx4 v10, s[44:47], s67 offen offset:0 lds
    v_mfma_f32_16x16x32_bf16 v[236:239], a[12:15], v[188:191], v[236:239]
    v_mfma_f32_16x16x32_bf16 v[144:147], a[16:19], v[32:35], v[144:147]
    ds_read_b64_tr_b16 a[44:45], v13 offset:43552
    v_mfma_f32_16x16x32_bf16 v[172:175], a[16:19], v[88:91], v[172:175]
    ds_read_b64_tr_b16 a[46:47], v13 offset:44640
    s_add_u32 m0, s28, 960
    s_nop 0
    buffer_load_dwordx4 v10, s[44:47], s67 offen offset:64 lds
    v_mfma_f32_16x16x32_bf16 v[240:243], a[16:19], v[188:191], v[240:243]
    v_mfma_f32_16x16x32_bf16 v[148:151], a[20:23], v[32:35], v[148:151]
    ds_read_b64_tr_b16 a[48:49], v13 offset:43560
we_all_67:
wp_all_67:
    s_cmp_eq_u32 s43, 1
    s_cbranch_scc1 wr_0
    s_add_u32 m0, s28, 2048
    s_nop 0
    buffer_load_dwordx4 v11, s[44:47], s67 offen offset:0 lds
    v_mfma_f32_16x16x32_bf16 v[176:179], a[20:23], v[88:91], v[176:179]
    ds_read_b64_tr_b16 a[50:51], v13 offset:44648
    s_add_u32 m0, s28, 3008
    s_nop 0
    buffer_load_dwordx4 v11, s[44:47], s67 offen offset:64 lds
    v_mfma_f32_16x16x32_bf16 v[244:247], a[20:23], v[188:191], v[244:247]
    v_mfma_f32_16x16x32_bf16 v[152:155], a[24:27], v[32:35], v[152:155]
    ds_read_b64_tr_b16 a[52:53], v13 offset:43568
    v_mfma_f32_16x16x32_bf16 v[180:183], a[24:27], v[88:91], v[180:183]
    ds_read_b64_tr_b16 a[54:55], v13 offset:44656
    v_mfma_f32_16x16x32_bf16 v[248:251], a[24:27], v[188:191], v[248:251]
    v_mfma_f32_16x16x32_bf16 v[204:207], v[188:191], v[32:35], v[204:207]
    v_mfma_f32_16x16x32_bf16 v[208:211], v[32:35], v[32:35], v[208:211]
    v_mfma_f32_16x16x32_bf16 v[212:215], v[188:191], v[88:91], v[212:215]
    v_mfma_f32_16x16x32_bf16 v[216:219], v[88:91], v[88:91], v[216:219]
    s_waitcnt lgkmcnt(12)
    v_mfma_f32_16x16x32_bf16 v[128:131], a[28:31], v[36:39], v[128:131]
    s_lshl_b32 s13, s14, 2
    s_mul_i32 s13, s13, s15
    s_add_u32 s13, s13, s68
    s_add_u32 s15, s15, 1
    s_cmp_eq_u32 s15, 7
    s_cselect_b32 s15, 0, s15
    s_add_u32 m0, s61, 69632
    s_nop 0
    buffer_load_dwordx4 v12, s[48:51], s13 offen lds
    s_add_u32 s13, s13, s14
    v_mfma_f32_16x16x32_bf16 v[156:159], a[28:31], v[92:95], v[156:159]
    s_add_u32 m0, s61, 73984
    s_nop 0
    buffer_load_dwordx4 v12, s[48:51], s13 offen lds
    s_add_u32 s13, s13, s14
    v_mfma_f32_16x16x32_bf16 v[224:227], a[28:31], v[188:191], v[224:227]
    s_waitcnt lgkmcnt(10)
    v_mfma_f32_16x16x32_bf16 v[132:135], a[32:35], v[36:39], v[132:135]
we_all_68:
wp_all_68:
    s_cmp_eq_u32 s43, 1
    s_cbranch_scc1 wr_0
    v_mfma_f32_16x16x32_bf16 v[160:163], a[32:35], v[92:95], v[160:163]
    s_add_u32 m0, s61, 78336
    s_nop 0
    buffer_load_dwordx4 v12, s[48:51], s13 offen lds
    s_add_u32 s13, s13, s14
    v_mfma_f32_16x16x32_bf16 v[228:231], a[32:35], v[188:191], v[228:231]
    s_waitcnt lgkmcnt(8)
    v_mfma_f32_16x16x32_bf16 v[136:139], a[36:39], v[36:39], v[136:139]
    v_mfma_f32_16x16x32_bf16 v[164:167], a[36:39], v[92:95], v[164:167]
    s_add_u32 m0, s61, 82688
    s_nop 0
    buffer_load_dwordx4 v12, s[48:51], s13 offen lds
    v_mfma_f32_16x16x32_bf16 v[232:235], a[36:39], v[188:191], v[232:235]
    s_waitcnt vmcnt(12)
    s_barrier
    s_waitcnt lgkmcnt(6)
    v_mfma_f32_16x16x32_bf16 v[140:143], a[40:43], v[36:39], v[140:143]
    ds_read_b128 v[40:43], v2 offset:4096
    ds_read_b128 v[96:99], v2 offset:6144
    ds_read_b64_tr_b16 a[0:1], v13 offset:52224
    v_mfma_f32_16x16x32_bf16 v[168:171], a[40:43], v[92:95], v[168:171]
    ds_read_b64_tr_b16 a[2:3], v13 offset:53312
    ds_read_b64_tr_b16 a[4:5], v13 offset:52232
    ds_read_b64_tr_b16 a[6:7], v13 offset:53320
    s_lshl_b32 s13, s14, 2
    s_mul_i32 s13, s13, s15
    s_add_u32 s13, s13, s68
    s_add_u32 s15, s15, 1
    s_cmp_eq_u32 s15, 7
    s_cselect_b32 s15, 0, s15
    s_add_u32 m0, s61, 87040
    s_nop 0
    buffer_load_dwordx4 v12, s[48:51], s13 offen lds
    s_add_u32 s13, s13, s14
    v_mfma_f32_16x16x32_bf16 v[236:239], a[40:43], v[188:191], v[236:239]
    s_waitcnt lgkmcnt(10)
    v_mfma_f32_16x16x32_bf16 v[144:147], a[44:47], v[36:39], v[144:147]
    ds_read_b64_tr_b16 a[8:9], v13 offset:52240
    ds_read_b64_tr_b16 a[10:11], v13 offset:53328
we_all_69:
wp_all_69:
    s_cmp_eq_u32 s43, 1
    s_cbranch_scc1 wr_0
    v_mfma_f32_16x16x32_bf16 v[172:175], a[44:47], v[92:95], v[172:175]
    ds_read_b64_tr_b16 a[12:13], v13 offset:52248
    ds_read_b64_tr_b16 a[14:15], v13 offset:53336
    s_add_u32 m0, s61, 91392
    s_nop 0
    buffer_load_dwordx4 v12, s[48:51], s13 offen lds
    s_add_u32 s13, s13, s14
    v_mfma_f32_16x16x32_bf16 v[240:243], a[44:47], v[188:191], v[240:243]
    s_waitcnt lgkmcnt(12)
    v_mfma_f32_16x16x32_bf16 v[148:151], a[48:51], v[36:39], v[148:151]
    ds_read_b64_tr_b16 a[16:17], v13 offset:52256
    ds_read_b64_tr_b16 a[18:19], v13 offset:53344
    s_add_u32 m0, s61, 95744
    s_nop 0
    buffer_load_dwordx4 v12, s[48:51], s13 offen lds
    s_add_u32 s13, s13, s14
    v_mfma_f32_16x16x32_bf16 v[176:179], a[48:51], v[92:95], v[176:179]
    ds_read_b64_tr_b16 a[20:21], v13 offset:52264
    ds_read_b64_tr_b16 a[22:23], v13 offset:53352
    s_add_u32 m0, s61, 100096
    s_nop 0
    buffer_load_dwordx4 v12, s[48:51], s13 offen lds
    v_mfma_f32_16x16x32_bf16 v[244:247], a[48:51], v[188:191], v[244:247]
    s_waitcnt lgkmcnt(14)
    v_mfma_f32_16x16x32_bf16 v[152:155], a[52:55], v[36:39], v[152:155]
    ds_read_b64_tr_b16 a[24:25], v13 offset:52272
    ds_read_b64_tr_b16 a[26:27], v13 offset:53360
    v_mfma_f32_16x16x32_bf16 v[180:183], a[52:55], v[92:95], v[180:183]
    ds_read_b128 v[44:47], v2 offset:5120
    ds_read_b128 v[100:103], v2 offset:7168
    v_mfma_f32_16x16x32_bf16 v[248:251], a[52:55], v[188:191], v[248:251]
    v_mfma_f32_16x16x32_bf16 v[204:207], v[188:191], v[36:39], v[204:207]
    v_mfma_f32_16x16x32_bf16 v[208:211], v[36:39], v[36:39], v[208:211]
    v_mfma_f32_16x16x32_bf16 v[212:215], v[188:191], v[92:95], v[212:215]
we_all_70:
wp_all_70:
    s_cmp_eq_u32 s43, 1
    s_cbranch_scc1 wr_0
    v_mfma_f32_16x16x32_bf16 v[216:219], v[92:95], v[92:95], v[216:219]
    s_waitcnt lgkmcnt(14)
    v_mfma_f32_16x16x32_bf16 v[128:131], a[0:3], v[40:43], v[128:131]
    ds_read_b64_tr_b16 a[28:29], v14 offset:0
    s_lshl_b32 s67, s60, 7
    s_add_u32 s60, s60, 1
    s_cmp_eq_u32 s60, 7
    s_cselect_b32 s60, 0, s60
    s_add_u32 m0, s28, 17408
    s_nop 0
    buffer_load_dwordx4 v10, s[44:47], s67 offen offset:0 lds
    v_mfma_f32_16x16x32_bf16 v[156:159], a[0:3], v[96:99], v[156:159]
    ds_read_b64_tr_b16 a[30:31], v14 offset:1088
    s_add_u32 m0, s28, 18368
    s_nop 0
    buffer_load_dwordx4 v10, s[44:47], s67 offen offset:64 lds
    v_mfma_f32_16x16x32_bf16 v[224:227], a[0:3], v[188:191], v[224:227]
    s_waitcnt lgkmcnt(14)
    v_mfma_f32_16x16x32_bf16 v[132:135], a[4:7], v[40:43], v[132:135]
    ds_read_b64_tr_b16 a[32:33], v14 offset:8
    v_mfma_f32_16x16x32_bf16 v[160:163], a[4:7], v[96:99], v[160:163]
    ds_read_b64_tr_b16 a[34:35], v14 offset:1096
    s_add_u32 m0, s28, 19456
    s_nop 0
    buffer_load_dwordx4 v11, s[44:47], s67 offen offset:0 lds
    v_mfma_f32_16x16x32_bf16 v[228:231], a[4:7], v[188:191], v[228:231]
    s_waitcnt lgkmcnt(14)
    v_mfma_f32_16x16x32_bf16 v[136:139], a[8:11], v[40:43], v[136:139]
    ds_read_b64_tr_b16 a[36:37], v14 offset:16
    v_mfma_f32_16x16x32_bf16 v[164:167], a[8:11], v[96:99], v[164:167]
    ds_read_b64_tr_b16 a[38:39], v14 offset:1104
    s_add_u32 m0, s28, 20416
    s_nop 0
    buffer_load_dwordx4 v11, s[44:47], s67 offen offset:64 lds
    v_mfma_f32_16x16x32_bf16 v[232:235], a[8:11], v[188:191], v[232:235]
    s_waitcnt lgkmcnt(14)
    v_mfma_f32_16x16x32_bf16 v[140:143], a[12:15], v[40:43], v[140:143]
we_all_71:
wp_all_71:
    s_cmp_eq_u32 s43, 1
    s_cbranch_scc1 wr_0
    ds_read_b64_tr_b16 a[40:41], v14 offset:24
    v_mfma_f32_16x16x32_bf16 v[168:171], a[12:15], v[96:99], v[168:171]
    ds_read_b64_tr_b16 a[42:43], v14 offset:1112
    s_lshl_b32 s13, s14, 2
    s_mul_i32 s13, s13, s15
    s_add_u32 s13, s13, s68
    s_add_u32 s15, s15, 1
    s_cmp_eq_u32 s15, 7
    s_cselect_b32 s15, 0, s15
    s_add_u32 m0, s61, 104448
    s_nop 0
    buffer_load_dwordx4 v12, s[48:51], s13 offen lds
    s_add_u32 s13, s13, s14
    v_mfma_f32_16x16x32_bf16 v[236:239], a[12:15], v[188:191], v[236:239]
    s_waitcnt lgkmcnt(14)
    v_mfma_f32_16x16x32_bf16 v[144:147], a[16:19], v[40:43], v[144:147]
    ds_read_b64_tr_b16 a[44:45], v14 offset:32
    v_mfma_f32_16x16x32_bf16 v[172:175], a[16:19], v[96:99], v[172:175]
    ds_read_b64_tr_b16 a[46:47], v14 offset:1120
    s_add_u32 m0, s61, 108800
    s_nop 0
    buffer_load_dwordx4 v12, s[48:51], s13 offen lds
    s_add_u32 s13, s13, s14
    v_mfma_f32_16x16x32_bf16 v[240:243], a[16:19], v[188:191], v[240:243]
    s_waitcnt lgkmcnt(14)
    v_mfma_f32_16x16x32_bf16 v[148:151], a[20:23], v[40:43], v[148:151]
    ds_read_b64_tr_b16 a[48:49], v14 offset:40
    s_add_u32 m0, s61, 113152
    s_nop 0
    buffer_load_dwordx4 v12, s[48:51], s13 offen lds
    s_add_u32 s13, s13, s14
    v_mfma_f32_16x16x32_bf16 v[176:179], a[20:23], v[96:99], v[176:179]
    ds_read_b64_tr_b16 a[50:51], v14 offset:1128
    s_add_u32 m0, s61, 117504
    s_nop 0
    buffer_load_dwordx4 v12, s[48:51], s13 offen lds
    v_mfma_f32_16x16x32_bf16 v[244:247], a[20:23], v[188:191], v[244:247]
    s_waitcnt lgkmcnt(14)
    v_mfma_f32_16x16x32_bf16 v[152:155], a[24:27], v[40:43], v[152:155]
we_all_72:
wp_all_72:
    s_cmp_eq_u32 s43, 1
    s_cbranch_scc1 wr_0
    ds_read_b64_tr_b16 a[52:53], v14 offset:48
    v_mfma_f32_16x16x32_bf16 v[180:183], a[24:27], v[96:99], v[180:183]
    ds_read_b64_tr_b16 a[54:55], v14 offset:1136
    v_mfma_f32_16x16x32_bf16 v[248:251], a[24:27], v[188:191], v[248:251]
    v_mfma_f32_16x16x32_bf16 v[204:207], v[188:191], v[40:43], v[204:207]
    v_mfma_f32_16x16x32_bf16 v[208:211], v[40:43], v[40:43], v[208:211]
    v_mfma_f32_16x16x32_bf16 v[212:215], v[188:191], v[96:99], v[212:215]
    v_mfma_f32_16x16x32_bf16 v[216:219], v[96:99], v[96:99], v[216:219]
    s_waitcnt lgkmcnt(12)
    v_mfma_f32_16x16x32_bf16 v[128:131], a[28:31], v[44:47], v[128:131]
    s_add_u32 m0, s42, 4096
    s_nop 0
    buffer_load_dwordx4 v200, s[88:91], s16 offen lds
    s_add_u32 s16, s16, s17
    v_mfma_f32_16x16x32_bf16 v[156:159], a[28:31], v[100:103], v[156:159]
    s_add_u32 m0, s42, 5120
    s_nop 0
    buffer_load_dwordx4 v200, s[88:91], s16 offen lds
    s_add_u32 s16, s16, s17
    v_mfma_f32_16x16x32_bf16 v[224:227], a[28:31], v[188:191], v[224:227]
    s_waitcnt lgkmcnt(10)
    v_mfma_f32_16x16x32_bf16 v[132:135], a[32:35], v[44:47], v[132:135]
    v_mfma_f32_16x16x32_bf16 v[160:163], a[32:35], v[100:103], v[160:163]
    v_mfma_f32_16x16x32_bf16 v[228:231], a[32:35], v[188:191], v[228:231]
    s_waitcnt lgkmcnt(8)
    v_mfma_f32_16x16x32_bf16 v[136:139], a[36:39], v[44:47], v[136:139]
    v_mfma_f32_16x16x32_bf16 v[164:167], a[36:39], v[100:103], v[164:167]
    s_add_u32 m0, s42, 6144
    s_nop 0
    buffer_load_dwordx4 v200, s[88:91], s16 offen lds
    s_add_u32 s16, s16, s17
    v_mfma_f32_16x16x32_bf16 v[232:235], a[36:39], v[188:191], v[232:235]
    s_waitcnt vmcnt(15)
    s_barrier
    s_waitcnt lgkmcnt(6)
    v_mfma_f32_16x16x32_bf16 v[140:143], a[40:43], v[44:47], v[140:143]
    ds_read_b128 v[48:51], v2 offset:0
we_all_73:
wp_all_73:
    s_cmp_eq_u32 s43, 1
    s_cbranch_scc1 wr_0
    ds_read_b128 v[104:107], v2 offset:2048
    ds_read_b64_tr_b16 a[0:1], v14 offset:8704
    v_mfma_f32_16x16x32_bf16 v[168:171], a[40:43], v[100:103], v[168:171]
    ds_read_b64_tr_b16 a[2:3], v14 offset:9792
    ds_read_b64_tr_b16 a[4:5], v14 offset:8712
    ds_read_b64_tr_b16 a[6:7], v14 offset:9800
    v_mfma_f32_16x16x32_bf16 v[236:239], a[40:43], v[188:191], v[236:239]
    s_waitcnt lgkmcnt(10)
    v_mfma_f32_16x16x32_bf16 v[144:147], a[44:47], v[44:47], v[144:147]
    ds_read_b64_tr_b16 a[8:9], v14 offset:8720
    ds_read_b64_tr_b16 a[10:11], v14 offset:9808
    v_mfma_f32_16x16x32_bf16 v[172:175], a[44:47], v[100:103], v[172:175]
    ds_read_b64_tr_b16 a[12:13], v14 offset:8728
    ds_read_b64_tr_b16 a[14:15], v14 offset:9816
    s_add_u32 m0, s42, 7168
    s_nop 0
    buffer_load_dwordx4 v200, s[88:91], s16 offen lds
    v_mfma_f32_16x16x32_bf16 v[240:243], a[44:47], v[188:191], v[240:243]
    s_waitcnt lgkmcnt(12)
    v_mfma_f32_16x16x32_bf16 v[148:151], a[48:51], v[44:47], v[148:151]
    ds_read_b64_tr_b16 a[16:17], v14 offset:8736
    ds_read_b64_tr_b16 a[18:19], v14 offset:9824
    v_mfma_f32_16x16x32_bf16 v[176:179], a[48:51], v[100:103], v[176:179]
    ds_read_b64_tr_b16 a[20:21], v14 offset:8744
    ds_read_b64_tr_b16 a[22:23], v14 offset:9832
    s_lshl_b32 s100, s2, 12
    s_add_u32 s100, s100, 0x1500000
    v_mov_b32 v8, s3
    v_lshlrev_b32 v8, 10, v8
    v_mov_b32 v196, 0
    v_mov_b32 v197, 0
    v_mov_b32 v198, 0
    v_mov_b32 v199, 0
    buffer_store_dwordx4 v[196:199], v8, s[92:95], s100 offen sc1
    v_mfma_f32_16x16x32_bf16 v[244:247], a[48:51], v[188:191], v[244:247]
    s_waitcnt lgkmcnt(14)
    v_mfma_f32_16x16x32_bf16 v[152:155], a[52:55], v[44:47], v[152:155]
we_all_74:
wp_all_74:
    s_cmp_eq_u32 s43, 1
    s_cbranch_scc1 wr_0
    ds_read_b64_tr_b16 a[24:25], v14 offset:8752
    ds_read_b64_tr_b16 a[26:27], v14 offset:9840
    v_mfma_f32_16x16x32_bf16 v[180:183], a[52:55], v[100:103], v[180:183]
    ds_read_b128 v[52:55], v2 offset:1024
    ds_read_b128 v[108:111], v2 offset:3072
    v_mfma_f32_16x16x32_bf16 v[248:251], a[52:55], v[188:191], v[248:251]
    v_mfma_f32_16x16x32_bf16 v[204:207], v[188:191], v[44:47], v[204:207]
    v_mfma_f32_16x16x32_bf16 v[208:211], v[44:47], v[44:47], v[208:211]
    v_mfma_f32_16x16x32_bf16 v[212:215], v[188:191], v[100:103], v[212:215]
    v_mfma_f32_16x16x32_bf16 v[216:219], v[100:103], v[100:103], v[216:219]
    s_waitcnt lgkmcnt(14)
    v_mfma_f32_16x16x32_bf16 v[128:131], a[0:3], v[48:51], v[128:131]
    ds_read_b64_tr_b16 a[28:29], v14 offset:17408
    v_mfma_f32_16x16x32_bf16 v[156:159], a[0:3], v[104:107], v[156:159]
    ds_read_b64_tr_b16 a[30:31], v14 offset:18496
    v_mfma_f32_16x16x32_bf16 v[224:227], a[0:3], v[188:191], v[224:227]
    s_waitcnt lgkmcnt(14)
    v_mfma_f32_16x16x32_bf16 v[132:135], a[4:7], v[48:51], v[132:135]
    ds_read_b64_tr_b16 a[32:33], v14 offset:17416
    v_mfma_f32_16x16x32_bf16 v[160:163], a[4:7], v[104:107], v[160:163]
    ds_read_b64_tr_b16 a[34:35], v14 offset:18504
    s_add_u32 s36, s40, 0x900000
    s_addc_u32 s37, s41, 0
    s_mov_b32 s38, 0x200000
    s_mov_b32 s39, 0x20000
    s_lshl_b32 s101, s2, 2
    s_add_u32 s101, s101, s3
    s_mul_i32 s101, s101, 2048
    v_lshlrev_b32 v192, 4, v1
    v_add_u32 v192, s101, v192
    v_add_u32 v193, 4096, v192
    v_add_u32 v194, 8192, v192
    v_mov_b32 v195, -1
    v_accvgpr_write_b32 a240, v195
    v_accvgpr_write_b32 a241, v195
we_all_75:
wp_all_75:
    s_cmp_eq_u32 s43, 1
    s_cbranch_scc1 wr_0
    v_accvgpr_write_b32 a242, v195
    v_accvgpr_write_b32 a243, v195
    buffer_store_dwordx4 a[240:243], v192, s[36:39], 0 offen offset:0 sc1
    v_mfma_f32_16x16x32_bf16 v[228:231], a[4:7], v[188:191], v[228:231]
    s_waitcnt lgkmcnt(14)
    v_mfma_f32_16x16x32_bf16 v[136:139], a[8:11], v[48:51], v[136:139]
    ds_read_b64_tr_b16 a[36:37], v14 offset:17424
    v_mfma_f32_16x16x32_bf16 v[164:167], a[8:11], v[104:107], v[164:167]
    ds_read_b64_tr_b16 a[38:39], v14 offset:18512
    v_mfma_f32_16x16x32_bf16 v[232:235], a[8:11], v[188:191], v[232:235]
    s_waitcnt lgkmcnt(14)
    v_mfma_f32_16x16x32_bf16 v[140:143], a[12:15], v[48:51], v[140:143]
    ds_read_b64_tr_b16 a[40:41], v14 offset:17432
    v_mfma_f32_16x16x32_bf16 v[168:171], a[12:15], v[104:107], v[168:171]
    ds_read_b64_tr_b16 a[42:43], v14 offset:18520
    v_mfma_f32_16x16x32_bf16 v[236:239], a[12:15], v[188:191], v[236:239]
    s_waitcnt lgkmcnt(14)
    v_mfma_f32_16x16x32_bf16 v[144:147], a[16:19], v[48:51], v[144:147]
    ds_read_b64_tr_b16 a[44:45], v14 offset:17440
    v_mfma_f32_16x16x32_bf16 v[172:175], a[16:19], v[104:107], v[172:175]
    ds_read_b64_tr_b16 a[46:47], v14 offset:18528
    v_mfma_f32_16x16x32_bf16 v[240:243], a[16:19], v[188:191], v[240:243]
    s_waitcnt lgkmcnt(14)
    v_mfma_f32_16x16x32_bf16 v[148:151], a[20:23], v[48:51], v[148:151]
    ds_read_b64_tr_b16 a[48:49], v14 offset:17448
    v_mfma_f32_16x16x32_bf16 v[176:179], a[20:23], v[104:107], v[176:179]
    ds_read_b64_tr_b16 a[50:51], v14 offset:18536
    v_mfma_f32_16x16x32_bf16 v[244:247], a[20:23], v[188:191], v[244:247]
    s_waitcnt lgkmcnt(14)
    v_mfma_f32_16x16x32_bf16 v[152:155], a[24:27], v[48:51], v[152:155]
    ds_read_b64_tr_b16 a[52:53], v14 offset:17456
    v_mfma_f32_16x16x32_bf16 v[180:183], a[24:27], v[104:107], v[180:183]
    ds_read_b64_tr_b16 a[54:55], v14 offset:18544
we_all_76:
wp_all_76:
    s_cmp_eq_u32 s43, 1
    s_cbranch_scc1 wr_0
    v_mfma_f32_16x16x32_bf16 v[248:251], a[24:27], v[188:191], v[248:251]
    v_mfma_f32_16x16x32_bf16 v[204:207], v[188:191], v[48:51], v[204:207]
    v_mfma_f32_16x16x32_bf16 v[208:211], v[48:51], v[48:51], v[208:211]
    v_mfma_f32_16x16x32_bf16 v[212:215], v[188:191], v[104:107], v[212:215]
    v_mfma_f32_16x16x32_bf16 v[216:219], v[104:107], v[104:107], v[216:219]
    s_waitcnt lgkmcnt(12)
    v_mfma_f32_16x16x32_bf16 v[128:131], a[28:31], v[52:55], v[128:131]
    buffer_store_dwordx4 a[240:243], v192, s[36:39], 0 offen offset:1024 sc1
    v_mfma_f32_16x16x32_bf16 v[156:159], a[28:31], v[108:111], v[156:159]
    v_mfma_f32_16x16x32_bf16 v[224:227], a[28:31], v[188:191], v[224:227]
    s_waitcnt lgkmcnt(10)
    v_mfma_f32_16x16x32_bf16 v[132:135], a[32:35], v[52:55], v[132:135]
    v_mfma_f32_16x16x32_bf16 v[160:163], a[32:35], v[108:111], v[160:163]
    v_mfma_f32_16x16x32_bf16 v[228:231], a[32:35], v[188:191], v[228:231]
    s_waitcnt lgkmcnt(8)
    v_mfma_f32_16x16x32_bf16 v[136:139], a[36:39], v[52:55], v[136:139]
    v_mfma_f32_16x16x32_bf16 v[164:167], a[36:39], v[108:111], v[164:167]
    v_mfma_f32_16x16x32_bf16 v[232:235], a[36:39], v[188:191], v[232:235]
    s_waitcnt vmcnt(15)
    s_barrier
    s_waitcnt lgkmcnt(6)
    v_mfma_f32_16x16x32_bf16 v[140:143], a[40:43], v[52:55], v[140:143]
    ds_read_b128 v[56:59], v202 offset:0
    ds_read_b128 v[112:115], v202 offset:2048
    ds_read_b64_tr_b16 a[0:1], v14 offset:26112
    v_mfma_f32_16x16x32_bf16 v[168:171], a[40:43], v[108:111], v[168:171]
    ds_read_b64_tr_b16 a[2:3], v14 offset:27200
    ds_read_b64_tr_b16 a[4:5], v14 offset:26120
    ds_read_b64_tr_b16 a[6:7], v14 offset:27208
    v_mfma_f32_16x16x32_bf16 v[236:239], a[40:43], v[188:191], v[236:239]
    s_waitcnt lgkmcnt(10)
    v_mfma_f32_16x16x32_bf16 v[144:147], a[44:47], v[52:55], v[144:147]
    ds_read_b64_tr_b16 a[8:9], v14 offset:26128
    ds_read_b64_tr_b16 a[10:11], v14 offset:27216
    v_mfma_f32_16x16x32_bf16 v[172:175], a[44:47], v[108:111], v[172:175]
we_all_77:
wp_all_77:
    s_cmp_eq_u32 s43, 1
    s_cbranch_scc1 wr_0
    ds_read_b64_tr_b16 a[12:13], v14 offset:26136
    ds_read_b64_tr_b16 a[14:15], v14 offset:27224
    v_mfma_f32_16x16x32_bf16 v[240:243], a[44:47], v[188:191], v[240:243]
    s_waitcnt lgkmcnt(12)
    v_mfma_f32_16x16x32_bf16 v[148:151], a[48:51], v[52:55], v[148:151]
    ds_read_b64_tr_b16 a[16:17], v14 offset:26144
    ds_read_b64_tr_b16 a[18:19], v14 offset:27232
    v_mfma_f32_16x16x32_bf16 v[176:179], a[48:51], v[108:111], v[176:179]
    ds_read_b64_tr_b16 a[20:21], v14 offset:26152
    ds_read_b64_tr_b16 a[22:23], v14 offset:27240
    v_mfma_f32_16x16x32_bf16 v[244:247], a[48:51], v[188:191], v[244:247]
    s_waitcnt lgkmcnt(14)
    v_mfma_f32_16x16x32_bf16 v[152:155], a[52:55], v[52:55], v[152:155]
    ds_read_b64_tr_b16 a[24:25], v14 offset:26160
    ds_read_b64_tr_b16 a[26:27], v14 offset:27248
    v_mfma_f32_16x16x32_bf16 v[180:183], a[52:55], v[108:111], v[180:183]
    ds_read_b128 v[60:63], v202 offset:1024
    ds_read_b128 v[116:119], v202 offset:3072
    v_mfma_f32_16x16x32_bf16 v[248:251], a[52:55], v[188:191], v[248:251]
    v_mfma_f32_16x16x32_bf16 v[204:207], v[188:191], v[52:55], v[204:207]
    v_mfma_f32_16x16x32_bf16 v[208:211], v[52:55], v[52:55], v[208:211]
    v_mfma_f32_16x16x32_bf16 v[212:215], v[188:191], v[108:111], v[212:215]
    v_mfma_f32_16x16x32_bf16 v[216:219], v[108:111], v[108:111], v[216:219]
    s_waitcnt lgkmcnt(14)
    v_mfma_f32_16x16x32_bf16 v[128:131], a[0:3], v[56:59], v[128:131]
    ds_read_b64_tr_b16 a[28:29], v14 offset:34816
    v_mfma_f32_16x16x32_bf16 v[156:159], a[0:3], v[112:115], v[156:159]
    ds_read_b64_tr_b16 a[30:31], v14 offset:35904
    v_mfma_f32_16x16x32_bf16 v[224:227], a[0:3], v[188:191], v[224:227]
    s_waitcnt lgkmcnt(14)
    v_mfma_f32_16x16x32_bf16 v[132:135], a[4:7], v[56:59], v[132:135]
    ds_read_b64_tr_b16 a[32:33], v14 offset:34824
    v_mfma_f32_16x16x32_bf16 v[160:163], a[4:7], v[112:115], v[160:163]
we_all_78:
wp_all_78:
    s_cmp_eq_u32 s43, 1
    s_cbranch_scc1 wr_0
    ds_read_b64_tr_b16 a[34:35], v14 offset:35912
    v_mfma_f32_16x16x32_bf16 v[228:231], a[4:7], v[188:191], v[228:231]
    s_waitcnt lgkmcnt(14)
    v_mfma_f32_16x16x32_bf16 v[136:139], a[8:11], v[56:59], v[136:139]
    ds_read_b64_tr_b16 a[36:37], v14 offset:34832
    v_mfma_f32_16x16x32_bf16 v[164:167], a[8:11], v[112:115], v[164:167]
    ds_read_b64_tr_b16 a[38:39], v14 offset:35920
    v_mfma_f32_16x16x32_bf16 v[232:235], a[8:11], v[188:191], v[232:235]
    s_waitcnt lgkmcnt(14)
    v_mfma_f32_16x16x32_bf16 v[140:143], a[12:15], v[56:59], v[140:143]
    ds_read_b64_tr_b16 a[40:41], v14 offset:34840
    v_mfma_f32_16x16x32_bf16 v[168:171], a[12:15], v[112:115], v[168:171]
    ds_read_b64_tr_b16 a[42:43], v14 offset:35928
    v_mfma_f32_16x16x32_bf16 v[236:239], a[12:15], v[188:191], v[236:239]
    s_waitcnt lgkmcnt(14)
    v_mfma_f32_16x16x32_bf16 v[144:147], a[16:19], v[56:59], v[144:147]
    ds_read_b64_tr_b16 a[44:45], v14 offset:34848
    v_mfma_f32_16x16x32_bf16 v[172:175], a[16:19], v[112:115], v[172:175]
    ds_read_b64_tr_b16 a[46:47], v14 offset:35936
    v_mfma_f32_16x16x32_bf16 v[240:243], a[16:19], v[188:191], v[240:243]
    s_waitcnt lgkmcnt(14)
    v_mfma_f32_16x16x32_bf16 v[148:151], a[20:23], v[56:59], v[148:151]
    ds_read_b64_tr_b16 a[48:49], v14 offset:34856
    v_mfma_f32_16x16x32_bf16 v[176:179], a[20:23], v[112:115], v[176:179]
    ds_read_b64_tr_b16 a[50:51], v14 offset:35944
    v_mfma_f32_16x16x32_bf16 v[244:247], a[20:23], v[188:191], v[244:247]
    s_waitcnt lgkmcnt(14)
    v_mfma_f32_16x16x32_bf16 v[152:155], a[24:27], v[56:59], v[152:155]
    ds_read_b64_tr_b16 a[52:53], v14 offset:34864
    v_mfma_f32_16x16x32_bf16 v[180:183], a[24:27], v[112:115], v[180:183]
    ds_read_b64_tr_b16 a[54:55], v14 offset:35952
    v_mfma_f32_16x16x32_bf16 v[248:251], a[24:27], v[188:191], v[248:251]
    v_mfma_f32_16x16x32_bf16 v[204:207], v[188:191], v[56:59], v[204:207]
we_all_79:
wp_all_79:
    s_cmp_eq_u32 s43, 1
    s_cbranch_scc1 wr_0
    v_mfma_f32_16x16x32_bf16 v[208:211], v[56:59], v[56:59], v[208:211]
    v_mfma_f32_16x16x32_bf16 v[212:215], v[188:191], v[112:115], v[212:215]
    v_mfma_f32_16x16x32_bf16 v[216:219], v[112:115], v[112:115], v[216:219]
    s_waitcnt lgkmcnt(12)
    v_mfma_f32_16x16x32_bf16 v[128:131], a[28:31], v[60:63], v[128:131]
    v_mfma_f32_16x16x32_bf16 v[156:159], a[28:31], v[116:119], v[156:159]
    v_mfma_f32_16x16x32_bf16 v[224:227], a[28:31], v[188:191], v[224:227]
    s_waitcnt lgkmcnt(10)
    v_mfma_f32_16x16x32_bf16 v[132:135], a[32:35], v[60:63], v[132:135]
    v_mfma_f32_16x16x32_bf16 v[160:163], a[32:35], v[116:119], v[160:163]
    v_mfma_f32_16x16x32_bf16 v[228:231], a[32:35], v[188:191], v[228:231]
    s_waitcnt lgkmcnt(8)
    v_mfma_f32_16x16x32_bf16 v[136:139], a[36:39], v[60:63], v[136:139]
    v_mfma_f32_16x16x32_bf16 v[164:167], a[36:39], v[116:119], v[164:167]
    v_mfma_f32_16x16x32_bf16 v[232:235], a[36:39], v[188:191], v[232:235]
    s_waitcnt vmcnt(7)
    s_barrier
    s_waitcnt lgkmcnt(6)
    v_mfma_f32_16x16x32_bf16 v[140:143], a[40:43], v[60:63], v[140:143]
    ds_read_b128 v[64:67], v202 offset:17408
    ds_read_b128 v[120:123], v202 offset:19456
    ds_read_b64_tr_b16 a[0:1], v14 offset:43520
    v_mfma_f32_16x16x32_bf16 v[168:171], a[40:43], v[116:119], v[168:171]
    ds_read_b64_tr_b16 a[2:3], v14 offset:44608
    ds_read_b64_tr_b16 a[4:5], v14 offset:43528
    ds_read_b64_tr_b16 a[6:7], v14 offset:44616
    v_mfma_f32_16x16x32_bf16 v[236:239], a[40:43], v[188:191], v[236:239]
    s_waitcnt lgkmcnt(10)
    v_mfma_f32_16x16x32_bf16 v[144:147], a[44:47], v[60:63], v[144:147]
    ds_read_b64_tr_b16 a[8:9], v14 offset:43536
    ds_read_b64_tr_b16 a[10:11], v14 offset:44624
    v_mfma_f32_16x16x32_bf16 v[172:175], a[44:47], v[116:119], v[172:175]
    ds_read_b64_tr_b16 a[12:13], v14 offset:43544
    ds_read_b64_tr_b16 a[14:15], v14 offset:44632
    v_mfma_f32_16x16x32_bf16 v[240:243], a[44:47], v[188:191], v[240:243]
we_all_80:
wp_all_80:
    s_cmp_eq_u32 s43, 1
    s_cbranch_scc1 wr_0
    s_waitcnt lgkmcnt(12)
    v_mfma_f32_16x16x32_bf16 v[148:151], a[48:51], v[60:63], v[148:151]
    ds_read_b64_tr_b16 a[16:17], v14 offset:43552
    ds_read_b64_tr_b16 a[18:19], v14 offset:44640
    v_mfma_f32_16x16x32_bf16 v[176:179], a[48:51], v[116:119], v[176:179]
    ds_read_b64_tr_b16 a[20:21], v14 offset:43560
    ds_read_b64_tr_b16 a[22:23], v14 offset:44648
    v_mfma_f32_16x16x32_bf16 v[244:247], a[48:51], v[188:191], v[244:247]
    s_waitcnt lgkmcnt(14)
    v_mfma_f32_16x16x32_bf16 v[152:155], a[52:55], v[60:63], v[152:155]
    ds_read_b64_tr_b16 a[24:25], v14 offset:43568
    ds_read_b64_tr_b16 a[26:27], v14 offset:44656
    v_mfma_f32_16x16x32_bf16 v[180:183], a[52:55], v[116:119], v[180:183]
    ds_read_b128 v[68:71], v202 offset:18432
    ds_read_b128 v[124:127], v202 offset:20480
    v_mfma_f32_16x16x32_bf16 v[248:251], a[52:55], v[188:191], v[248:251]
    v_mfma_f32_16x16x32_bf16 v[204:207], v[188:191], v[60:63], v[204:207]
    v_mfma_f32_16x16x32_bf16 v[208:211], v[60:63], v[60:63], v[208:211]
    v_mfma_f32_16x16x32_bf16 v[212:215], v[188:191], v[116:119], v[212:215]
    v_mfma_f32_16x16x32_bf16 v[216:219], v[116:119], v[116:119], v[216:219]
    s_waitcnt lgkmcnt(14)
    v_mfma_f32_16x16x32_bf16 v[128:131], a[0:3], v[64:67], v[128:131]
    ds_read_b64_tr_b16 a[28:29], v14 offset:52224
    v_mfma_f32_16x16x32_bf16 v[156:159], a[0:3], v[120:123], v[156:159]
    ds_read_b64_tr_b16 a[30:31], v14 offset:53312
    v_mfma_f32_16x16x32_bf16 v[224:227], a[0:3], v[188:191], v[224:227]
    s_waitcnt lgkmcnt(14)
    v_mfma_f32_16x16x32_bf16 v[132:135], a[4:7], v[64:67], v[132:135]
    ds_read_b64_tr_b16 a[32:33], v14 offset:52232
    v_mfma_f32_16x16x32_bf16 v[204:207], v[188:191], v[64:67], v[204:207]
    v_mfma_f32_16x16x32_bf16 v[208:211], v[64:67], v[64:67], v[208:211]
    v_mfma_f32_16x16x32_bf16 v[212:215], v[188:191], v[120:123], v[212:215]
    v_mfma_f32_16x16x32_bf16 v[216:219], v[120:123], v[120:123], v[216:219]
we_all_81:
wp_all_81:
    s_cmp_eq_u32 s43, 1
    s_cbranch_scc1 wr_0
    s_waitcnt lgkmcnt(4)
    v_mfma_f32_16x16x32_bf16 v[204:207], v[188:191], v[68:71], v[204:207]
    v_mfma_f32_16x16x32_bf16 v[208:211], v[68:71], v[68:71], v[208:211]
    s_waitcnt lgkmcnt(3)
    v_mfma_f32_16x16x32_bf16 v[212:215], v[188:191], v[124:127], v[212:215]
    v_mfma_f32_16x16x32_bf16 v[216:219], v[124:127], v[124:127], v[216:219]
    v_mfma_f32_16x16x32_bf16 v[160:163], a[4:7], v[120:123], v[160:163]
    ds_read_b64_tr_b16 a[34:35], v14 offset:53320
    v_mfma_f32_16x16x32_bf16 v[228:231], a[4:7], v[188:191], v[228:231]
    v_mfma_f32_16x16x32_bf16 v[136:139], a[8:11], v[64:67], v[136:139]
    ds_read_b64_tr_b16 a[36:37], v14 offset:52240
    v_mul_f32 v185, v208, v252
    v_mul_f32 v187, v216, v252
    v_fma_f32 v185, v209, v253, v185
    v_mfma_f32_16x16x32_bf16 v[164:167], a[8:11], v[120:123], v[164:167]
    ds_read_b64_tr_b16 a[38:39], v14 offset:53328
    v_mfma_f32_16x16x32_bf16 v[232:235], a[8:11], v[188:191], v[232:235]
    v_fma_f32 v187, v217, v253, v187
    v_fma_f32 v185, v210, v254, v185
    v_fma_f32 v187, v218, v254, v187
    v_mfma_f32_16x16x32_bf16 v[140:143], a[12:15], v[64:67], v[140:143]
    ds_read_b64_tr_b16 a[40:41], v14 offset:52248
    v_fma_f32 v185, v211, v255, v185
    v_fma_f32 v187, v219, v255, v187
    v_mul_f32 v184, 0x3b124925, v204
    v_mfma_f32_16x16x32_bf16 v[168:171], a[12:15], v[120:123], v[168:171]
    ds_read_b64_tr_b16 a[42:43], v14 offset:53336
    v_mfma_f32_16x16x32_bf16 v[236:239], a[12:15], v[188:191], v[236:239]
    v_mul_f32 v186, 0x3b124925, v212
    v_mov_b32 v16, v185
    v_mov_b32 v17, v187
    v_mfma_f32_16x16x32_bf16 v[144:147], a[16:19], v[64:67], v[144:147]
    ds_read_b64_tr_b16 a[44:45], v14 offset:52256
    v_permlane32_swap_b32 v16, v185
we_all_82:
wp_all_82:
    s_cmp_eq_u32 s43, 1
    s_cbranch_scc1 wr_0
    v_permlane32_swap_b32 v17, v187
    v_add_f32 v185, v185, v16
    v_mfma_f32_16x16x32_bf16 v[172:175], a[16:19], v[120:123], v[172:175]
    ds_read_b64_tr_b16 a[46:47], v14 offset:53344
    v_mfma_f32_16x16x32_bf16 v[240:243], a[16:19], v[188:191], v[240:243]
    v_add_f32 v187, v187, v17
    v_mov_b32 v16, v185
    v_mov_b32 v17, v187
    v_mfma_f32_16x16x32_bf16 v[148:151], a[20:23], v[64:67], v[148:151]
    ds_read_b64_tr_b16 a[48:49], v14 offset:52264
    v_permlane16_swap_b32 v16, v185
    v_permlane16_swap_b32 v17, v187
    v_add_f32 v185, v185, v16
    v_mfma_f32_16x16x32_bf16 v[176:179], a[20:23], v[120:123], v[176:179]
    ds_read_b64_tr_b16 a[50:51], v14 offset:53352
    v_mfma_f32_16x16x32_bf16 v[244:247], a[20:23], v[188:191], v[244:247]
    v_add_f32 v187, v187, v17
    v_mul_f32 v185, 0x3b124925, v185
    v_mul_f32 v187, 0x3b124925, v187
    v_mfma_f32_16x16x32_bf16 v[152:155], a[24:27], v[64:67], v[152:155]
    ds_read_b64_tr_b16 a[52:53], v14 offset:52272
    v_fma_f32 v185, -v184, v184, v185
    v_fma_f32 v187, -v186, v186, v187
    v_max_f32 v185, 0, v185
    v_mfma_f32_16x16x32_bf16 v[180:183], a[24:27], v[120:123], v[180:183]
    ds_read_b64_tr_b16 a[54:55], v14 offset:53360
    v_mfma_f32_16x16x32_bf16 v[248:251], a[24:27], v[188:191], v[248:251]
    v_max_f32 v187, 0, v187
    v_cvt_pk_bf16_f32 v185, v185, v185
    v_cvt_pk_bf16_f32 v187, v187, v187
    s_waitcnt lgkmcnt(12)
    v_mfma_f32_16x16x32_bf16 v[128:131], a[28:31], v[68:71], v[128:131]
    v_lshlrev_b32 v185, 16, v185
    v_lshlrev_b32 v187, 16, v187
    v_add_f32 v185, 0x3727c5ac, v185
    v_mfma_f32_16x16x32_bf16 v[156:159], a[28:31], v[124:127], v[156:159]
    v_mfma_f32_16x16x32_bf16 v[224:227], a[28:31], v[188:191], v[224:227]
    v_add_f32 v187, 0x3727c5ac, v187
we_all_83:
wp_all_83:
    s_cmp_eq_u32 s43, 1
    s_cbranch_scc1 wr_0
    v_cvt_pk_bf16_f32 v185, v185, v185
    v_cvt_pk_bf16_f32 v187, v187, v187
    s_waitcnt lgkmcnt(10)
    v_mfma_f32_16x16x32_bf16 v[132:135], a[32:35], v[68:71], v[132:135]
    v_lshlrev_b32 v185, 16, v185
    v_lshlrev_b32 v187, 16, v187
    v_sqrt_f32 v185, v185
    v_mfma_f32_16x16x32_bf16 v[160:163], a[32:35], v[124:127], v[160:163]
    v_mfma_f32_16x16x32_bf16 v[228:231], a[32:35], v[188:191], v[228:231]
    v_sqrt_f32 v187, v187
    v_cvt_pk_bf16_f32 v184, v184, v184
    v_cvt_pk_bf16_f32 v186, v186, v186
    s_waitcnt lgkmcnt(8)
    v_mfma_f32_16x16x32_bf16 v[136:139], a[36:39], v[68:71], v[136:139]
    v_lshlrev_b32 v184, 16, v184
    v_lshlrev_b32 v186, 16, v186
    v_cvt_pk_bf16_f32 v185, v185, v185
    v_mfma_f32_16x16x32_bf16 v[164:167], a[36:39], v[124:127], v[164:167]
    v_mfma_f32_16x16x32_bf16 v[232:235], a[36:39], v[188:191], v[232:235]
    v_cvt_pk_bf16_f32 v187, v187, v187
    v_lshlrev_b32 v32, 16, v185
    v_lshlrev_b32 v34, 16, v187
    s_waitcnt lgkmcnt(6)
    v_mfma_f32_16x16x32_bf16 v[140:143], a[40:43], v[68:71], v[140:143]
    v_rcp_f32 v18, v32
    v_rcp_f32 v19, v34
    v_mul_f32 v20, -1.0, v184
    v_mfma_f32_16x16x32_bf16 v[168:171], a[40:43], v[124:127], v[168:171]
    v_mfma_f32_16x16x32_bf16 v[236:239], a[40:43], v[188:191], v[236:239]
    v_mul_f32 v22, -1.0, v186
    v_mul_f32 v21, -1.0, v184
    v_mul_f32 v23, -1.0, v186
    s_waitcnt lgkmcnt(4)
    v_mfma_f32_16x16x32_bf16 v[144:147], a[44:47], v[68:71], v[144:147]
    v_lshlrev_b32 v33, 16, v185
    v_lshlrev_b32 v35, 16, v187
    v_mul_f32 v24, 0xc0135761, v18
    v_mfma_f32_16x16x32_bf16 v[172:175], a[44:47], v[124:127], v[172:175]
    v_mfma_f32_16x16x32_bf16 v[240:243], a[44:47], v[188:191], v[240:243]
    v_mul_f32 v26, 0xc0135761, v19
    v_mul_f32 v16, v18, v18
    v_mul_f32 v17, v19, v19
we_all_84:
wp_all_84:
    s_cmp_eq_u32 s43, 1
    s_cbranch_scc1 wr_0
    s_waitcnt lgkmcnt(2)
    v_mfma_f32_16x16x32_bf16 v[148:151], a[48:51], v[68:71], v[148:151]
    v_mul_f32 v18, 0xbdd2d3e8, v18
    v_mul_f32 v19, 0xbdd2d3e8, v19
    v_mov_b32 v25, v24
    v_mfma_f32_16x16x32_bf16 v[176:179], a[48:51], v[124:127], v[176:179]
    v_mfma_f32_16x16x32_bf16 v[244:247], a[48:51], v[188:191], v[244:247]
    v_mov_b32 v27, v26
    v_mul_f32 v28, v16, v18
    v_mul_f32 v30, v17, v19
    s_waitcnt lgkmcnt(0)
    v_mfma_f32_16x16x32_bf16 v[152:155], a[52:55], v[68:71], v[152:155]
    v_mul_f32 v29, v16, v18
    v_mul_f32 v31, v17, v19
    v_lshlrev_b32 v36, 4, v1
    v_mfma_f32_16x16x32_bf16 v[180:183], a[52:55], v[124:127], v[180:183]
    v_mfma_f32_16x16x32_bf16 v[248:251], a[52:55], v[188:191], v[248:251]
    s_lshl_b32 s62, s6, 3
    s_lshl_b32 s63, s3, 1
    s_add_u32 s62, s62, s63
    s_lshl_b32 s62, s62, 2
    s_add_u32 s62, s62, s7
    s_sub_u32 s62, s62, 12
    s_lshl_b32 s62, s62, 12
    s_add_u32 s63, s62, 16384
    v_pk_fma_f32 v[64:65], v[224:225], v[20:21], v[128:129]
    v_pk_mul_f32 v[92:93], v[64:65], v[64:65]
    v_pk_fma_f32 v[66:67], v[226:227], v[20:21], v[130:131]
    v_pk_fma_f32 v[92:93], v[92:93], v[28:29], v[24:25]
    v_pk_mul_f32 v[94:95], v[66:67], v[66:67]
    v_pk_fma_f32 v[68:69], v[228:229], v[20:21], v[132:133]
    v_pk_mul_f32 v[92:93], v[92:93], v[64:65]
    v_pk_fma_f32 v[94:95], v[94:95], v[28:29], v[24:25]
    v_pk_mul_f32 v[96:97], v[68:69], v[68:69]
    v_pk_fma_f32 v[70:71], v[230:231], v[20:21], v[134:135]
    v_exp_f32 v92, v92
    v_pk_mul_f32 v[94:95], v[94:95], v[66:67]
    v_pk_fma_f32 v[96:97], v[96:97], v[28:29], v[24:25]
    v_exp_f32 v93, v93
    v_pk_mul_f32 v[98:99], v[70:71], v[70:71]
we_all_85:
wp_all_85:
    s_cmp_eq_u32 s43, 1
    s_cbranch_scc1 wr_0
    v_pk_fma_f32 v[72:73], v[232:233], v[20:21], v[136:137]
    v_exp_f32 v94, v94
    v_pk_fma_f32 v[92:93], v[92:93], v[32:33], v[32:33]
    v_pk_mul_f32 v[96:97], v[96:97], v[68:69]
    v_exp_f32 v95, v95
    v_pk_fma_f32 v[98:99], v[98:99], v[28:29], v[24:25]
    v_pk_mul_f32 v[100:101], v[72:73], v[72:73]
    v_pk_fma_f32 v[74:75], v[234:235], v[20:21], v[138:139]
    v_rcp_f32 v92, v92
    v_pk_fma_f32 v[94:95], v[94:95], v[32:33], v[32:33]
    v_pk_mul_f32 v[98:99], v[98:99], v[70:71]
    v_rcp_f32 v93, v93
    v_pk_fma_f32 v[100:101], v[100:101], v[28:29], v[24:25]
    v_exp_f32 v96, v96
    v_pk_mul_f32 v[102:103], v[74:75], v[74:75]
    v_exp_f32 v97, v97
    v_pk_fma_f32 v[76:77], v[236:237], v[20:21], v[140:141]
    v_rcp_f32 v94, v94
    v_pk_mul_f32 v[64:65], v[64:65], v[92:93]
    v_pk_fma_f32 v[96:97], v[96:97], v[32:33], v[32:33]
    v_rcp_f32 v95, v95
    v_pk_mul_f32 v[100:101], v[100:101], v[72:73]
    v_pk_fma_f32 v[102:103], v[102:103], v[28:29], v[24:25]
    v_exp_f32 v98, v98
    v_pk_mul_f32 v[104:105], v[76:77], v[76:77]
    v_exp_f32 v99, v99
    v_pk_fma_f32 v[78:79], v[238:239], v[20:21], v[142:143]
    v_rcp_f32 v96, v96
    v_cvt_pk_bf16_f32 v192, v64, v65
    v_pk_mul_f32 v[66:67], v[66:67], v[94:95]
    v_rcp_f32 v97, v97
    v_pk_fma_f32 v[98:99], v[98:99], v[32:33], v[32:33]
    v_pk_mul_f32 v[102:103], v[102:103], v[74:75]
    v_exp_f32 v100, v100
    v_pk_fma_f32 v[104:105], v[104:105], v[28:29], v[24:25]
    v_pk_mul_f32 v[106:107], v[78:79], v[78:79]
    v_exp_f32 v101, v101
    v_pk_fma_f32 v[80:81], v[240:241], v[20:21], v[144:145]
we_all_86:
wp_all_86:
    s_cmp_eq_u32 s43, 1
    s_cbranch_scc1 wr_0
    v_rcp_f32 v98, v98
    v_cvt_pk_bf16_f32 v193, v66, v67
    v_pk_mul_f32 v[68:69], v[68:69], v[96:97]
    v_rcp_f32 v99, v99
    v_pk_fma_f32 v[100:101], v[100:101], v[32:33], v[32:33]
    v_pk_mul_f32 v[104:105], v[104:105], v[76:77]
    v_exp_f32 v102, v102
    v_pk_fma_f32 v[106:107], v[106:107], v[28:29], v[24:25]
    v_pk_mul_f32 v[108:109], v[80:81], v[80:81]
    v_exp_f32 v103, v103
    v_pk_fma_f32 v[82:83], v[242:243], v[20:21], v[146:147]
    v_rcp_f32 v100, v100
    v_cvt_pk_bf16_f32 v194, v68, v69
    v_pk_mul_f32 v[70:71], v[70:71], v[98:99]
    v_rcp_f32 v101, v101
    v_pk_fma_f32 v[102:103], v[102:103], v[32:33], v[32:33]
    v_pk_mul_f32 v[106:107], v[106:107], v[78:79]
    v_exp_f32 v104, v104
    v_pk_fma_f32 v[108:109], v[108:109], v[28:29], v[24:25]
    v_pk_mul_f32 v[110:111], v[82:83], v[82:83]
    v_exp_f32 v105, v105
    v_pk_fma_f32 v[84:85], v[244:245], v[20:21], v[148:149]
    v_rcp_f32 v102, v102
    v_cvt_pk_bf16_f32 v195, v70, v71
    v_pk_mul_f32 v[72:73], v[72:73], v[100:101]
    v_rcp_f32 v103, v103
    v_pk_fma_f32 v[104:105], v[104:105], v[32:33], v[32:33]
    v_pk_mul_f32 v[108:109], v[108:109], v[80:81]
    v_exp_f32 v106, v106
    v_pk_fma_f32 v[110:111], v[110:111], v[28:29], v[24:25]
    v_pk_mul_f32 v[112:113], v[84:85], v[84:85]
    v_exp_f32 v107, v107
    v_pk_fma_f32 v[86:87], v[246:247], v[20:21], v[150:151]
    buffer_store_dwordx4 v[192:195], v36, s[56:59], s62 offen offset:0 sc1
    v_rcp_f32 v104, v104
    v_cvt_pk_bf16_f32 v196, v72, v73
    v_pk_mul_f32 v[74:75], v[74:75], v[102:103]
    v_rcp_f32 v105, v105
we_all_87:
wp_all_87:
    s_cmp_eq_u32 s43, 1
    s_cbranch_scc1 wr_0
    v_pk_fma_f32 v[106:107], v[106:107], v[32:33], v[32:33]
    v_pk_mul_f32 v[110:111], v[110:111], v[82:83]
    v_exp_f32 v108, v108
    v_pk_fma_f32 v[112:113], v[112:113], v[28:29], v[24:25]
    v_pk_mul_f32 v[114:115], v[86:87], v[86:87]
    v_exp_f32 v109, v109
    v_pk_fma_f32 v[88:89], v[248:249], v[20:21], v[152:153]
    v_rcp_f32 v106, v106
    v_cvt_pk_bf16_f32 v197, v74, v75
    v_pk_mul_f32 v[76:77], v[76:77], v[104:105]
    v_rcp_f32 v107, v107
    v_pk_fma_f32 v[108:109], v[108:109], v[32:33], v[32:33]
    v_pk_mul_f32 v[112:113], v[112:113], v[84:85]
    v_exp_f32 v110, v110
    v_pk_fma_f32 v[114:115], v[114:115], v[28:29], v[24:25]
    v_pk_mul_f32 v[116:117], v[88:89], v[88:89]
    v_exp_f32 v111, v111
    v_pk_fma_f32 v[90:91], v[250:251], v[20:21], v[154:155]
    v_rcp_f32 v108, v108
    v_cvt_pk_bf16_f32 v198, v76, v77
    v_pk_mul_f32 v[78:79], v[78:79], v[106:107]
    v_rcp_f32 v109, v109
    v_pk_fma_f32 v[110:111], v[110:111], v[32:33], v[32:33]
    v_pk_mul_f32 v[114:115], v[114:115], v[86:87]
    v_exp_f32 v112, v112
    v_pk_fma_f32 v[116:117], v[116:117], v[28:29], v[24:25]
    v_exp_f32 v113, v113
    v_pk_mul_f32 v[118:119], v[90:91], v[90:91]
    v_rcp_f32 v110, v110
    v_cvt_pk_bf16_f32 v199, v78, v79
    v_pk_mul_f32 v[80:81], v[80:81], v[108:109]
    v_rcp_f32 v111, v111
    v_pk_fma_f32 v[112:113], v[112:113], v[32:33], v[32:33]
    v_exp_f32 v114, v114
    v_pk_mul_f32 v[116:117], v[116:117], v[88:89]
    v_exp_f32 v115, v115
    v_pk_fma_f32 v[118:119], v[118:119], v[28:29], v[24:25]
    buffer_store_dwordx4 v[196:199], v36, s[56:59], s62 offen offset:1024 sc1
we_all_88:
wp_all_88:
    s_cmp_eq_u32 s43, 1
    s_cbranch_scc1 wr_0
    v_rcp_f32 v112, v112
    v_cvt_pk_bf16_f32 v200, v80, v81
    v_rcp_f32 v113, v113
    v_pk_mul_f32 v[82:83], v[82:83], v[110:111]
    v_exp_f32 v116, v116
    v_pk_fma_f32 v[114:115], v[114:115], v[32:33], v[32:33]
    v_exp_f32 v117, v117
    v_pk_mul_f32 v[118:119], v[118:119], v[90:91]
    v_rcp_f32 v114, v114
    v_cvt_pk_bf16_f32 v201, v82, v83
    v_rcp_f32 v115, v115
    v_pk_mul_f32 v[84:85], v[84:85], v[112:113]
    v_exp_f32 v118, v118
    v_pk_fma_f32 v[116:117], v[116:117], v[32:33], v[32:33]
    v_exp_f32 v119, v119
    v_rcp_f32 v116, v116
    v_cvt_pk_bf16_f32 v202, v84, v85
    v_pk_mul_f32 v[86:87], v[86:87], v[114:115]
    v_rcp_f32 v117, v117
    v_pk_fma_f32 v[118:119], v[118:119], v[32:33], v[32:33]
    v_rcp_f32 v118, v118
    v_cvt_pk_bf16_f32 v203, v86, v87
    v_rcp_f32 v119, v119
    v_pk_mul_f32 v[88:89], v[88:89], v[116:117]
    buffer_store_dwordx4 v[200:203], v36, s[56:59], s62 offen offset:2048 sc1
    v_cvt_pk_bf16_f32 v204, v88, v89
    v_pk_mul_f32 v[90:91], v[90:91], v[118:119]
    v_cvt_pk_bf16_f32 v205, v90, v91
    buffer_store_dwordx2 v[204:205], v36, s[56:59], s62 offen offset:3072 sc1
    v_bfe_u32 v128, v1, 2, 2
    v_lshl_add_u32 v128, v4, 3, v128
    v_lshlrev_b32 v128, 7, v128
    v_and_b32 v129, 1, v1
    v_lshl_add_u32 v128, v129, 4, v128
    v_and_b32 v129, 2, v1
    v_lshl_add_u32 v128, v129, 2, v128
    v_add_u32 v128, s42, v128
    v_lshlrev_b32 v130, 4, v3
    v_lshl_add_u32 v129, v4, 9, v130
    s_waitcnt vmcnt(7)
we_all_89:
wp_all_89:
    s_cmp_eq_u32 s43, 1
    s_cbranch_scc1 wr_0
    ds_read_b64_tr_b16 a[212:213], v128 offset:4096
    ds_read_b64_tr_b16 a[214:215], v128 offset:4608
    ds_read_b64_tr_b16 a[216:217], v128 offset:4128
    ds_read_b64_tr_b16 a[218:219], v128 offset:4640
    ds_read_b64_tr_b16 a[220:221], v128 offset:4160
    ds_read_b64_tr_b16 a[222:223], v128 offset:4672
    ds_read_b64_tr_b16 a[224:225], v128 offset:4192
    ds_read_b64_tr_b16 a[226:227], v128 offset:4704
    s_waitcnt lgkmcnt(0)
    buffer_store_dwordx4 a[212:215], v129, s[92:95], s18 offen offset:0 sc1
    buffer_store_dwordx4 a[216:219], v129, s[92:95], s18 offen offset:256 sc1
    buffer_store_dwordx4 a[220:223], v129, s[92:95], s18 offen offset:2048 sc1
    buffer_store_dwordx4 a[224:227], v129, s[92:95], s18 offen offset:2304 sc1
    s_cmp_eq_u32 s19, 0
    s_nop 0
    s_cbranch_scc1 k1_kernelw_tkf
    v_mov_b32 v132, 0x3f803f80
    v_mov_b32 v133, 0x3f803f80
    v_mov_b32 v134, 0x3f803f80
    v_mov_b32 v135, 0x3f803f80
    s_nop 1
    v_mfma_f32_16x16x32_bf16 v[136:139], v[132:135], a[212:215], 0
    v_mfma_f32_16x16x32_bf16 v[140:143], v[132:135], a[216:219], 0
    v_mfma_f32_16x16x32_bf16 v[144:147], v[132:135], a[220:223], 0
    v_mfma_f32_16x16x32_bf16 v[148:151], v[132:135], a[224:227], 0
    v_lshrrev_b32 v152, 1, v4
    v_lshl_add_u32 v130, v152, 11, v130
    v_and_b32 v152, 1, v4
    v_lshl_add_u32 v130, v152, 8, v130
    v_mov_b32 v154, 0
    s_and_b32 s27, s19, 0x600
    s_cmp_eq_u32 s27, 0x600
    s_cselect_b32 s27, s19, 0x7f000000
    v_cmp_eq_u32 vcc, 1, v4
    s_nop 1
    v_cndmask_b32 v136, v136, v140, vcc
    v_cmp_eq_u32 vcc, 2, v4
we_all_90:
wp_all_90:
    s_cmp_eq_u32 s43, 1
    s_cbranch_scc1 wr_0
    s_nop 1
    v_cndmask_b32 v136, v136, v144, vcc
    v_cmp_eq_u32 vcc, 3, v4
    s_nop 1
    v_cndmask_b32 v136, v136, v148, vcc
    v_cvt_pk_bf16_f32 v152, v136, v136
    v_lshlrev_b32 v152, 16, v152
    v_sub_f32 v153, v136, v152
    v_cvt_pk_bf16_f32 v152, v152, v153
    buffer_store_dword v152, v130, s[92:95], s19 offen sc1
    buffer_store_dword v154, v130, s[92:95], s27 offen offset:8 sc1
k1_kernelw_tkf:
    v_pk_fma_f32 v[64:65], v[224:225], v[22:23], v[156:157]
    v_pk_mul_f32 v[92:93], v[64:65], v[64:65]
    v_pk_fma_f32 v[66:67], v[226:227], v[22:23], v[158:159]
    v_pk_fma_f32 v[92:93], v[92:93], v[30:31], v[26:27]
    v_pk_mul_f32 v[94:95], v[66:67], v[66:67]
    v_pk_fma_f32 v[68:69], v[228:229], v[22:23], v[160:161]
    v_pk_mul_f32 v[92:93], v[92:93], v[64:65]
    v_pk_fma_f32 v[94:95], v[94:95], v[30:31], v[26:27]
    v_pk_mul_f32 v[96:97], v[68:69], v[68:69]
    v_pk_fma_f32 v[70:71], v[230:231], v[22:23], v[162:163]
    v_exp_f32 v92, v92
    v_pk_mul_f32 v[94:95], v[94:95], v[66:67]
    v_pk_fma_f32 v[96:97], v[96:97], v[30:31], v[26:27]
    v_exp_f32 v93, v93
    v_pk_mul_f32 v[98:99], v[70:71], v[70:71]
    v_pk_fma_f32 v[72:73], v[232:233], v[22:23], v[164:165]
    v_exp_f32 v94, v94
    v_pk_fma_f32 v[92:93], v[92:93], v[34:35], v[34:35]
    v_pk_mul_f32 v[96:97], v[96:97], v[68:69]
    v_exp_f32 v95, v95
    v_pk_fma_f32 v[98:99], v[98:99], v[30:31], v[26:27]
    v_pk_mul_f32 v[100:101], v[72:73], v[72:73]
    v_pk_fma_f32 v[74:75], v[234:235], v[22:23], v[166:167]
    v_rcp_f32 v92, v92
    v_pk_fma_f32 v[94:95], v[94:95], v[34:35], v[34:35]
    v_pk_mul_f32 v[98:99], v[98:99], v[70:71]
we_all_91:
wp_all_91:
    s_cmp_eq_u32 s43, 1
    s_cbranch_scc1 wr_0
    v_rcp_f32 v93, v93
    v_pk_fma_f32 v[100:101], v[100:101], v[30:31], v[26:27]
    v_exp_f32 v96, v96
    v_pk_mul_f32 v[102:103], v[74:75], v[74:75]
    v_exp_f32 v97, v97
    v_pk_fma_f32 v[76:77], v[236:237], v[22:23], v[168:169]
    v_rcp_f32 v94, v94
    v_pk_mul_f32 v[64:65], v[64:65], v[92:93]
    v_pk_fma_f32 v[96:97], v[96:97], v[34:35], v[34:35]
    v_rcp_f32 v95, v95
    v_pk_mul_f32 v[100:101], v[100:101], v[72:73]
    v_pk_fma_f32 v[102:103], v[102:103], v[30:31], v[26:27]
    v_exp_f32 v98, v98
    v_pk_mul_f32 v[104:105], v[76:77], v[76:77]
    v_exp_f32 v99, v99
    v_pk_fma_f32 v[78:79], v[238:239], v[22:23], v[170:171]
    v_rcp_f32 v96, v96
    v_cvt_pk_bf16_f32 v208, v64, v65
    v_pk_mul_f32 v[66:67], v[66:67], v[94:95]
    v_rcp_f32 v97, v97
    v_pk_fma_f32 v[98:99], v[98:99], v[34:35], v[34:35]
    v_pk_mul_f32 v[102:103], v[102:103], v[74:75]
    v_exp_f32 v100, v100
    v_pk_fma_f32 v[104:105], v[104:105], v[30:31], v[26:27]
    v_pk_mul_f32 v[106:107], v[78:79], v[78:79]
    v_exp_f32 v101, v101
    v_pk_fma_f32 v[80:81], v[240:241], v[22:23], v[172:173]
    v_rcp_f32 v98, v98
    v_cvt_pk_bf16_f32 v209, v66, v67
    v_pk_mul_f32 v[68:69], v[68:69], v[96:97]
    v_rcp_f32 v99, v99
    v_pk_fma_f32 v[100:101], v[100:101], v[34:35], v[34:35]
    v_pk_mul_f32 v[104:105], v[104:105], v[76:77]
    v_exp_f32 v102, v102
    v_pk_fma_f32 v[106:107], v[106:107], v[30:31], v[26:27]
    v_pk_mul_f32 v[108:109], v[80:81], v[80:81]
    v_exp_f32 v103, v103
    v_pk_fma_f32 v[82:83], v[242:243], v[22:23], v[174:175]
    v_rcp_f32 v100, v100
we_all_92:
wp_all_92:
    s_cmp_eq_u32 s43, 1
    s_cbranch_scc1 wr_0
    v_cvt_pk_bf16_f32 v210, v68, v69
    v_pk_mul_f32 v[70:71], v[70:71], v[98:99]
    v_rcp_f32 v101, v101
    v_pk_fma_f32 v[102:103], v[102:103], v[34:35], v[34:35]
    v_pk_mul_f32 v[106:107], v[106:107], v[78:79]
    v_exp_f32 v104, v104
    v_pk_fma_f32 v[108:109], v[108:109], v[30:31], v[26:27]
    v_pk_mul_f32 v[110:111], v[82:83], v[82:83]
    v_exp_f32 v105, v105
    v_pk_fma_f32 v[84:85], v[244:245], v[22:23], v[176:177]
    v_rcp_f32 v102, v102
    v_cvt_pk_bf16_f32 v211, v70, v71
    v_pk_mul_f32 v[72:73], v[72:73], v[100:101]
    v_rcp_f32 v103, v103
    v_pk_fma_f32 v[104:105], v[104:105], v[34:35], v[34:35]
    v_pk_mul_f32 v[108:109], v[108:109], v[80:81]
    v_exp_f32 v106, v106
    v_pk_fma_f32 v[110:111], v[110:111], v[30:31], v[26:27]
    v_pk_mul_f32 v[112:113], v[84:85], v[84:85]
    v_exp_f32 v107, v107
    v_pk_fma_f32 v[86:87], v[246:247], v[22:23], v[178:179]
    buffer_store_dwordx4 v[208:211], v36, s[56:59], s63 offen offset:0 sc1
    v_rcp_f32 v104, v104
    v_cvt_pk_bf16_f32 v212, v72, v73
    v_pk_mul_f32 v[74:75], v[74:75], v[102:103]
    v_rcp_f32 v105, v105
    v_pk_fma_f32 v[106:107], v[106:107], v[34:35], v[34:35]
    v_pk_mul_f32 v[110:111], v[110:111], v[82:83]
    v_exp_f32 v108, v108
    v_pk_fma_f32 v[112:113], v[112:113], v[30:31], v[26:27]
    v_pk_mul_f32 v[114:115], v[86:87], v[86:87]
    v_exp_f32 v109, v109
    v_pk_fma_f32 v[88:89], v[248:249], v[22:23], v[180:181]
    v_rcp_f32 v106, v106
    v_cvt_pk_bf16_f32 v213, v74, v75
    v_pk_mul_f32 v[76:77], v[76:77], v[104:105]
    v_rcp_f32 v107, v107
    v_pk_fma_f32 v[108:109], v[108:109], v[34:35], v[34:35]
we_all_93:
wp_all_93:
    s_cmp_eq_u32 s43, 1
    s_cbranch_scc1 wr_0
    v_pk_mul_f32 v[112:113], v[112:113], v[84:85]
    v_exp_f32 v110, v110
    v_pk_fma_f32 v[114:115], v[114:115], v[30:31], v[26:27]
    v_pk_mul_f32 v[116:117], v[88:89], v[88:89]
    v_exp_f32 v111, v111
    v_pk_fma_f32 v[90:91], v[250:251], v[22:23], v[182:183]
    v_rcp_f32 v108, v108
    v_cvt_pk_bf16_f32 v214, v76, v77
    v_pk_mul_f32 v[78:79], v[78:79], v[106:107]
    v_rcp_f32 v109, v109
    v_pk_fma_f32 v[110:111], v[110:111], v[34:35], v[34:35]
    v_pk_mul_f32 v[114:115], v[114:115], v[86:87]
    v_exp_f32 v112, v112
    v_pk_fma_f32 v[116:117], v[116:117], v[30:31], v[26:27]
    v_exp_f32 v113, v113
    v_pk_mul_f32 v[118:119], v[90:91], v[90:91]
    v_rcp_f32 v110, v110
    v_cvt_pk_bf16_f32 v215, v78, v79
    v_pk_mul_f32 v[80:81], v[80:81], v[108:109]
    v_rcp_f32 v111, v111
    v_pk_fma_f32 v[112:113], v[112:113], v[34:35], v[34:35]
    v_exp_f32 v114, v114
    v_pk_mul_f32 v[116:117], v[116:117], v[88:89]
    v_exp_f32 v115, v115
    v_pk_fma_f32 v[118:119], v[118:119], v[30:31], v[26:27]
    buffer_store_dwordx4 v[212:215], v36, s[56:59], s63 offen offset:1024 sc1
    v_rcp_f32 v112, v112
    v_cvt_pk_bf16_f32 v216, v80, v81
    v_rcp_f32 v113, v113
    v_pk_mul_f32 v[82:83], v[82:83], v[110:111]
    v_exp_f32 v116, v116
    v_pk_fma_f32 v[114:115], v[114:115], v[34:35], v[34:35]
    v_exp_f32 v117, v117
    v_pk_mul_f32 v[118:119], v[118:119], v[90:91]
    v_rcp_f32 v114, v114
    v_cvt_pk_bf16_f32 v217, v82, v83
    v_rcp_f32 v115, v115
    v_pk_mul_f32 v[84:85], v[84:85], v[112:113]
    v_exp_f32 v118, v118
we_all_94:
wp_all_94:
    s_cmp_eq_u32 s43, 1
    s_cbranch_scc1 wr_0
    v_pk_fma_f32 v[116:117], v[116:117], v[34:35], v[34:35]
    v_exp_f32 v119, v119
    v_rcp_f32 v116, v116
    v_cvt_pk_bf16_f32 v218, v84, v85
    v_pk_mul_f32 v[86:87], v[86:87], v[114:115]
    v_rcp_f32 v117, v117
    v_pk_fma_f32 v[118:119], v[118:119], v[34:35], v[34:35]
    v_rcp_f32 v118, v118
    v_cvt_pk_bf16_f32 v219, v86, v87
    v_rcp_f32 v119, v119
    v_pk_mul_f32 v[88:89], v[88:89], v[116:117]
    buffer_store_dwordx4 v[216:219], v36, s[56:59], s63 offen offset:2048 sc1
    v_cvt_pk_bf16_f32 v220, v88, v89
    v_pk_mul_f32 v[90:91], v[90:91], v[118:119]
    v_cvt_pk_bf16_f32 v221, v90, v91
    buffer_store_dwordx2 v[220:221], v36, s[56:59], s63 offen offset:3072 sc1
    s_nop 0
k1_kernel_end:
    s_endpgm
.globl kf_kernel
.p2align 8
.type kf_kernel,@function
kf_kernel:
    s_load_dwordx16 s[16:31], s[0:1], 0
    s_load_dwordx8 s[32:39], s[0:1], 64
    s_load_dwordx2 s[40:41], s[0:1], 96
    s_cmp_ge_u32 s2, 256
    s_cbranch_scc1 kf_kernel_end
    s_mov_b32 s43, 0
we_all_95:
wp_all_95:
    s_cmp_eq_u32 s43, 1
    s_cbranch_scc1 wr_0
    s_lshr_b32 s68, s2, 3
    s_xor_b32 s69, s2, 232
    s_cmp_eq_u32 s68, 1
    s_cselect_b32 s2, s69, s2
    s_cmp_eq_u32 s68, 28
    s_cselect_b32 s2, s69, s2
    v_and_b32 v1, 63, v0
    v_lshrrev_b32 v2, 6, v0
    s_nop 0
    v_readfirstlane_b32 s3, v2
    v_and_b32 v3, 15, v1
    v_lshrrev_b32 v4, 4, v1
    v_lshlrev_b32 v10, 4, v1
    s_mov_b32 s100, 0
    s_cmp_ge_u32 s2, 224
    s_cbranch_scc1 kf_kernel_o
    s_and_b32 s4, s2, 7
    s_lshr_b32 s70, s2, 3
    s_mul_i32 s5, s70, 37
    s_lshr_b32 s5, s5, 8
    s_mul_i32 s69, s5, 7
    s_sub_u32 s7, s70, s69
    s_lshl_b32 s6, s4, 2
    s_add_u32 s6, s6, s5
    v_lshrrev_b32 v5, 3, v1
    v_and_b32 v6, 7, v1
    s_lshl_b32 s69, s7, 7
    s_lshl_b32 s72, s6, 6
    s_lshl_b32 s71, s3, 4
    s_add_u32 s71, s71, s72
    v_lshrrev_b32 v8, 1, v5
    v_xor_b32 v8, v8, v6
    v_add_u32 v9, s71, v5
    v_mul_u32_u24 v9, 896, v9
    v_lshl_add_u32 v9, v8, 4, v9
    v_add_u32 v198, s69, v9
    v_xor_b32 v199, 64, v198
    v_add_u32 v199, 7168, v199
    v_lshl_add_u32 v6, v6, 4, s69
    v_and_b32 v7, 16, v1
    v_lshlrev_b32 v7, 2, v7
    v_xor_b32 v6, v6, v7
    v_mul_u32_u24 v7, 896, v5
    v_add_u32 v196, v7, v6
    v_and_b32 v5, 3, v5
we_all_96:
wp_all_96:
    s_cmp_eq_u32 s43, 1
    s_cbranch_scc1 wr_0
    v_mul_u32_u24 v7, 896, v5
    v_add_u32 v197, v7, v6
    s_mul_i32 s14, s3, 16640
    s_add_u32 s14, s14, 89088
    s_lshl_b32 s11, s3, 11
    s_add_u32 s11, s11, 155648
    s_mul_i32 s8, s3, 100352
    v_add_u32 v7, s71, v3
    v_lshlrev_b32 v8, 8, v4
    v_add_u32 v5, -1, v7
    v_ashrrev_i32 v6, 4, v5
    v_lshlrev_b32 v6, 14, v6
    v_and_b32 v5, 15, v5
    v_lshl_add_u32 v5, v5, 4, v6
    v_add_u32 v192, v5, v8
    v_add_u32 v5, 1, v7
    v_ashrrev_i32 v6, 4, v5
    v_lshlrev_b32 v6, 14, v6
    v_and_b32 v5, 15, v5
    v_lshl_add_u32 v5, v5, 4, v6
    v_add_u32 v5, 4096, v5
    v_add_u32 v193, v5, v8
    v_add_u32 v5, -2, v7
    v_ashrrev_i32 v6, 4, v5
    v_lshlrev_b32 v6, 14, v6
    v_and_b32 v5, 15, v5
    v_lshl_add_u32 v5, v5, 4, v6
    v_add_u32 v5, 8192, v5
    v_add_u32 v194, v5, v8
    v_add_u32 v5, 2, v7
    v_ashrrev_i32 v6, 4, v5
    v_lshlrev_b32 v6, 14, v6
    v_and_b32 v5, 15, v5
    v_lshl_add_u32 v5, v5, 4, v6
    v_add_u32 v5, 12288, v5
    v_add_u32 v195, v5, v8
    v_lshl_add_u32 v6, v4, 4, s69
    s_waitcnt lgkmcnt(0)
    s_mov_b32 s48, s16
    s_mov_b32 s49, s17
    s_mov_b32 s50, 0x1c0000
    s_mov_b32 s51, 0x20000
    s_mov_b32 s52, s28
    s_mov_b32 s53, s29
    s_mov_b32 s54, 0x62000
    s_mov_b32 s55, 0x20000
we_all_97:
wp_all_97:
    s_cmp_eq_u32 s43, 1
    s_cbranch_scc1 wr_0
    s_mov_b32 s56, s40
    s_mov_b32 s57, s41
    s_mov_b32 s58, 0x200000
    s_mov_b32 s59, 0x20000
    s_add_u32 m0, s14, 0
    s_add_u32 s9, s8, 0
    buffer_load_dwordx4 v196, s[52:55], s9 offen lds
    s_add_u32 m0, s14, 1032
    s_add_u32 s9, s8, 25088
    buffer_load_dwordx4 v196, s[52:55], s9 offen lds
    s_add_u32 m0, s14, 2064
    s_add_u32 s9, s8, 50176
    buffer_load_dwordx4 v196, s[52:55], s9 offen lds
    s_add_u32 m0, s14, 3096
    s_add_u32 s9, s8, 75264
    buffer_load_dwordx4 v196, s[52:55], s9 offen lds
    buffer_load_dwordx4 v[32:35], v192, s[56:59], 0 offen offset:0
    buffer_load_dwordx4 v[48:51], v193, s[56:59], 0 offen offset:0
    buffer_load_dwordx4 v[64:67], v194, s[56:59], 0 offen offset:0
    buffer_load_dwordx4 v[80:83], v195, s[56:59], 0 offen offset:0
    s_mov_b32 m0, s11
    s_nop 0
    buffer_load_dwordx4 v198, s[48:51], 0 offen lds
    s_add_u32 m0, m0, 1024
    s_nop 0
    buffer_load_dwordx4 v199, s[48:51], 0 offen lds
    s_mov_b32 s64, s34
    s_mov_b32 s65, s35
    s_mov_b32 s66, 0x380
    s_mov_b32 s67, 0x20000
    buffer_load_dwordx4 v[232:235], v6, s[64:67], 0 offen offset:0
    buffer_load_dwordx4 v[236:239], v6, s[64:67], 0 offen offset:64
    s_add_u32 m0, s14, 4128
    s_add_u32 s9, s8, 7168
    buffer_load_dwordx4 v196, s[52:55], s9 offen lds
we_all_98:
wp_all_98:
    s_cmp_eq_u32 s43, 1
    s_cbranch_scc1 wr_0
    s_add_u32 m0, s14, 5160
    s_add_u32 s9, s8, 32256
    buffer_load_dwordx4 v196, s[52:55], s9 offen lds
    s_add_u32 m0, s14, 6192
    s_add_u32 s9, s8, 57344
    buffer_load_dwordx4 v196, s[52:55], s9 offen lds
    s_add_u32 m0, s14, 7224
    s_add_u32 s9, s8, 82432
    buffer_load_dwordx4 v196, s[52:55], s9 offen lds
    buffer_load_dwordx4 v[36:39], v192, s[56:59], 0 offen offset:1024
    buffer_load_dwordx4 v[52:55], v193, s[56:59], 0 offen offset:1024
    buffer_load_dwordx4 v[68:71], v194, s[56:59], 0 offen offset:1024
    buffer_load_dwordx4 v[84:87], v195, s[56:59], 0 offen offset:1024
    s_mov_b32 s44, s40
    s_mov_b32 s45, s41
    s_mov_b32 s46, 0x1c00000
    s_mov_b32 s47, 0x20000
    s_mov_b32 s60, s36
    s_mov_b32 s61, s37
    s_mov_b32 s62, 0x1c0000
    s_mov_b32 s63, 0x20000
    v_mov_b32 v46, 0
    v_mov_b32 v47, 0
    v_mov_b32 v62, 0
    v_mov_b32 v63, 0
    v_mov_b32 v78, 0
    v_mov_b32 v79, 0
    v_mov_b32 v94, 0
    v_mov_b32 v95, 0
    v_bfe_u32 v5, v1, 2, 2
    v_and_b32 v6, 3, v1
    v_mul_u32_u24 v7, 1032, v4
    v_lshl_add_u32 v7, v5, 7, v7
    v_lshl_add_u32 v7, v6, 4, v7
    v_add_u32 v7, 89088, v7
    v_and_b32 v6, 8, v1
    v_lshlrev_b32 v6, 3, v6
    v_add_u32 v200, v7, v6
    v_xor_b32 v6, 64, v6
    v_add_u32 v201, v7, v6
we_all_99:
wp_all_99:
    s_cmp_eq_u32 s43, 1
    s_cbranch_scc1 wr_0
    v_add_u32 v202, 33280, v200
    v_add_u32 v203, 33280, v201
    v_lshrrev_b32 v5, 1, v3
    v_xor_b32 v5, v5, v4
    v_lshlrev_b32 v5, 4, v5
    v_lshl_add_u32 v5, v3, 7, v5
    v_add_u32 v204, s11, v5
    v_xor_b32 v205, 64, v204
    s_lshl_b32 s15, s6, 2
    s_add_u32 s15, s15, s3
    s_mul_i32 s12, s15, 14
    s_lshl_b32 s13, s7, 1
    s_add_u32 s12, s12, s13
    s_lshl_b32 s12, s12, 10
    s_add_u32 s12, s12, 0x900000
    s_lshl_b32 s13, s15, 11
    s_add_u32 s13, s13, 0xac0000
    v_and_b32 v5, 511, v10
    v_add_u32 v26, s13, v5
    s_lshr_b32 s10, s7, 2
    s_lshl_b32 s10, s10, 8
    s_add_u32 s13, s13, s10
    s_and_b32 s10, s7, 3
    s_lshl_b32 s10, s10, 2
    s_add_u32 s13, s13, s10
    v_lshlrev_b32 v211, 4, v3
    v_lshl_add_u32 v211, v4, 9, v211
    v_mov_b32 v209, 0x3f803f80
    v_add_u32 v250, 122880, v211
    v_mov_b32 v251, v211
    s_lshl_b32 s34, s15, 14
    s_add_u32 s34, s34, 0xb00000
    v_mov_b32 v246, 1
    s_lshl_b32 s68, s2, 12
    s_add_u32 s68, s68, 0x1500000
    s_lshl_b32 s69, s3, 2
    s_add_u32 s68, s68, s69
    v_mov_b32 v247, s68
    s_and_b32 s38, s4, 1
    s_lshr_b32 s39, s4, 1
    s_lshl_b32 s39, s39, 2
    s_add_u32 s39, s39, s5
    s_mul_i32 s38, s38, 7
    s_add_u32 s38, s38, s7
    s_mul_i32 s68, s38, 122880
    s_add_u32 s68, s68, 0x1600000
    v_add_u32 v16, s68, v10
    s_lshl_b32 s23, s3, 12
    s_and_b32 s35, s23, 4096
we_all_100:
wp_all_100:
    s_cmp_eq_u32 s43, 1
    s_cbranch_scc1 wr_0
    s_add_u32 s35, s35, 114688
    v_add_u32 v11, 4096, v10
    v_add_u32 v12, 8192, v10
    v_add_u32 v13, 12288, v10
    v_add_u32 v14, 114688, v10
    v_add_u32 v15, 118784, v10
    s_lshl_b32 s71, s39, 2
    s_add_u32 s71, s71, s3
    s_mul_i32 s37, s71, 28672
    s_add_u32 s37, s37, 0x900000
    s_mul_i32 s32, s71, 114688
    s_lshl_b32 s72, s38, 13
    s_add_u32 s32, s32, s72
    s_add_u32 s32, s32, 0xd00000
    s_lshl_b32 s72, s71, 12
    s_add_u32 s72, s72, 0xac0000
    v_and_b32 v5, 1, v4
    v_lshrrev_b32 v6, 1, v4
    v_lshlrev_b32 v7, 4, v3
    v_lshl_add_u32 v8, v6, 8, v7
    v_mul_u32_u24 v9, 14336, v5
    v_add_u32 v17, v8, v9
    v_lshl_add_u32 v8, v6, 9, v7
    v_lshl_add_u32 v8, v5, 11, v8
    v_add_u32 v20, s72, v8
    s_lshl_b32 s72, s37, 2
    v_subrev_u32 v18, s72, v10
    v_add_u32 v19, 61440, v18
    s_lshl_b32 s68, s5, 1
    s_add_u32 s68, s68, s7
    s_sub_u32 s69, s68, 7
    s_cmp_ge_u32 s68, 7
    s_cselect_b32 s68, s69, s68
    s_lshl_b32 s69, s68, 11
    s_add_u32 s16, s37, s69
    s_add_u32 s70, s37, 14336
    s_add_u32 s17, s16, 2048
    s_cmp_eq_u32 s17, s70
    s_cselect_b32 s17, s37, s17
    s_add_u32 s18, s17, 2048
    s_cmp_eq_u32 s18, s70
    s_cselect_b32 s18, s37, s18
we_all_101:
wp_all_101:
    s_cmp_eq_u32 s43, 1
    s_cbranch_scc1 wr_0
    s_add_u32 s19, s18, 2048
    s_cmp_eq_u32 s19, s70
    s_cselect_b32 s19, s37, s19
    s_add_u32 s20, s19, 2048
    s_cmp_eq_u32 s20, s70
    s_cselect_b32 s20, s37, s20
    s_add_u32 s21, s20, 2048
    s_cmp_eq_u32 s21, s70
    s_cselect_b32 s21, s37, s21
    s_add_u32 s22, s21, 2048
    s_cmp_eq_u32 s22, s70
    s_cselect_b32 s22, s37, s22
    s_lshl_b32 s68, s68, 1
    s_mul_i32 s69, s6, 229376
    s_add_u32 s69, s69, 0xd00000
    s_mul_i32 s70, s7, 229376
    s_add_u32 s70, s70, 0x1800000
    s_and_b32 s72, s3, 1
    s_add_u32 s71, s68, s3
    s_sub_u32 s73, s71, 14
    s_cmp_ge_u32 s71, 14
    s_cselect_b32 s71, s73, s71
    s_lshl_b32 s24, s71, 13
    s_add_u32 s24, s24, s69
    s_lshl_b32 s28, s71, 14
    s_add_u32 s28, s28, s70
    v_mov_b32 v21, s71
    s_add_u32 s71, s68, s3
    s_add_u32 s71, s71, 4
    s_sub_u32 s73, s71, 14
    s_cmp_ge_u32 s71, 14
    s_cselect_b32 s71, s73, s71
    s_lshl_b32 s25, s71, 13
    s_add_u32 s25, s25, s69
    s_lshl_b32 s29, s71, 14
    s_add_u32 s29, s29, s70
    v_writelane_b32 v21, s71, 1
    s_add_u32 s71, s68, s3
    s_add_u32 s71, s71, 8
    s_sub_u32 s73, s71, 14
    s_cmp_ge_u32 s71, 14
    s_cselect_b32 s71, s73, s71
    s_lshl_b32 s26, s71, 13
    s_add_u32 s26, s26, s69
    s_lshl_b32 s30, s71, 14
    s_add_u32 s30, s30, s70
    v_writelane_b32 v21, s71, 2
    s_add_u32 s71, s68, s72
    s_add_u32 s71, s71, 12
    s_sub_u32 s73, s71, 14
    s_cmp_ge_u32 s71, 14
    s_cselect_b32 s71, s73, s71
we_all_102:
wp_all_102:
    s_cmp_eq_u32 s43, 1
    s_cbranch_scc1 wr_0
    s_lshl_b32 s27, s71, 13
    s_add_u32 s27, s27, s69
    s_lshl_b32 s31, s71, 14
    s_add_u32 s31, s31, s70
    v_writelane_b32 v21, s71, 3
    s_lshr_b32 s72, s3, 1
    s_lshl_b32 s73, s72, 11
    s_add_u32 s27, s27, s73
    s_lshl_b32 s73, s72, 12
    s_add_u32 s31, s31, s73
    s_lshr_b32 s72, s5, 1
    s_and_b32 s69, s4, 1
    s_lshl_b32 s69, s69, 1
    s_add_u32 s69, s69, s72
    s_mul_i32 s69, s69, 56
    s_and_b32 s70, s4, 6
    s_add_u32 s69, s69, s70
    s_lshl_b32 s69, s69, 12
    s_add_u32 s69, s69, 0x1500000
    s_and_b32 s72, s5, 1
    s_lshl_b32 s72, s72, 3
    s_add_u32 s69, s69, s72
    v_cmp_lt_u32 vcc, 6, v21
    v_lshl_add_u32 v21, v21, 15, s69
    v_subrev_u32 v6, 225280, v21
    v_cndmask_b32 v21, v21, v6, vcc
    s_lshr_b32 s69, s4, 2
    s_lshl_b32 s69, s69, 3
    s_add_u32 s69, s69, 224
    s_lshl_b32 s69, s69, 12
    s_add_u32 s69, s69, 0x1500000
    v_and_b32 v5, 7, v1
    v_lshl_add_u32 v22, v5, 12, s69
    v_and_b32 v5, 8, v1
    v_lshl_add_u32 v22, v5, 13, v22
    s_lshl_b32 s36, s7, 16
    s_add_u32 s36, s36, s23
    s_add_u32 s36, s36, 0x1a00000
    s_add_u32 m0, s14, 8256
    s_add_u32 s9, s8, 14336
    buffer_load_dwordx4 v196, s[52:55], s9 offen lds
    s_add_u32 m0, s14, 9288
    s_add_u32 s9, s8, 39424
    buffer_load_dwordx4 v196, s[52:55], s9 offen lds
    s_add_u32 m0, s14, 10320
    s_add_u32 s9, s8, 64512
we_all_103:
wp_all_103:
    s_cmp_eq_u32 s43, 1
    s_cbranch_scc1 wr_0
    buffer_load_dwordx4 v196, s[52:55], s9 offen lds
    s_add_u32 m0, s14, 11352
    s_add_u32 s9, s8, 89600
    buffer_load_dwordx4 v196, s[52:55], s9 offen lds
    buffer_load_dwordx4 v[40:43], v192, s[56:59], 0 offen offset:2048
    buffer_load_dwordx4 v[56:59], v193, s[56:59], 0 offen offset:2048
    buffer_load_dwordx4 v[72:75], v194, s[56:59], 0 offen offset:2048
    buffer_load_dwordx4 v[88:91], v195, s[56:59], 0 offen offset:2048
    s_add_u32 m0, s14, 12384
    s_add_u32 s9, s8, 21504
    buffer_load_dwordx4 v197, s[52:55], s9 offen lds
    s_add_u32 m0, s14, 13416
    s_add_u32 s9, s8, 46592
    buffer_load_dwordx4 v197, s[52:55], s9 offen lds
    s_add_u32 m0, s14, 14448
    s_add_u32 s9, s8, 71680
    buffer_load_dwordx4 v197, s[52:55], s9 offen lds
    s_add_u32 m0, s14, 15480
    s_add_u32 s9, s8, 96768
    buffer_load_dwordx4 v197, s[52:55], s9 offen lds
    buffer_load_dwordx2 v[44:45], v192, s[56:59], 0 offen offset:3072
    buffer_load_dwordx2 v[60:61], v193, s[56:59], 0 offen offset:3072
    buffer_load_dwordx2 v[76:77], v194, s[56:59], 0 offen offset:3072
    buffer_load_dwordx2 v[92:93], v195, s[56:59], 0 offen offset:3072
    s_waitcnt vmcnt(32)
    s_barrier
    ds_read_b64_tr_b16 v[96:97], v200 offset:0
    ds_read_b64_tr_b16 v[98:99], v200 offset:512
    ds_read_b64_tr_b16 v[100:101], v200 offset:8
    ds_read_b64_tr_b16 v[102:103], v200 offset:520
    ds_read_b64_tr_b16 v[104:105], v201 offset:0
    ds_read_b64_tr_b16 v[106:107], v201 offset:512
we_all_104:
wp_all_104:
    s_cmp_eq_u32 s43, 1
    s_cbranch_scc1 wr_0
    ds_read_b64_tr_b16 v[108:109], v201 offset:8
    ds_read_b64_tr_b16 v[110:111], v201 offset:520
    ds_read_b64_tr_b16 v[112:113], v200 offset:16640
    ds_read_b64_tr_b16 v[114:115], v200 offset:17152
    ds_read_b64_tr_b16 v[116:117], v200 offset:16648
    ds_read_b64_tr_b16 v[118:119], v200 offset:17160
    ds_read_b64_tr_b16 v[120:121], v201 offset:16640
    ds_read_b64_tr_b16 v[122:123], v201 offset:17152
    ds_read_b64_tr_b16 v[124:125], v201 offset:16648
    ds_read_b64_tr_b16 v[126:127], v201 offset:17160
    ds_read_b64_tr_b16 v[128:129], v202 offset:0
    ds_read_b64_tr_b16 v[130:131], v202 offset:512
    ds_read_b64_tr_b16 v[132:133], v202 offset:8
    ds_read_b64_tr_b16 v[134:135], v202 offset:520
    ds_read_b64_tr_b16 v[136:137], v203 offset:0
    ds_read_b64_tr_b16 v[138:139], v203 offset:512
    ds_read_b64_tr_b16 v[140:141], v203 offset:8
    ds_read_b64_tr_b16 v[142:143], v203 offset:520
    s_waitcnt vmcnt(31) lgkmcnt(15)
    v_mfma_f32_16x16x32_bf16 v[160:163], v[96:99], v[32:35], 0
    ds_read_b64_tr_b16 v[144:145], v202 offset:16640
    ds_read_b64_tr_b16 v[146:147], v202 offset:17152
    v_mfma_f32_16x16x32_bf16 v[164:167], v[100:103], v[32:35], 0
    s_add_u32 m0, s23, 0
    s_nop 0
    buffer_load_dwordx4 v16, s[44:47], m0 offen offset:0 lds
    ds_read_b64_tr_b16 v[148:149], v202 offset:16648
    ds_read_b64_tr_b16 v[150:151], v202 offset:17160
    v_mfma_f32_16x16x32_bf16 v[168:171], v[104:107], v[32:35], 0
    ds_read_b64_tr_b16 v[152:153], v203 offset:16640
    ds_read_b64_tr_b16 v[154:155], v203 offset:17152
    v_mfma_f32_16x16x32_bf16 v[172:175], v[108:111], v[32:35], 0
we_all_105:
wp_all_105:
    s_cmp_eq_u32 s43, 1
    s_cbranch_scc1 wr_0
    buffer_load_dwordx4 v16, s[44:47], m0 offen offset:1024 lds
    ds_read_b64_tr_b16 v[156:157], v203 offset:16648
    ds_read_b64_tr_b16 v[158:159], v203 offset:17160
    s_waitcnt vmcnt(22)
    s_barrier
    s_waitcnt lgkmcnt(15)
    v_mfma_f32_16x16x32_bf16 v[160:163], v[112:115], v[48:51], v[160:163]
    ds_read_b64_tr_b16 v[96:97], v200 offset:4128
    ds_read_b64_tr_b16 v[98:99], v200 offset:4640
    v_mfma_f32_16x16x32_bf16 v[164:167], v[116:119], v[48:51], v[164:167]
    buffer_load_dwordx4 v16, s[44:47], m0 offen offset:2048 lds
    ds_read_b64_tr_b16 v[100:101], v200 offset:4136
    ds_read_b64_tr_b16 v[102:103], v200 offset:4648
    v_mfma_f32_16x16x32_bf16 v[168:171], v[120:123], v[48:51], v[168:171]
    ds_read_b64_tr_b16 v[104:105], v201 offset:4128
    ds_read_b64_tr_b16 v[106:107], v201 offset:4640
    v_mfma_f32_16x16x32_bf16 v[172:175], v[124:127], v[48:51], v[172:175]
    buffer_load_dwordx4 v16, s[44:47], m0 offen offset:3072 lds
    ds_read_b64_tr_b16 v[108:109], v201 offset:4136
    ds_read_b64_tr_b16 v[110:111], v201 offset:4648
    s_waitcnt lgkmcnt(15)
    v_mfma_f32_16x16x32_bf16 v[160:163], v[128:131], v[64:67], v[160:163]
    ds_read_b64_tr_b16 v[112:113], v200 offset:20768
    ds_read_b64_tr_b16 v[114:115], v200 offset:21280
    v_mfma_f32_16x16x32_bf16 v[164:167], v[132:135], v[64:67], v[164:167]
    s_add_u32 m0, s23, 16384
    s_nop 0
    buffer_load_dwordx4 v16, s[44:47], m0 offen offset:0 lds
    ds_read_b64_tr_b16 v[116:117], v200 offset:20776
    ds_read_b64_tr_b16 v[118:119], v200 offset:21288
    v_mfma_f32_16x16x32_bf16 v[168:171], v[136:139], v[64:67], v[168:171]
    ds_read_b64_tr_b16 v[120:121], v201 offset:20768
    ds_read_b64_tr_b16 v[122:123], v201 offset:21280
    v_mfma_f32_16x16x32_bf16 v[172:175], v[140:143], v[64:67], v[172:175]
we_all_106:
wp_all_106:
    s_cmp_eq_u32 s43, 1
    s_cbranch_scc1 wr_0
    buffer_load_dwordx4 v16, s[44:47], m0 offen offset:1024 lds
    ds_read_b64_tr_b16 v[124:125], v201 offset:20776
    ds_read_b64_tr_b16 v[126:127], v201 offset:21288
    s_waitcnt lgkmcnt(15)
    v_mfma_f32_16x16x32_bf16 v[160:163], v[144:147], v[80:83], v[160:163]
    ds_read_b64_tr_b16 v[128:129], v202 offset:4128
    ds_read_b64_tr_b16 v[130:131], v202 offset:4640
    v_mfma_f32_16x16x32_bf16 v[164:167], v[148:151], v[80:83], v[164:167]
    buffer_load_dwordx4 v16, s[44:47], m0 offen offset:2048 lds
    ds_read_b64_tr_b16 v[132:133], v202 offset:4136
    ds_read_b64_tr_b16 v[134:135], v202 offset:4648
    v_mfma_f32_16x16x32_bf16 v[168:171], v[152:155], v[80:83], v[168:171]
    ds_read_b64_tr_b16 v[136:137], v203 offset:4128
    ds_read_b64_tr_b16 v[138:139], v203 offset:4640
    v_mfma_f32_16x16x32_bf16 v[172:175], v[156:159], v[80:83], v[172:175]
    buffer_load_dwordx4 v16, s[44:47], m0 offen offset:3072 lds
    ds_read_b64_tr_b16 v[140:141], v203 offset:4136
    ds_read_b64_tr_b16 v[142:143], v203 offset:4648
    ds_read_b128 v[224:227], v204
    ds_read_b128 v[228:231], v205
    s_waitcnt vmcnt(27) lgkmcnt(15)
    v_mfma_f32_16x16x32_bf16 v[160:163], v[96:99], v[36:39], v[160:163]
    ds_read_b64_tr_b16 v[144:145], v202 offset:20768
    ds_read_b64_tr_b16 v[146:147], v202 offset:21280
    v_mfma_f32_16x16x32_bf16 v[164:167], v[100:103], v[36:39], v[164:167]
    s_add_u32 m0, s23, 32768
    s_nop 0
    buffer_load_dwordx4 v16, s[44:47], m0 offen offset:0 lds
    ds_read_b64_tr_b16 v[148:149], v202 offset:20776
    ds_read_b64_tr_b16 v[150:151], v202 offset:21288
    v_mfma_f32_16x16x32_bf16 v[168:171], v[104:107], v[36:39], v[168:171]
    ds_read_b64_tr_b16 v[152:153], v203 offset:20768
we_all_107:
wp_all_107:
    s_cmp_eq_u32 s43, 1
    s_cbranch_scc1 wr_0
    ds_read_b64_tr_b16 v[154:155], v203 offset:21280
    v_mfma_f32_16x16x32_bf16 v[172:175], v[108:111], v[36:39], v[172:175]
    buffer_load_dwordx4 v16, s[44:47], m0 offen offset:1024 lds
    ds_read_b64_tr_b16 v[156:157], v203 offset:20776
    ds_read_b64_tr_b16 v[158:159], v203 offset:21288
    s_waitcnt vmcnt(22)
    s_barrier
    v_mfma_f32_16x16x32_bf16 v[160:163], v[112:115], v[52:55], v[160:163]
    ds_read_b64_tr_b16 v[96:97], v200 offset:8256
    ds_read_b64_tr_b16 v[98:99], v200 offset:8768
    s_waitcnt lgkmcnt(15)
    v_mfma_f32_16x16x32_bf16 v[164:167], v[116:119], v[52:55], v[164:167]
    buffer_load_dwordx4 v16, s[44:47], m0 offen offset:2048 lds
    ds_read_b64_tr_b16 v[100:101], v200 offset:8264
    ds_read_b64_tr_b16 v[102:103], v200 offset:8776
    v_mfma_f32_16x16x32_bf16 v[168:171], v[120:123], v[52:55], v[168:171]
    ds_read_b64_tr_b16 v[104:105], v201 offset:8256
    ds_read_b64_tr_b16 v[106:107], v201 offset:8768
    v_mfma_f32_16x16x32_bf16 v[172:175], v[124:127], v[52:55], v[172:175]
    buffer_load_dwordx4 v16, s[44:47], m0 offen offset:3072 lds
    ds_read_b64_tr_b16 v[108:109], v201 offset:8264
    ds_read_b64_tr_b16 v[110:111], v201 offset:8776
    v_mfma_f32_16x16x32_bf16 v[160:163], v[128:131], v[68:71], v[160:163]
    ds_read_b64_tr_b16 v[112:113], v200 offset:24896
    ds_read_b64_tr_b16 v[114:115], v200 offset:25408
    v_mfma_f32_16x16x32_bf16 v[164:167], v[132:135], v[68:71], v[164:167]
    s_add_u32 m0, s23, 49152
    s_nop 0
    buffer_load_dwordx4 v16, s[44:47], m0 offen offset:0 lds
    ds_read_b64_tr_b16 v[116:117], v200 offset:24904
    ds_read_b64_tr_b16 v[118:119], v200 offset:25416
    s_waitcnt lgkmcnt(15)
    v_mfma_f32_16x16x32_bf16 v[168:171], v[136:139], v[68:71], v[168:171]
    ds_read_b64_tr_b16 v[120:121], v201 offset:24896
we_all_108:
wp_all_108:
    s_cmp_eq_u32 s43, 1
    s_cbranch_scc1 wr_0
    ds_read_b64_tr_b16 v[122:123], v201 offset:25408
    v_mfma_f32_16x16x32_bf16 v[172:175], v[140:143], v[68:71], v[172:175]
    buffer_load_dwordx4 v16, s[44:47], m0 offen offset:1024 lds
    ds_read_b64_tr_b16 v[124:125], v201 offset:24904
    ds_read_b64_tr_b16 v[126:127], v201 offset:25416
    v_dot2_f32_bf16 v206, v224, v232, 0
    v_dot2_f32_bf16 v206, v225, v233, v206
    v_dot2_f32_bf16 v206, v226, v234, v206
    v_dot2_f32_bf16 v206, v227, v235, v206
    v_dot2_f32_bf16 v206, v228, v236, v206
    v_dot2_f32_bf16 v206, v229, v237, v206
    v_dot2_f32_bf16 v206, v230, v238, v206
    v_dot2_f32_bf16 v206, v231, v239, v206
    v_lshlrev_b32 v176, 16, v224
    v_and_b32 v177, 0xffff0000, v224
    v_lshlrev_b32 v178, 16, v225
    v_and_b32 v179, 0xffff0000, v225
    v_lshlrev_b32 v180, 16, v226
    v_and_b32 v181, 0xffff0000, v226
    v_lshlrev_b32 v182, 16, v227
    v_and_b32 v183, 0xffff0000, v227
    v_lshlrev_b32 v184, 16, v228
    v_and_b32 v185, 0xffff0000, v228
    v_lshlrev_b32 v186, 16, v229
    v_and_b32 v187, 0xffff0000, v229
    v_lshlrev_b32 v188, 16, v230
    v_and_b32 v189, 0xffff0000, v230
    v_lshlrev_b32 v190, 16, v231
    v_and_b32 v191, 0xffff0000, v231
    v_mov_b32 v210, v206
    s_nop 1
    v_permlane32_swap_b32 v210, v206
    v_add_f32 v206, v206, v210
    v_mov_b32 v210, v206
    s_nop 1
    v_permlane16_swap_b32 v210, v206
    v_add_f32 v206, v206, v210
    v_mfma_f32_16x16x32_bf16 v[160:163], v[144:147], v[84:87], v[160:163]
    ds_read_b64_tr_b16 v[128:129], v202 offset:8256
we_all_109:
wp_all_109:
    s_cmp_eq_u32 s43, 1
    s_cbranch_scc1 wr_0
    ds_read_b64_tr_b16 v[130:131], v202 offset:8768
    v_mfma_f32_16x16x32_bf16 v[164:167], v[148:151], v[84:87], v[164:167]
    buffer_load_dwordx4 v16, s[44:47], m0 offen offset:2048 lds
    ds_read_b64_tr_b16 v[132:133], v202 offset:8264
    ds_read_b64_tr_b16 v[134:135], v202 offset:8776
    s_waitcnt lgkmcnt(15)
    v_mfma_f32_16x16x32_bf16 v[168:171], v[152:155], v[84:87], v[168:171]
    ds_read_b64_tr_b16 v[136:137], v203 offset:8256
    ds_read_b64_tr_b16 v[138:139], v203 offset:8768
    v_mfma_f32_16x16x32_bf16 v[172:175], v[156:159], v[84:87], v[172:175]
    buffer_load_dwordx4 v16, s[44:47], m0 offen offset:3072 lds
    ds_read_b64_tr_b16 v[140:141], v203 offset:8264
    ds_read_b64_tr_b16 v[142:143], v203 offset:8776
    s_waitcnt vmcnt(27)
    v_mfma_f32_16x16x32_bf16 v[160:163], v[96:99], v[40:43], v[160:163]
    ds_read_b64_tr_b16 v[144:145], v202 offset:24896
    ds_read_b64_tr_b16 v[146:147], v202 offset:25408
    v_mfma_f32_16x16x32_bf16 v[164:167], v[100:103], v[40:43], v[164:167]
    s_add_u32 m0, s23, 65536
    s_nop 0
    buffer_load_dwordx4 v16, s[44:47], m0 offen offset:0 lds
    ds_read_b64_tr_b16 v[148:149], v202 offset:24904
    ds_read_b64_tr_b16 v[150:151], v202 offset:25416
    s_waitcnt lgkmcnt(15)
    v_mfma_f32_16x16x32_bf16 v[168:171], v[104:107], v[40:43], v[168:171]
    ds_read_b64_tr_b16 v[152:153], v203 offset:24896
    ds_read_b64_tr_b16 v[154:155], v203 offset:25408
    v_mfma_f32_16x16x32_bf16 v[172:175], v[108:111], v[40:43], v[172:175]
    buffer_load_dwordx4 v16, s[44:47], m0 offen offset:1024 lds
    ds_read_b64_tr_b16 v[156:157], v203 offset:24904
    ds_read_b64_tr_b16 v[158:159], v203 offset:25416
    s_waitcnt vmcnt(0)
    s_barrier
    v_mfma_f32_16x16x32_bf16 v[160:163], v[112:115], v[56:59], v[160:163]
we_all_110:
wp_all_110:
    s_cmp_eq_u32 s43, 1
    s_cbranch_scc1 wr_0
    ds_read_b64_tr_b16 v[96:97], v200 offset:12384
    ds_read_b64_tr_b16 v[98:99], v200 offset:12896
    v_mfma_f32_16x16x32_bf16 v[164:167], v[116:119], v[56:59], v[164:167]
    buffer_load_dwordx4 v16, s[44:47], m0 offen offset:2048 lds
    ds_read_b64_tr_b16 v[100:101], v200 offset:12392
    ds_read_b64_tr_b16 v[102:103], v200 offset:12904
    s_waitcnt lgkmcnt(15)
    v_mfma_f32_16x16x32_bf16 v[168:171], v[120:123], v[56:59], v[168:171]
    ds_read_b64_tr_b16 v[104:105], v201 offset:12384
    ds_read_b64_tr_b16 v[106:107], v201 offset:12896
    v_mfma_f32_16x16x32_bf16 v[172:175], v[124:127], v[56:59], v[172:175]
    buffer_load_dwordx4 v16, s[44:47], m0 offen offset:3072 lds
    ds_read_b64_tr_b16 v[108:109], v201 offset:12392
    ds_read_b64_tr_b16 v[110:111], v201 offset:12904
    v_mfma_f32_16x16x32_bf16 v[160:163], v[128:131], v[72:75], v[160:163]
    ds_read_b64_tr_b16 v[112:113], v200 offset:29024
    ds_read_b64_tr_b16 v[114:115], v200 offset:29536
    v_mfma_f32_16x16x32_bf16 v[164:167], v[132:135], v[72:75], v[164:167]
    ds_read_b64_tr_b16 v[116:117], v200 offset:29032
    ds_read_b64_tr_b16 v[118:119], v200 offset:29544
    s_waitcnt lgkmcnt(15)
    v_mfma_f32_16x16x32_bf16 v[168:171], v[136:139], v[72:75], v[168:171]
    ds_read_b64_tr_b16 v[120:121], v201 offset:29024
    ds_read_b64_tr_b16 v[122:123], v201 offset:29536
    v_mfma_f32_16x16x32_bf16 v[172:175], v[140:143], v[72:75], v[172:175]
    ds_read_b64_tr_b16 v[124:125], v201 offset:29032
    ds_read_b64_tr_b16 v[126:127], v201 offset:29544
    v_mfma_f32_16x16x32_bf16 v[160:163], v[144:147], v[88:91], v[160:163]
    ds_read_b64_tr_b16 v[128:129], v202 offset:12384
    ds_read_b64_tr_b16 v[130:131], v202 offset:12896
    v_mfma_f32_16x16x32_bf16 v[164:167], v[148:151], v[88:91], v[164:167]
    ds_read_b64_tr_b16 v[132:133], v202 offset:12392
we_all_111:
wp_all_111:
    s_cmp_eq_u32 s43, 1
    s_cbranch_scc1 wr_0
    ds_read_b64_tr_b16 v[134:135], v202 offset:12904
    s_waitcnt lgkmcnt(15)
    v_mfma_f32_16x16x32_bf16 v[168:171], v[152:155], v[88:91], v[168:171]
    ds_read_b64_tr_b16 v[136:137], v203 offset:12384
    ds_read_b64_tr_b16 v[138:139], v203 offset:12896
    v_mfma_f32_16x16x32_bf16 v[172:175], v[156:159], v[88:91], v[172:175]
    ds_read_b64_tr_b16 v[140:141], v203 offset:12392
    ds_read_b64_tr_b16 v[142:143], v203 offset:12904
    v_mfma_f32_16x16x32_bf16 v[160:163], v[96:99], v[44:47], v[160:163]
    ds_read_b64_tr_b16 v[144:145], v202 offset:29024
    ds_read_b64_tr_b16 v[146:147], v202 offset:29536
    v_mfma_f32_16x16x32_bf16 v[164:167], v[100:103], v[44:47], v[164:167]
    ds_read_b64_tr_b16 v[148:149], v202 offset:29032
    ds_read_b64_tr_b16 v[150:151], v202 offset:29544
    s_waitcnt lgkmcnt(15)
    v_mfma_f32_16x16x32_bf16 v[168:171], v[104:107], v[44:47], v[168:171]
    ds_read_b64_tr_b16 v[152:153], v203 offset:29024
    ds_read_b64_tr_b16 v[154:155], v203 offset:29536
    v_mfma_f32_16x16x32_bf16 v[172:175], v[108:111], v[44:47], v[172:175]
    ds_read_b64_tr_b16 v[156:157], v203 offset:29032
    ds_read_b64_tr_b16 v[158:159], v203 offset:29544
    v_mfma_f32_16x16x32_bf16 v[160:163], v[112:115], v[60:63], v[160:163]
    v_mfma_f32_16x16x32_bf16 v[164:167], v[116:119], v[60:63], v[164:167]
    s_waitcnt lgkmcnt(15)
    v_mfma_f32_16x16x32_bf16 v[168:171], v[120:123], v[60:63], v[168:171]
    v_mfma_f32_16x16x32_bf16 v[172:175], v[124:127], v[60:63], v[172:175]
    s_waitcnt lgkmcnt(14)
    v_mfma_f32_16x16x32_bf16 v[160:163], v[128:131], v[76:79], v[160:163]
    s_waitcnt lgkmcnt(12)
    v_mfma_f32_16x16x32_bf16 v[164:167], v[132:135], v[76:79], v[164:167]
    s_waitcnt lgkmcnt(10)
    v_mfma_f32_16x16x32_bf16 v[168:171], v[136:139], v[76:79], v[168:171]
    s_waitcnt lgkmcnt(8)
    v_mfma_f32_16x16x32_bf16 v[172:175], v[140:143], v[76:79], v[172:175]
we_all_112:
wp_all_112:
    s_cmp_eq_u32 s43, 1
    s_cbranch_scc1 wr_0
    s_waitcnt lgkmcnt(6)
    v_mfma_f32_16x16x32_bf16 v[160:163], v[144:147], v[92:95], v[160:163]
    s_waitcnt lgkmcnt(4)
    v_mfma_f32_16x16x32_bf16 v[164:167], v[148:151], v[92:95], v[164:167]
    s_waitcnt lgkmcnt(2)
    v_mfma_f32_16x16x32_bf16 v[168:171], v[152:155], v[92:95], v[168:171]
    s_waitcnt lgkmcnt(0)
    v_mfma_f32_16x16x32_bf16 v[172:175], v[156:159], v[92:95], v[172:175]
    v_cvt_pk_bf16_f32 v112, v160, v161
    v_cvt_pk_bf16_f32 v113, v162, v163
    s_nop 1
    v_cvt_pk_bf16_f32 v114, v164, v165
    v_cvt_pk_bf16_f32 v115, v166, v167
    v_cvt_pk_bf16_f32 v116, v168, v169
    v_cvt_pk_bf16_f32 v117, v170, v171
    v_cvt_pk_bf16_f32 v118, v172, v173
    v_cvt_pk_bf16_f32 v119, v174, v175
    v_lshlrev_b32 v160, 16, v112
    v_and_b32 v161, 0xffff0000, v112
    v_lshlrev_b32 v162, 16, v113
    v_and_b32 v163, 0xffff0000, v113
    v_lshlrev_b32 v164, 16, v114
    v_and_b32 v165, 0xffff0000, v114
    v_lshlrev_b32 v166, 16, v115
    v_and_b32 v167, 0xffff0000, v115
    v_lshlrev_b32 v168, 16, v116
    v_and_b32 v169, 0xffff0000, v116
    v_lshlrev_b32 v170, 16, v117
    v_and_b32 v171, 0xffff0000, v117
    v_lshlrev_b32 v172, 16, v118
    v_and_b32 v173, 0xffff0000, v118
    v_lshlrev_b32 v174, 16, v119
    v_and_b32 v175, 0xffff0000, v119
    v_pk_add_f32 v[160:161], v[160:161], v[176:177]
    v_pk_add_f32 v[162:163], v[162:163], v[178:179]
    v_pk_add_f32 v[164:165], v[164:165], v[180:181]
    v_pk_add_f32 v[166:167], v[166:167], v[182:183]
    v_pk_add_f32 v[168:169], v[168:169], v[184:185]
we_all_113:
wp_all_113:
    s_cmp_eq_u32 s43, 1
    s_cbranch_scc1 wr_0
    v_pk_add_f32 v[170:171], v[170:171], v[186:187]
    v_pk_add_f32 v[172:173], v[172:173], v[188:189]
    v_pk_add_f32 v[174:175], v[174:175], v[190:191]
    v_cvt_pk_bf16_f32 v112, v160, v161
    v_cvt_pk_bf16_f32 v113, v162, v163
    v_cvt_pk_bf16_f32 v114, v164, v165
    v_cvt_pk_bf16_f32 v115, v166, v167
    v_cvt_pk_bf16_f32 v116, v168, v169
    v_cvt_pk_bf16_f32 v117, v170, v171
    v_cvt_pk_bf16_f32 v118, v172, v173
    v_cvt_pk_bf16_f32 v119, v174, v175
    buffer_store_dwordx4 v[112:115], v10, s[44:47], s12 offen offset:0 sc1
    buffer_store_dwordx4 v[116:119], v10, s[44:47], s12 offen offset:1024 sc1
    v_dot2_f32_bf16 v207, v112, v209, 0
    v_dot2_f32_bf16 v208, v112, v112, 0
    v_dot2_f32_bf16 v207, v113, v209, v207
    v_dot2_f32_bf16 v208, v113, v113, v208
    v_dot2_f32_bf16 v207, v114, v209, v207
    v_dot2_f32_bf16 v208, v114, v114, v208
    v_dot2_f32_bf16 v207, v115, v209, v207
    v_dot2_f32_bf16 v208, v115, v115, v208
    v_dot2_f32_bf16 v207, v116, v209, v207
    v_dot2_f32_bf16 v208, v116, v116, v208
    v_dot2_f32_bf16 v207, v117, v209, v207
    v_dot2_f32_bf16 v208, v117, v117, v208
    v_dot2_f32_bf16 v207, v118, v209, v207
    v_dot2_f32_bf16 v208, v118, v118, v208
    v_dot2_f32_bf16 v207, v119, v209, v207
    v_dot2_f32_bf16 v208, v119, v119, v208
    s_nop 1
    v_mov_b32 v210, v207
    s_nop 1
we_all_114:
wp_all_114:
    s_cmp_eq_u32 s43, 1
    s_cbranch_scc1 wr_0
    v_permlane32_swap_b32 v210, v207
    v_add_f32 v207, v207, v210
    v_mov_b32 v210, v207
    s_nop 1
    v_permlane16_swap_b32 v210, v207
    v_add_f32 v207, v207, v210
    v_mov_b32 v210, v208
    s_nop 1
    v_permlane32_swap_b32 v210, v208
    v_add_f32 v208, v208, v210
    v_mov_b32 v210, v208
    s_nop 1
    v_permlane16_swap_b32 v210, v208
    v_add_f32 v208, v208, v210
    v_cmp_eq_u32 vcc, 1, v4
    s_nop 1
    v_cndmask_b32 v207, v207, v208, vcc
    v_cmp_eq_u32 vcc, 2, v4
    s_nop 1
    v_cndmask_b32 v207, v207, v206, vcc
    buffer_store_dword v207, v211, s[44:47], s13 offen sc1
    ds_write_b128 v204, v[112:115]
    ds_write_b128 v205, v[116:119]
    s_waitcnt lgkmcnt(0)
    s_barrier
    s_add_u32 m0, s23, 81920
    s_nop 0
    buffer_load_dwordx4 v16, s[44:47], m0 offen offset:0 lds
    buffer_load_dwordx4 v16, s[44:47], m0 offen offset:1024 lds
    buffer_load_dwordx4 v16, s[44:47], m0 offen offset:2048 lds
    buffer_load_dwordx4 v16, s[44:47], m0 offen offset:3072 lds
    s_add_u32 m0, s23, 98304
    s_nop 0
    buffer_load_dwordx4 v16, s[44:47], m0 offen offset:0 lds
    buffer_load_dwordx4 v16, s[44:47], m0 offen offset:1024 lds
    buffer_load_dwordx4 v16, s[44:47], m0 offen offset:2048 lds
    buffer_load_dwordx4 v16, s[44:47], m0 offen offset:3072 lds
    s_mov_b32 m0, s35
    s_nop 0
    buffer_load_dwordx4 v16, s[44:47], m0 offen offset:0 lds
    buffer_load_dwordx4 v16, s[44:47], m0 offen offset:1024 lds
    buffer_load_dwordx4 v16, s[44:47], m0 offen offset:2048 lds
    buffer_load_dwordx4 v16, s[44:47], m0 offen offset:3072 lds
    s_waitcnt vmcnt(12)
    buffer_load_dwordx4 v[32:35], v17, s[44:47], s16 offen offset:0 sc1
we_all_115:
wp_all_115:
    s_cmp_eq_u32 s43, 1
    s_cbranch_scc1 wr_0
    buffer_load_dwordx4 v[36:39], v17, s[44:47], s16 offen offset:512 sc1
    buffer_load_dwordx4 v[40:43], v17, s[44:47], s16 offen offset:1024 sc1
    buffer_load_dwordx4 v[44:47], v17, s[44:47], s16 offen offset:1536 sc1
    buffer_load_dwordx4 v[48:51], v17, s[44:47], s17 offen offset:0 sc1
    buffer_load_dwordx4 v[52:55], v17, s[44:47], s17 offen offset:512 sc1
    buffer_load_dwordx4 v[56:59], v17, s[44:47], s17 offen offset:1024 sc1
    buffer_load_dwordx4 v[60:63], v17, s[44:47], s17 offen offset:1536 sc1
    buffer_load_dwordx4 v[64:67], v17, s[44:47], s18 offen offset:0 sc1
    buffer_load_dwordx4 v[68:71], v17, s[44:47], s18 offen offset:512 sc1
    buffer_load_dwordx4 v[72:75], v17, s[44:47], s18 offen offset:1024 sc1
    buffer_load_dwordx4 v[76:79], v17, s[44:47], s18 offen offset:1536 sc1
    buffer_load_dwordx4 v[80:83], v17, s[44:47], s19 offen offset:0 sc1
    buffer_load_dwordx4 v[84:87], v17, s[44:47], s19 offen offset:512 sc1
    buffer_load_dwordx4 v[88:91], v17, s[44:47], s19 offen offset:1024 sc1
    buffer_load_dwordx4 v[92:95], v17, s[44:47], s19 offen offset:1536 sc1
    buffer_load_dwordx4 v[96:99], v17, s[44:47], s20 offen offset:0 sc1
    buffer_load_dwordx4 v[100:103], v17, s[44:47], s20 offen offset:512 sc1
    buffer_load_dwordx4 v[104:107], v17, s[44:47], s20 offen offset:1024 sc1
    buffer_load_dwordx4 v[108:111], v17, s[44:47], s20 offen offset:1536 sc1
    buffer_load_dwordx4 v[112:115], v17, s[44:47], s21 offen offset:0 sc1
    buffer_load_dwordx4 v[116:119], v17, s[44:47], s21 offen offset:512 sc1
    buffer_load_dwordx4 v[120:123], v17, s[44:47], s21 offen offset:1024 sc1
    buffer_load_dwordx4 v[124:127], v17, s[44:47], s21 offen offset:1536 sc1
    buffer_load_dwordx4 v[128:131], v17, s[44:47], s22 offen offset:0 sc1
    buffer_load_dwordx4 v[132:135], v17, s[44:47], s22 offen offset:512 sc1
    buffer_load_dwordx4 v[136:139], v17, s[44:47], s22 offen offset:1024 sc1
    buffer_load_dwordx4 v[140:143], v17, s[44:47], s22 offen offset:1536 sc1
    s_waitcnt vmcnt(28)
    s_barrier
    v_lshl_add_u32 v24, s16, 2, v18
    ds_read_b128 a[208:211], v24 offset:0
    ds_read_b128 a[212:215], v24 offset:2048
we_all_116:
wp_all_116:
    s_cmp_eq_u32 s43, 1
    s_cbranch_scc1 wr_0
    v_lshl_add_u32 v25, s16, 2, v19
    ds_read_b128 a[216:219], v25 offset:0
    ds_read_b128 a[220:223], v24 offset:1024
    ds_read_b128 a[224:227], v24 offset:3072
    ds_read_b128 a[228:231], v25 offset:1024
    ds_read_b128 a[232:235], v24 offset:4096
    ds_read_b128 a[236:239], v24 offset:6144
    s_waitcnt vmcnt(25)
    v_max3_u32 v23, v32, v36, v40
    s_waitcnt vmcnt(24)
    v_max_u32 v23, v23, v44
    v_cmp_eq_u32 vcc, -1, v23
    s_nop 0
    s_or_b64 vcc, vcc, vcc
    s_cbranch_scc1 kf_kernel_x0_sl
kf_kernel_x0_bk:
    s_waitcnt lgkmcnt(6)
    v_mfma_f32_32x32x16_bf16 v[144:159], a[208:211], v[32:35], 0
    ds_read_b128 a[240:243], v25 offset:4096
    buffer_load_dwordx4 v[208:211], v20, s[44:47], 0 offen offset:0 sc1
    v_mfma_f32_32x32x16_bf16 v[160:175], a[212:215], v[32:35], 0
    ds_read_b128 a[244:247], v24 offset:5120
    s_waitcnt lgkmcnt(6)
    v_mfma_f32_32x32x16_bf16 v[176:191], a[216:219], v[32:35], 0
    ds_read_b128 a[248:251], v24 offset:7168
    buffer_load_dwordx4 v[212:215], v20, s[44:47], 0 offen offset:256 sc1
    v_mfma_f32_32x32x16_bf16 v[144:159], a[220:223], v[36:39], v[144:159]
    ds_read_b128 a[252:255], v25 offset:5120
    s_waitcnt lgkmcnt(6)
    v_mfma_f32_32x32x16_bf16 v[160:175], a[224:227], v[36:39], v[160:175]
    v_lshl_add_u32 v24, s17, 2, v18
    ds_read_b128 a[208:211], v24 offset:0
    s_add_u32 m0, s23, 122880
    s_add_u32 s73, s36, 0
    buffer_load_dwordx4 v10, s[44:47], s73 offen offset:0 lds
    v_mfma_f32_32x32x16_bf16 v[176:191], a[228:231], v[36:39], v[176:191]
    ds_read_b128 a[212:215], v24 offset:2048
we_all_117:
wp_all_117:
    s_cmp_eq_u32 s43, 1
    s_cbranch_scc1 wr_0
    s_waitcnt lgkmcnt(6)
    v_mfma_f32_32x32x16_bf16 v[144:159], a[232:235], v[40:43], v[144:159]
    v_lshl_add_u32 v25, s17, 2, v19
    ds_read_b128 a[216:219], v25 offset:0
    buffer_load_dwordx4 v10, s[44:47], s73 offen offset:1024 lds
    v_mfma_f32_32x32x16_bf16 v[160:175], a[236:239], v[40:43], v[160:175]
    ds_read_b128 a[220:223], v24 offset:1024
    s_waitcnt lgkmcnt(6)
    v_mfma_f32_32x32x16_bf16 v[176:191], a[240:243], v[40:43], v[176:191]
    ds_read_b128 a[224:227], v24 offset:3072
    buffer_load_dwordx4 v10, s[44:47], s73 offen offset:2048 lds
    v_mfma_f32_32x32x16_bf16 v[144:159], a[244:247], v[44:47], v[144:159]
    ds_read_b128 a[228:231], v25 offset:1024
    s_waitcnt vmcnt(26)
    v_max3_u32 v23, v48, v52, v56
    s_waitcnt vmcnt(25)
    v_max_u32 v23, v23, v60
    v_cmp_eq_u32 vcc, -1, v23
    s_nop 0
    s_or_b64 vcc, vcc, vcc
    s_cbranch_scc1 kf_kernel_x1_sl
kf_kernel_x1_bk:
    s_waitcnt lgkmcnt(6)
    v_mfma_f32_32x32x16_bf16 v[160:175], a[248:251], v[44:47], v[160:175]
    ds_read_b128 a[232:235], v24 offset:4096
    buffer_load_dwordx4 v10, s[44:47], s73 offen offset:3072 lds
    v_mfma_f32_32x32x16_bf16 v[176:191], a[252:255], v[44:47], v[176:191]
    ds_read_b128 a[236:239], v24 offset:6144
    s_waitcnt lgkmcnt(6)
    v_mfma_f32_32x32x16_bf16 v[144:159], a[208:211], v[48:51], v[144:159]
    ds_read_b128 a[240:243], v25 offset:4096
    s_add_u32 m0, s23, 139264
    s_add_u32 s73, s36, 16384
    buffer_load_dwordx4 v10, s[44:47], s73 offen offset:0 lds
    v_mfma_f32_32x32x16_bf16 v[160:175], a[212:215], v[48:51], v[160:175]
    ds_read_b128 a[244:247], v24 offset:5120
    s_waitcnt lgkmcnt(6)
    v_mfma_f32_32x32x16_bf16 v[176:191], a[216:219], v[48:51], v[176:191]
we_all_118:
wp_all_118:
    s_cmp_eq_u32 s43, 1
    s_cbranch_scc1 wr_0
    ds_read_b128 a[248:251], v24 offset:7168
    buffer_load_dwordx4 v10, s[44:47], s73 offen offset:1024 lds
    v_mfma_f32_32x32x16_bf16 v[144:159], a[220:223], v[52:55], v[144:159]
    ds_read_b128 a[252:255], v25 offset:5120
    s_waitcnt lgkmcnt(6)
    v_mfma_f32_32x32x16_bf16 v[160:175], a[224:227], v[52:55], v[160:175]
    v_lshl_add_u32 v24, s18, 2, v18
    ds_read_b128 a[208:211], v24 offset:0
    buffer_load_dwordx4 v10, s[44:47], s73 offen offset:2048 lds
    v_mfma_f32_32x32x16_bf16 v[176:191], a[228:231], v[52:55], v[176:191]
    ds_read_b128 a[212:215], v24 offset:2048
    s_waitcnt lgkmcnt(6)
    v_mfma_f32_32x32x16_bf16 v[144:159], a[232:235], v[56:59], v[144:159]
    v_lshl_add_u32 v25, s18, 2, v19
    ds_read_b128 a[216:219], v25 offset:0
    buffer_load_dwordx4 v10, s[44:47], s73 offen offset:3072 lds
    v_mfma_f32_32x32x16_bf16 v[160:175], a[236:239], v[56:59], v[160:175]
    ds_read_b128 a[220:223], v24 offset:1024
    s_waitcnt lgkmcnt(6)
    v_mfma_f32_32x32x16_bf16 v[176:191], a[240:243], v[56:59], v[176:191]
    ds_read_b128 a[224:227], v24 offset:3072
    buffer_load_dwordx4 a[0:3], v10, s[44:47], s28 offen offset:0
    v_mfma_f32_32x32x16_bf16 v[144:159], a[244:247], v[60:63], v[144:159]
    ds_read_b128 a[228:231], v25 offset:1024
    s_waitcnt vmcnt(28)
    v_max3_u32 v23, v64, v68, v72
    s_waitcnt vmcnt(27)
    v_max_u32 v23, v23, v76
    v_cmp_eq_u32 vcc, -1, v23
    s_nop 0
    s_or_b64 vcc, vcc, vcc
    s_cbranch_scc1 kf_kernel_x2_sl
kf_kernel_x2_bk:
    s_waitcnt lgkmcnt(6)
    v_mfma_f32_32x32x16_bf16 v[160:175], a[248:251], v[60:63], v[160:175]
    ds_read_b128 a[232:235], v24 offset:4096
    buffer_load_dwordx4 a[4:7], v10, s[44:47], s28 offen offset:1024
    v_mfma_f32_32x32x16_bf16 v[176:191], a[252:255], v[60:63], v[176:191]
we_all_119:
wp_all_119:
    s_cmp_eq_u32 s43, 1
    s_cbranch_scc1 wr_0
    ds_read_b128 a[236:239], v24 offset:6144
    s_waitcnt lgkmcnt(6)
    v_mfma_f32_32x32x16_bf16 v[144:159], a[208:211], v[64:67], v[144:159]
    ds_read_b128 a[240:243], v25 offset:4096
    buffer_load_dwordx4 a[8:11], v10, s[44:47], s28 offen offset:2048
    v_mfma_f32_32x32x16_bf16 v[160:175], a[212:215], v[64:67], v[160:175]
    ds_read_b128 a[244:247], v24 offset:5120
    s_waitcnt lgkmcnt(6)
    v_mfma_f32_32x32x16_bf16 v[176:191], a[216:219], v[64:67], v[176:191]
    ds_read_b128 a[248:251], v24 offset:7168
    buffer_load_dwordx4 a[12:15], v10, s[44:47], s28 offen offset:3072
    v_mfma_f32_32x32x16_bf16 v[144:159], a[220:223], v[68:71], v[144:159]
    ds_read_b128 a[252:255], v25 offset:5120
    s_waitcnt lgkmcnt(6)
    v_mfma_f32_32x32x16_bf16 v[160:175], a[224:227], v[68:71], v[160:175]
    v_lshl_add_u32 v24, s19, 2, v18
    ds_read_b128 a[208:211], v24 offset:0
    buffer_load_dwordx4 a[16:19], v10, s[44:47], s29 offen offset:0
    v_mfma_f32_32x32x16_bf16 v[176:191], a[228:231], v[68:71], v[176:191]
    ds_read_b128 a[212:215], v24 offset:2048
    s_waitcnt lgkmcnt(6)
    v_mfma_f32_32x32x16_bf16 v[144:159], a[232:235], v[72:75], v[144:159]
    v_lshl_add_u32 v25, s19, 2, v19
    ds_read_b128 a[216:219], v25 offset:0
    buffer_load_dwordx4 a[20:23], v10, s[44:47], s29 offen offset:1024
    v_mfma_f32_32x32x16_bf16 v[160:175], a[236:239], v[72:75], v[160:175]
    ds_read_b128 a[220:223], v24 offset:1024
    s_waitcnt lgkmcnt(6)
    v_mfma_f32_32x32x16_bf16 v[176:191], a[240:243], v[72:75], v[176:191]
    ds_read_b128 a[224:227], v24 offset:3072
    buffer_load_dwordx4 a[24:27], v10, s[44:47], s29 offen offset:2048
    v_mfma_f32_32x32x16_bf16 v[144:159], a[244:247], v[76:79], v[144:159]
    ds_read_b128 a[228:231], v25 offset:1024
we_all_120:
wp_all_120:
    s_cmp_eq_u32 s43, 1
    s_cbranch_scc1 wr_0
    s_waitcnt vmcnt(30)
    v_max3_u32 v23, v80, v84, v88
    s_waitcnt vmcnt(29)
    v_max_u32 v23, v23, v92
    v_cmp_eq_u32 vcc, -1, v23
    s_nop 0
    s_or_b64 vcc, vcc, vcc
    s_cbranch_scc1 kf_kernel_x3_sl
kf_kernel_x3_bk:
    s_waitcnt lgkmcnt(6)
    v_mfma_f32_32x32x16_bf16 v[160:175], a[248:251], v[76:79], v[160:175]
    ds_read_b128 a[232:235], v24 offset:4096
    buffer_load_dwordx4 a[28:31], v10, s[44:47], s29 offen offset:3072
    v_mfma_f32_32x32x16_bf16 v[176:191], a[252:255], v[76:79], v[176:191]
    ds_read_b128 a[236:239], v24 offset:6144
    s_waitcnt lgkmcnt(6)
    v_mfma_f32_32x32x16_bf16 v[144:159], a[208:211], v[80:83], v[144:159]
    ds_read_b128 a[240:243], v25 offset:4096
    buffer_load_dwordx4 a[32:35], v10, s[44:47], s30 offen offset:0
    v_mfma_f32_32x32x16_bf16 v[160:175], a[212:215], v[80:83], v[160:175]
    ds_read_b128 a[244:247], v24 offset:5120
    s_waitcnt lgkmcnt(6)
    v_mfma_f32_32x32x16_bf16 v[176:191], a[216:219], v[80:83], v[176:191]
    ds_read_b128 a[248:251], v24 offset:7168
    buffer_load_dwordx4 a[36:39], v10, s[44:47], s30 offen offset:1024
    v_mfma_f32_32x32x16_bf16 v[144:159], a[220:223], v[84:87], v[144:159]
    ds_read_b128 a[252:255], v25 offset:5120
    s_waitcnt lgkmcnt(6)
    v_mfma_f32_32x32x16_bf16 v[160:175], a[224:227], v[84:87], v[160:175]
    v_lshl_add_u32 v24, s20, 2, v18
    ds_read_b128 a[208:211], v24 offset:0
    buffer_load_dwordx4 a[40:43], v10, s[44:47], s30 offen offset:2048
    v_mfma_f32_32x32x16_bf16 v[176:191], a[228:231], v[84:87], v[176:191]
    ds_read_b128 a[212:215], v24 offset:2048
    s_waitcnt lgkmcnt(6)
    v_mfma_f32_32x32x16_bf16 v[144:159], a[232:235], v[88:91], v[144:159]
    v_lshl_add_u32 v25, s20, 2, v19
    ds_read_b128 a[216:219], v25 offset:0
we_all_121:
wp_all_121:
    s_cmp_eq_u32 s43, 1
    s_cbranch_scc1 wr_0
    buffer_load_dwordx4 a[44:47], v10, s[44:47], s30 offen offset:3072
    s_waitcnt vmcnt(21)
    v_add_f32 v216, v208, v209
    v_add_f32 v217, v210, v211
    s_waitcnt vmcnt(20)
    v_add_f32 v218, v212, v213
    v_add_f32 v216, v216, v217
    v_add_f32 v218, v218, v214
    v_add_f32 v216, v216, v218
    v_cmp_u_f32 vcc, v216, v216
    s_nop 0
    s_or_b64 vcc, vcc, vcc
    s_cbranch_scc1 kf_kernel_stc_sl
kf_kernel_stc_bk:
    v_mfma_f32_32x32x16_bf16 v[160:175], a[236:239], v[88:91], v[160:175]
    ds_read_b128 a[220:223], v24 offset:1024
    v_mov_b32 v217, v216
    s_nop 1
    v_permlane32_swap_b32 v216, v217
    v_mul_f32 v216, 0x3b124925, v216
    s_waitcnt lgkmcnt(6)
    v_mfma_f32_32x32x16_bf16 v[176:191], a[240:243], v[88:91], v[176:191]
    ds_read_b128 a[224:227], v24 offset:3072
    buffer_load_dwordx4 a[48:51], v10, s[44:47], s31 offen offset:0
    v_mul_f32 v217, 0x3b124925, v217
    v_fma_f32 v217, -v216, v216, v217
    v_mfma_f32_32x32x16_bf16 v[144:159], a[244:247], v[92:95], v[144:159]
    ds_read_b128 a[228:231], v25 offset:1024
    v_max_f32 v217, 0, v217
    v_cvt_pk_bf16_f32 v28, -v216, -v216
    v_cvt_pk_bf16_f32 v217, v217, v217
    v_mov_b32 v29, v28
    v_max3_u32 v23, v96, v100, v104
    v_max_u32 v23, v23, v108
    v_cmp_eq_u32 vcc, -1, v23
    s_nop 0
    s_or_b64 vcc, vcc, vcc
    s_cbranch_scc1 kf_kernel_x4_sl
kf_kernel_x4_bk:
    s_waitcnt lgkmcnt(6)
    v_mfma_f32_32x32x16_bf16 v[160:175], a[248:251], v[92:95], v[160:175]
    ds_read_b128 a[232:235], v24 offset:4096
    buffer_load_dwordx4 a[52:55], v10, s[44:47], s31 offen offset:1024
    v_lshlrev_b32 v217, 16, v217
    v_mov_b32 v30, v28
    v_mfma_f32_32x32x16_bf16 v[176:191], a[252:255], v[92:95], v[176:191]
we_all_122:
wp_all_122:
    s_cmp_eq_u32 s43, 1
    s_cbranch_scc1 wr_0
    ds_read_b128 a[236:239], v24 offset:6144
    v_add_f32 v217, 0x3727c5ac, v217
    v_mov_b32 v31, v28
    v_cvt_pk_bf16_f32 v217, v217, v217
    v_lshlrev_b32 v217, 16, v217
    s_waitcnt lgkmcnt(6)
    v_mfma_f32_32x32x16_bf16 v[144:159], a[208:211], v[96:99], v[144:159]
    ds_read_b128 a[240:243], v25 offset:4096
    buffer_load_dwordx4 a[56:59], v10, s[44:47], s31 offen offset:2048
    v_sqrt_f32 v217, v217
    v_mfma_f32_32x32x16_bf16 v[160:175], a[212:215], v[96:99], v[160:175]
    ds_read_b128 a[244:247], v24 offset:5120
    v_cvt_pk_bf16_f32 v217, v217, v217
    v_lshlrev_b32 v244, 16, v217
    v_rcp_f32 v218, v244
    s_waitcnt lgkmcnt(6)
    v_mfma_f32_32x32x16_bf16 v[176:191], a[216:219], v[96:99], v[176:191]
    ds_read_b128 a[248:251], v24 offset:7168
    buffer_load_dwordx4 a[60:63], v10, s[44:47], s31 offen offset:3072
    v_mov_b32 v245, v244
    v_mul_f32 v240, 0xc0135761, v218
    v_mfma_f32_32x32x16_bf16 v[144:159], a[220:223], v[100:103], v[144:159]
    ds_read_b128 a[252:255], v25 offset:5120
    v_mul_f32 v219, v218, v218
    v_mov_b32 v241, v240
    v_mul_f32 v219, v219, v218
    v_mul_f32 v242, 0xbdd2d3e8, v219
    s_waitcnt lgkmcnt(6)
    v_mfma_f32_32x32x16_bf16 v[160:175], a[224:227], v[100:103], v[160:175]
    v_lshl_add_u32 v24, s21, 2, v18
    ds_read_b128 a[208:211], v24 offset:0
    buffer_load_dwordx4 a[64:67], v11, s[44:47], s28 offen offset:0
    v_mov_b32 v243, v242
    v_mfma_f32_32x32x16_bf16 v[176:191], a[228:231], v[100:103], v[176:191]
    ds_read_b128 a[212:215], v24 offset:2048
    s_waitcnt lgkmcnt(6)
    v_mfma_f32_32x32x16_bf16 v[144:159], a[232:235], v[104:107], v[144:159]
    v_lshl_add_u32 v25, s21, 2, v19
we_all_123:
wp_all_123:
    s_cmp_eq_u32 s43, 1
    s_cbranch_scc1 wr_0
    ds_read_b128 a[216:219], v25 offset:0
    buffer_load_dwordx4 a[68:71], v11, s[44:47], s28 offen offset:1024
    v_mfma_f32_32x32x16_bf16 v[160:175], a[236:239], v[104:107], v[160:175]
    ds_read_b128 a[220:223], v24 offset:1024
    s_waitcnt lgkmcnt(6)
    v_mfma_f32_32x32x16_bf16 v[176:191], a[240:243], v[104:107], v[176:191]
    ds_read_b128 a[224:227], v24 offset:3072
    buffer_load_dwordx4 a[72:75], v11, s[44:47], s28 offen offset:2048
    v_mfma_f32_32x32x16_bf16 v[144:159], a[244:247], v[108:111], v[144:159]
    ds_read_b128 a[228:231], v25 offset:1024
    v_max3_u32 v23, v112, v116, v120
    v_max_u32 v23, v23, v124
    v_cmp_eq_u32 vcc, -1, v23
    s_nop 0
    s_or_b64 vcc, vcc, vcc
    s_cbranch_scc1 kf_kernel_x5_sl
kf_kernel_x5_bk:
    s_waitcnt lgkmcnt(6)
    v_mfma_f32_32x32x16_bf16 v[160:175], a[248:251], v[108:111], v[160:175]
    ds_read_b128 a[232:235], v24 offset:4096
    buffer_load_dwordx4 a[76:79], v11, s[44:47], s28 offen offset:3072
    v_mfma_f32_32x32x16_bf16 v[176:191], a[252:255], v[108:111], v[176:191]
    ds_read_b128 a[236:239], v24 offset:6144
    s_waitcnt lgkmcnt(6)
    v_mfma_f32_32x32x16_bf16 v[144:159], a[208:211], v[112:115], v[144:159]
    ds_read_b128 a[240:243], v25 offset:4096
    buffer_load_dwordx4 a[80:83], v11, s[44:47], s29 offen offset:0
    v_mfma_f32_32x32x16_bf16 v[160:175], a[212:215], v[112:115], v[160:175]
    ds_read_b128 a[244:247], v24 offset:5120
    s_waitcnt lgkmcnt(6)
    v_mfma_f32_32x32x16_bf16 v[176:191], a[216:219], v[112:115], v[176:191]
    ds_read_b128 a[248:251], v24 offset:7168
    buffer_load_dwordx4 a[84:87], v11, s[44:47], s29 offen offset:1024
    v_mfma_f32_32x32x16_bf16 v[144:159], a[220:223], v[116:119], v[144:159]
    ds_read_b128 a[252:255], v25 offset:5120
    s_waitcnt lgkmcnt(6)
    v_mfma_f32_32x32x16_bf16 v[160:175], a[224:227], v[116:119], v[160:175]
we_all_124:
wp_all_124:
    s_cmp_eq_u32 s43, 1
    s_cbranch_scc1 wr_0
    v_lshl_add_u32 v24, s22, 2, v18
    ds_read_b128 a[208:211], v24 offset:0
    buffer_load_dwordx4 a[88:91], v11, s[44:47], s29 offen offset:2048
    v_mfma_f32_32x32x16_bf16 v[176:191], a[228:231], v[116:119], v[176:191]
    ds_read_b128 a[212:215], v24 offset:2048
    s_waitcnt lgkmcnt(6)
    v_mfma_f32_32x32x16_bf16 v[144:159], a[232:235], v[120:123], v[144:159]
    v_lshl_add_u32 v25, s22, 2, v19
    ds_read_b128 a[216:219], v25 offset:0
    buffer_load_dwordx4 a[92:95], v11, s[44:47], s29 offen offset:3072
    v_mfma_f32_32x32x16_bf16 v[160:175], a[236:239], v[120:123], v[160:175]
    ds_read_b128 a[220:223], v24 offset:1024
    s_waitcnt lgkmcnt(6)
    v_mfma_f32_32x32x16_bf16 v[176:191], a[240:243], v[120:123], v[176:191]
    ds_read_b128 a[224:227], v24 offset:3072
    buffer_load_dwordx4 a[96:99], v11, s[44:47], s30 offen offset:0
    v_mfma_f32_32x32x16_bf16 v[144:159], a[244:247], v[124:127], v[144:159]
    ds_read_b128 a[228:231], v25 offset:1024
    v_max3_u32 v23, v128, v132, v136
    v_max_u32 v23, v23, v140
    v_cmp_eq_u32 vcc, -1, v23
    s_nop 0
    s_or_b64 vcc, vcc, vcc
    s_cbranch_scc1 kf_kernel_x6_sl
kf_kernel_x6_bk:
    s_waitcnt lgkmcnt(6)
    v_mfma_f32_32x32x16_bf16 v[160:175], a[248:251], v[124:127], v[160:175]
    ds_read_b128 a[232:235], v24 offset:4096
    buffer_load_dwordx4 a[100:103], v11, s[44:47], s30 offen offset:1024
    v_mfma_f32_32x32x16_bf16 v[176:191], a[252:255], v[124:127], v[176:191]
    ds_read_b128 a[236:239], v24 offset:6144
    s_waitcnt lgkmcnt(6)
    v_mfma_f32_32x32x16_bf16 v[144:159], a[208:211], v[128:131], v[144:159]
    ds_read_b128 a[240:243], v25 offset:4096
    buffer_load_dwordx4 a[104:107], v11, s[44:47], s30 offen offset:2048
    v_mfma_f32_32x32x16_bf16 v[160:175], a[212:215], v[128:131], v[160:175]
    ds_read_b128 a[244:247], v24 offset:5120
we_all_125:
wp_all_125:
    s_cmp_eq_u32 s43, 1
    s_cbranch_scc1 wr_0
    s_waitcnt lgkmcnt(6)
    v_mfma_f32_32x32x16_bf16 v[176:191], a[216:219], v[128:131], v[176:191]
    ds_read_b128 a[248:251], v24 offset:7168
    buffer_load_dwordx4 a[108:111], v11, s[44:47], s30 offen offset:3072
    v_mfma_f32_32x32x16_bf16 v[144:159], a[220:223], v[132:135], v[144:159]
    ds_read_b128 a[252:255], v25 offset:5120
    s_waitcnt lgkmcnt(6)
    v_mfma_f32_32x32x16_bf16 v[160:175], a[224:227], v[132:135], v[160:175]
    ds_read_b128 a[208:211], v10 offset:57344
    buffer_load_dwordx4 a[112:115], v12, s[44:47], s28 offen offset:0
    v_mfma_f32_32x32x16_bf16 v[176:191], a[228:231], v[132:135], v[176:191]
    ds_read_b128 a[212:215], v10 offset:59392
    s_waitcnt lgkmcnt(6)
    v_mfma_f32_32x32x16_bf16 v[144:159], a[232:235], v[136:139], v[144:159]
    ds_read_b128 a[216:219], v14 offset:4096
    buffer_load_dwordx4 a[116:119], v12, s[44:47], s28 offen offset:1024
    v_mfma_f32_32x32x16_bf16 v[160:175], a[236:239], v[136:139], v[160:175]
    ds_read_b128 a[220:223], v10 offset:58368
    s_waitcnt lgkmcnt(6)
    v_mfma_f32_32x32x16_bf16 v[176:191], a[240:243], v[136:139], v[176:191]
    ds_read_b128 a[224:227], v10 offset:60416
    buffer_load_dwordx4 a[120:123], v12, s[44:47], s28 offen offset:2048
    v_mfma_f32_32x32x16_bf16 v[144:159], a[244:247], v[140:143], v[144:159]
    ds_read_b128 a[228:231], v14 offset:5120
    s_waitcnt lgkmcnt(6)
    v_mfma_f32_32x32x16_bf16 v[160:175], a[248:251], v[140:143], v[160:175]
    v_lshl_add_u32 v25, s16, 2, v19
    ds_read_b128 a[232:235], v25 offset:2048
    buffer_load_dwordx4 a[124:127], v12, s[44:47], s28 offen offset:3072
    v_mfma_f32_32x32x16_bf16 v[176:191], a[252:255], v[140:143], v[176:191]
    ds_read_b128 a[236:239], v25 offset:3072
    s_waitcnt lgkmcnt(6)
    v_mfma_f32_32x32x16_bf16 v[144:159], a[208:211], v[28:31], v[144:159]
    ds_read_b128 a[240:243], v25 offset:6144
we_all_126:
wp_all_126:
    s_cmp_eq_u32 s43, 1
    s_cbranch_scc1 wr_0
    buffer_load_dwordx4 a[128:131], v12, s[44:47], s29 offen offset:0
    v_mfma_f32_32x32x16_bf16 v[160:175], a[212:215], v[28:31], v[160:175]
    ds_read_b128 a[244:247], v25 offset:7168
    s_waitcnt lgkmcnt(6)
    v_mfma_f32_32x32x16_bf16 v[176:191], a[216:219], v[28:31], v[176:191]
    v_lshl_add_u32 v25, s17, 2, v19
    ds_read_b128 a[248:251], v25 offset:2048
    buffer_load_dwordx4 a[132:135], v12, s[44:47], s29 offen offset:1024
    v_mfma_f32_32x32x16_bf16 v[144:159], a[220:223], v[28:31], v[144:159]
    ds_read_b128 a[252:255], v25 offset:3072
    s_waitcnt lgkmcnt(6)
    v_mfma_f32_32x32x16_bf16 v[160:175], a[224:227], v[28:31], v[160:175]
    ds_read_b128 a[208:211], v25 offset:6144
    buffer_load_dwordx4 a[136:139], v12, s[44:47], s29 offen offset:2048
    v_mfma_f32_32x32x16_bf16 v[176:191], a[228:231], v[28:31], v[176:191]
    ds_read_b128 a[212:215], v25 offset:7168
    s_waitcnt lgkmcnt(6)
    v_mfma_f32_32x32x16_bf16 v[192:207], a[232:235], v[32:35], 0
    v_lshl_add_u32 v25, s18, 2, v19
    ds_read_b128 a[216:219], v25 offset:2048
    buffer_load_dwordx4 a[140:143], v12, s[44:47], s29 offen offset:3072
    v_mfma_f32_32x32x16_bf16 v[192:207], a[236:239], v[36:39], v[192:207]
    ds_read_b128 a[220:223], v25 offset:3072
    s_waitcnt lgkmcnt(6)
    v_mfma_f32_32x32x16_bf16 v[192:207], a[240:243], v[40:43], v[192:207]
    ds_read_b128 a[224:227], v25 offset:6144
    v_mul_f32 v208, v144, v144
    v_mul_f32 v209, v145, v145
    v_fma_f32 v208, v208, v242, v240
    v_mfma_f32_32x32x16_bf16 v[192:207], a[244:247], v[44:47], v[192:207]
    ds_read_b128 a[228:231], v25 offset:7168
    v_fma_f32 v209, v209, v242, v240
    v_mul_f32 v210, v146, v146
    v_mul_f32 v211, v147, v147
    v_mul_f32 v208, v208, v144
we_all_127:
wp_all_127:
    s_cmp_eq_u32 s43, 1
    s_cbranch_scc1 wr_0
    s_waitcnt lgkmcnt(6)
    v_mfma_f32_32x32x16_bf16 v[192:207], a[248:251], v[48:51], v[192:207]
    v_lshl_add_u32 v25, s19, 2, v19
    ds_read_b128 a[232:235], v25 offset:2048
    v_mul_f32 v209, v209, v145
    v_fma_f32 v210, v210, v242, v240
    v_mfma_f32_32x32x16_bf16 v[192:207], a[252:255], v[52:55], v[192:207]
    ds_read_b128 a[236:239], v25 offset:3072
    v_fma_f32 v211, v211, v242, v240
    v_mul_f32 v212, v148, v148
    v_mul_f32 v213, v149, v149
    v_exp_f32 v208, v208
    s_waitcnt lgkmcnt(6)
    v_mfma_f32_32x32x16_bf16 v[192:207], a[208:211], v[56:59], v[192:207]
    ds_read_b128 a[240:243], v25 offset:6144
    v_exp_f32 v209, v209
    v_mul_f32 v210, v210, v146
    v_mfma_f32_32x32x16_bf16 v[192:207], a[212:215], v[60:63], v[192:207]
    ds_read_b128 a[244:247], v25 offset:7168
    v_mul_f32 v211, v211, v147
    v_fma_f32 v212, v212, v242, v240
    v_fma_f32 v213, v213, v242, v240
    v_mul_f32 v214, v150, v150
    s_waitcnt lgkmcnt(6)
    v_mfma_f32_32x32x16_bf16 v[192:207], a[216:219], v[64:67], v[192:207]
    v_lshl_add_u32 v25, s20, 2, v19
    ds_read_b128 a[248:251], v25 offset:2048
    v_mul_f32 v215, v151, v151
    v_fma_f32 v208, v208, v244, v244
    v_mfma_f32_32x32x16_bf16 v[192:207], a[220:223], v[68:71], v[192:207]
    ds_read_b128 a[252:255], v25 offset:3072
    v_fma_f32 v209, v209, v244, v244
    v_exp_f32 v210, v210
    v_exp_f32 v211, v211
    buffer_load_dword v248, v22, s[44:47], 0 offen offset:0 sc1
    s_waitcnt lgkmcnt(6)
    v_mfma_f32_32x32x16_bf16 v[192:207], a[224:227], v[72:75], v[192:207]
    ds_read_b128 a[208:211], v25 offset:6144
    v_mul_f32 v212, v212, v148
we_all_128:
wp_all_128:
    s_cmp_eq_u32 s43, 1
    s_cbranch_scc1 wr_0
    v_mul_f32 v213, v213, v149
    v_fma_f32 v214, v214, v242, v240
    v_mfma_f32_32x32x16_bf16 v[192:207], a[228:231], v[76:79], v[192:207]
    ds_read_b128 a[212:215], v25 offset:7168
    v_fma_f32 v215, v215, v242, v240
    v_mul_f32 v216, v152, v152
    v_mul_f32 v217, v153, v153
    v_rcp_f32 v208, v208
    s_waitcnt lgkmcnt(6)
    v_mfma_f32_32x32x16_bf16 v[192:207], a[232:235], v[80:83], v[192:207]
    v_lshl_add_u32 v25, s21, 2, v19
    ds_read_b128 a[216:219], v25 offset:2048
    v_rcp_f32 v209, v209
    v_mfma_f32_32x32x16_bf16 v[192:207], a[236:239], v[84:87], v[192:207]
    ds_read_b128 a[220:223], v25 offset:3072
    v_fma_f32 v210, v210, v244, v244
    v_fma_f32 v211, v211, v244, v244
    v_exp_f32 v212, v212
    s_waitcnt lgkmcnt(6)
    v_mfma_f32_32x32x16_bf16 v[192:207], a[240:243], v[88:91], v[192:207]
    ds_read_b128 a[224:227], v25 offset:6144
    v_exp_f32 v213, v213
    v_mul_f32 v214, v214, v150
    v_mfma_f32_32x32x16_bf16 v[192:207], a[244:247], v[92:95], v[192:207]
    ds_read_b128 a[228:231], v25 offset:7168
    v_mul_f32 v215, v215, v151
    v_fma_f32 v216, v216, v242, v240
    v_fma_f32 v217, v217, v242, v240
    v_mul_f32 v218, v154, v154
    s_waitcnt lgkmcnt(6)
    v_mfma_f32_32x32x16_bf16 v[192:207], a[248:251], v[96:99], v[192:207]
    v_lshl_add_u32 v25, s22, 2, v19
    ds_read_b128 a[232:235], v25 offset:2048
    v_mul_f32 v219, v155, v155
    v_mul_f32 v144, v144, v208
    v_mfma_f32_32x32x16_bf16 v[192:207], a[252:255], v[100:103], v[192:207]
    ds_read_b128 a[236:239], v25 offset:3072
    v_mul_f32 v145, v145, v209
    v_rcp_f32 v210, v210
    v_rcp_f32 v211, v211
we_all_129:
wp_all_129:
    s_cmp_eq_u32 s43, 1
    s_cbranch_scc1 wr_0
    s_waitcnt lgkmcnt(6)
    v_mfma_f32_32x32x16_bf16 v[192:207], a[208:211], v[104:107], v[192:207]
    ds_read_b128 a[240:243], v25 offset:6144
    v_fma_f32 v212, v212, v244, v244
    v_fma_f32 v213, v213, v244, v244
    v_exp_f32 v214, v214
    v_mfma_f32_32x32x16_bf16 v[192:207], a[212:215], v[108:111], v[192:207]
    ds_read_b128 a[244:247], v25 offset:7168
    v_exp_f32 v215, v215
    v_mul_f32 v216, v216, v152
    v_mul_f32 v217, v217, v153
    s_waitcnt lgkmcnt(6)
    v_mfma_f32_32x32x16_bf16 v[192:207], a[216:219], v[112:115], v[192:207]
    ds_read_b128 a[248:251], v14 offset:6144
    v_fma_f32 v218, v218, v242, v240
    v_fma_f32 v219, v219, v242, v240
    v_mul_f32 v220, v156, v156
    v_mfma_f32_32x32x16_bf16 v[192:207], a[220:223], v[116:119], v[192:207]
    ds_read_b128 a[252:255], v14 offset:7168
    v_mul_f32 v221, v157, v157
    v_mul_f32 v146, v146, v210
    v_mul_f32 v147, v147, v211
    v_rcp_f32 v212, v212
    s_waitcnt lgkmcnt(6)
    v_mfma_f32_32x32x16_bf16 v[192:207], a[224:227], v[120:123], v[192:207]
    v_rcp_f32 v213, v213
    v_fma_f32 v214, v214, v244, v244
    v_fma_f32 v215, v215, v244, v244
    v_mfma_f32_32x32x16_bf16 v[192:207], a[228:231], v[124:127], v[192:207]
    v_exp_f32 v216, v216
    v_exp_f32 v217, v217
    v_mul_f32 v218, v218, v154
    s_waitcnt lgkmcnt(4)
    v_mfma_f32_32x32x16_bf16 v[192:207], a[232:235], v[128:131], v[192:207]
    v_mul_f32 v219, v219, v155
    v_fma_f32 v220, v220, v242, v240
    v_fma_f32 v221, v221, v242, v240
    v_mul_f32 v222, v158, v158
    v_mfma_f32_32x32x16_bf16 v[192:207], a[236:239], v[132:135], v[192:207]
    v_mul_f32 v223, v159, v159
    v_cvt_pk_bf16_f32 v224, v144, v145
we_all_130:
wp_all_130:
    s_cmp_eq_u32 s43, 1
    s_cbranch_scc1 wr_0
    v_mul_f32 v148, v148, v212
    v_mul_f32 v149, v149, v213
    v_rcp_f32 v214, v214
    s_waitcnt lgkmcnt(2)
    v_mfma_f32_32x32x16_bf16 v[192:207], a[240:243], v[136:139], v[192:207]
    v_rcp_f32 v215, v215
    v_fma_f32 v216, v216, v244, v244
    v_fma_f32 v217, v217, v244, v244
    v_mfma_f32_32x32x16_bf16 v[192:207], a[244:247], v[140:143], v[192:207]
    v_exp_f32 v218, v218
    v_exp_f32 v219, v219
    v_mul_f32 v220, v220, v156
    s_waitcnt lgkmcnt(0)
    v_mfma_f32_32x32x16_bf16 v[192:207], a[248:251], v[28:31], v[192:207]
    v_mul_f32 v221, v221, v157
    v_fma_f32 v222, v222, v242, v240
    v_fma_f32 v223, v223, v242, v240
    v_cvt_pk_bf16_f32 v225, v146, v147
    v_mfma_f32_32x32x16_bf16 v[192:207], a[252:255], v[28:31], v[192:207]
    v_mul_f32 v150, v150, v214
    v_mul_f32 v151, v151, v215
    v_rcp_f32 v216, v216
    v_rcp_f32 v217, v217
    v_fma_f32 v218, v218, v244, v244
    v_fma_f32 v219, v219, v244, v244
    v_exp_f32 v220, v220
    v_exp_f32 v221, v221
    v_mul_f32 v222, v222, v158
    v_mul_f32 v223, v223, v159
    v_cvt_pk_bf16_f32 v226, v148, v149
    v_mul_f32 v152, v152, v216
    v_mul_f32 v153, v153, v217
    v_rcp_f32 v218, v218
    v_rcp_f32 v219, v219
    v_fma_f32 v220, v220, v244, v244
    v_fma_f32 v221, v221, v244, v244
    v_exp_f32 v222, v222
    v_exp_f32 v223, v223
    v_cvt_pk_bf16_f32 v227, v150, v151
    v_mul_f32 v154, v154, v218
    v_mul_f32 v155, v155, v219
    v_rcp_f32 v220, v220
    v_rcp_f32 v221, v221
    v_fma_f32 v222, v222, v244, v244
    v_fma_f32 v223, v223, v244, v244
we_all_131:
wp_all_131:
    s_cmp_eq_u32 s43, 1
    s_cbranch_scc1 wr_0
    v_cvt_pk_bf16_f32 v228, v152, v153
    v_mul_f32 v156, v156, v220
    v_mul_f32 v157, v157, v221
    v_rcp_f32 v222, v222
    v_rcp_f32 v223, v223
    v_cvt_pk_bf16_f32 v229, v154, v155
    v_mul_f32 v158, v158, v222
    v_mul_f32 v159, v159, v223
    v_cvt_pk_bf16_f32 v230, v156, v157
    v_cvt_pk_bf16_f32 v231, v158, v159
    buffer_store_dwordx4 v[224:227], v10, s[44:47], s32 offen offset:0 sc1
    buffer_store_dwordx4 v[228:231], v10, s[44:47], s32 offen offset:1024 sc1
    v_readlane_b32 s56, v21, 0
    v_readlane_b32 s57, v21, 1
    v_readlane_b32 s58, v21, 2
    v_readlane_b32 s59, v21, 3
    s_mul_i32 s35, s3, 17408
    s_add_u32 s35, s35, 32768
    v_add_u32 v16, s35, v10
    s_waitcnt vmcnt(39)
    s_barrier
    s_waitcnt vmcnt(2)
kf_kernel_po_lp:
    v_cmp_ne_u32 vcc, 1, v248
    s_add_u32 s100, s100, 1
    s_nop 3
    s_cbranch_vccz kf_kernel_po_ok
    s_cmp_gt_u32 s100, 30000
    s_cbranch_scc1 kf_kernel_po_ok
    s_sleep 1
    buffer_load_dword v248, v22, s[44:47], 0 offen offset:0 sc1
    s_waitcnt vmcnt(0)
    s_branch kf_kernel_po_lp
kf_kernel_po_ok:
    v_pk_mul_f32 v[208:209], v[160:161], v[160:161]
    buffer_load_dwordx4 a[144:147], v10, s[44:47], s34 offen offset:0 sc1
    v_pk_mul_f32 v[210:211], v[162:163], v[162:163]
    v_pk_mul_f32 v[212:213], v[164:165], v[164:165]
    v_pk_mul_f32 v[214:215], v[166:167], v[166:167]
    v_pk_mul_f32 v[216:217], v[168:169], v[168:169]
    v_pk_mul_f32 v[218:219], v[170:171], v[170:171]
    v_pk_mul_f32 v[220:221], v[172:173], v[172:173]
we_all_132:
wp_all_132:
    s_cmp_eq_u32 s43, 1
    s_cbranch_scc1 wr_0
    buffer_load_dwordx4 a[148:151], v10, s[44:47], s34 offen offset:1024 sc1
    v_pk_mul_f32 v[222:223], v[174:175], v[174:175]
    v_pk_fma_f32 v[208:209], v[208:209], v[242:243], v[240:241]
    v_pk_fma_f32 v[210:211], v[210:211], v[242:243], v[240:241]
    v_pk_fma_f32 v[212:213], v[212:213], v[242:243], v[240:241]
    v_pk_fma_f32 v[214:215], v[214:215], v[242:243], v[240:241]
    v_pk_fma_f32 v[216:217], v[216:217], v[242:243], v[240:241]
    buffer_load_dwordx4 a[152:155], v10, s[44:47], s34 offen offset:2048 sc1
    v_pk_fma_f32 v[218:219], v[218:219], v[242:243], v[240:241]
    v_pk_fma_f32 v[220:221], v[220:221], v[242:243], v[240:241]
    v_pk_fma_f32 v[222:223], v[222:223], v[242:243], v[240:241]
    v_pk_mul_f32 v[208:209], v[208:209], v[160:161]
    v_pk_mul_f32 v[210:211], v[210:211], v[162:163]
    v_pk_mul_f32 v[212:213], v[212:213], v[164:165]
    buffer_load_dwordx4 a[156:159], v10, s[44:47], s34 offen offset:3072 sc1
    v_pk_mul_f32 v[214:215], v[214:215], v[166:167]
    v_pk_mul_f32 v[216:217], v[216:217], v[168:169]
    v_pk_mul_f32 v[218:219], v[218:219], v[170:171]
    v_pk_mul_f32 v[220:221], v[220:221], v[172:173]
    v_pk_mul_f32 v[222:223], v[222:223], v[174:175]
    v_exp_f32 v208, v208
    buffer_load_dwordx4 a[160:163], v11, s[44:47], s34 offen offset:0 sc1
    v_exp_f32 v209, v209
    v_exp_f32 v210, v210
    v_exp_f32 v211, v211
    v_exp_f32 v212, v212
    v_exp_f32 v213, v213
    v_exp_f32 v214, v214
    buffer_load_dwordx4 a[164:167], v11, s[44:47], s34 offen offset:1024 sc1
    v_exp_f32 v215, v215
    v_exp_f32 v216, v216
    v_exp_f32 v217, v217
    v_exp_f32 v218, v218
    v_exp_f32 v219, v219
    v_exp_f32 v220, v220
    buffer_load_dwordx4 a[168:171], v11, s[44:47], s34 offen offset:2048 sc1
    v_exp_f32 v221, v221
    v_exp_f32 v222, v222
    v_exp_f32 v223, v223
we_all_133:
wp_all_133:
    s_cmp_eq_u32 s43, 1
    s_cbranch_scc1 wr_0
    v_pk_fma_f32 v[208:209], v[208:209], v[244:245], v[244:245]
    v_pk_fma_f32 v[210:211], v[210:211], v[244:245], v[244:245]
    v_pk_fma_f32 v[212:213], v[212:213], v[244:245], v[244:245]
    buffer_load_dwordx4 a[172:175], v11, s[44:47], s34 offen offset:3072 sc1
    v_pk_fma_f32 v[214:215], v[214:215], v[244:245], v[244:245]
    v_pk_fma_f32 v[216:217], v[216:217], v[244:245], v[244:245]
    v_pk_fma_f32 v[218:219], v[218:219], v[244:245], v[244:245]
    v_pk_fma_f32 v[220:221], v[220:221], v[244:245], v[244:245]
    v_pk_fma_f32 v[222:223], v[222:223], v[244:245], v[244:245]
    v_rcp_f32 v208, v208
    buffer_load_dwordx4 a[176:179], v12, s[44:47], s34 offen offset:0 sc1
    v_rcp_f32 v209, v209
    v_rcp_f32 v210, v210
    v_rcp_f32 v211, v211
    v_rcp_f32 v212, v212
    v_rcp_f32 v213, v213
    v_rcp_f32 v214, v214
    buffer_load_dwordx4 a[180:183], v12, s[44:47], s34 offen offset:1024 sc1
    v_rcp_f32 v215, v215
    v_rcp_f32 v216, v216
    v_rcp_f32 v217, v217
    v_rcp_f32 v218, v218
    v_rcp_f32 v219, v219
    v_rcp_f32 v220, v220
    buffer_load_dwordx4 a[184:187], v12, s[44:47], s34 offen offset:2048 sc1
    v_rcp_f32 v221, v221
    v_rcp_f32 v222, v222
    v_rcp_f32 v223, v223
    v_pk_mul_f32 v[160:161], v[160:161], v[208:209]
    v_pk_mul_f32 v[162:163], v[162:163], v[210:211]
    v_pk_mul_f32 v[164:165], v[164:165], v[212:213]
    buffer_load_dwordx4 a[188:191], v12, s[44:47], s34 offen offset:3072 sc1
    v_pk_mul_f32 v[166:167], v[166:167], v[214:215]
    v_pk_mul_f32 v[168:169], v[168:169], v[216:217]
    v_pk_mul_f32 v[170:171], v[170:171], v[218:219]
    v_pk_mul_f32 v[172:173], v[172:173], v[220:221]
    v_pk_mul_f32 v[174:175], v[174:175], v[222:223]
    v_cvt_pk_bf16_f32 v232, v160, v161
    buffer_load_dwordx4 a[192:195], v13, s[44:47], s34 offen offset:0 sc1
we_all_134:
wp_all_134:
    s_cmp_eq_u32 s43, 1
    s_cbranch_scc1 wr_0
    v_cvt_pk_bf16_f32 v233, v162, v163
    v_cvt_pk_bf16_f32 v234, v164, v165
    v_cvt_pk_bf16_f32 v235, v166, v167
    v_cvt_pk_bf16_f32 v236, v168, v169
    v_cvt_pk_bf16_f32 v237, v170, v171
    v_cvt_pk_bf16_f32 v238, v172, v173
    buffer_load_dwordx4 a[196:199], v13, s[44:47], s34 offen offset:1024 sc1
    v_cvt_pk_bf16_f32 v239, v174, v175
    buffer_store_dwordx4 v[232:235], v10, s[44:47], s32 offen offset:2048 sc1
    buffer_store_dwordx4 v[236:239], v10, s[44:47], s32 offen offset:3072 sc1
    s_waitcnt vmcnt(16)
    buffer_store_dword v246, v247, s[44:47], 0 offen offset:0 sc1
    v_pk_mul_f32 v[208:209], v[176:177], v[176:177]
    buffer_load_dwordx4 a[200:203], v13, s[44:47], s34 offen offset:2048 sc1
    v_pk_mul_f32 v[210:211], v[178:179], v[178:179]
    v_pk_mul_f32 v[212:213], v[180:181], v[180:181]
    v_pk_mul_f32 v[214:215], v[182:183], v[182:183]
    v_pk_mul_f32 v[216:217], v[184:185], v[184:185]
    v_pk_mul_f32 v[218:219], v[186:187], v[186:187]
    v_pk_mul_f32 v[220:221], v[188:189], v[188:189]
    buffer_load_dwordx4 a[204:207], v13, s[44:47], s34 offen offset:3072 sc1
    v_pk_mul_f32 v[222:223], v[190:191], v[190:191]
    v_pk_fma_f32 v[208:209], v[208:209], v[242:243], v[240:241]
    v_pk_fma_f32 v[210:211], v[210:211], v[242:243], v[240:241]
    v_pk_fma_f32 v[212:213], v[212:213], v[242:243], v[240:241]
    v_pk_fma_f32 v[214:215], v[214:215], v[242:243], v[240:241]
    v_pk_fma_f32 v[216:217], v[216:217], v[242:243], v[240:241]
    s_add_u32 m0, s23, 0
    s_add_u32 s73, s36, 32768
    buffer_load_dwordx4 v10, s[44:47], s73 offen offset:0 lds
    v_pk_fma_f32 v[218:219], v[218:219], v[242:243], v[240:241]
    v_pk_fma_f32 v[220:221], v[220:221], v[242:243], v[240:241]
we_all_135:
wp_all_135:
    s_cmp_eq_u32 s43, 1
    s_cbranch_scc1 wr_0
    v_pk_fma_f32 v[222:223], v[222:223], v[242:243], v[240:241]
    v_pk_mul_f32 v[208:209], v[208:209], v[176:177]
    v_pk_mul_f32 v[210:211], v[210:211], v[178:179]
    v_pk_mul_f32 v[212:213], v[212:213], v[180:181]
    buffer_load_dwordx4 v10, s[44:47], s73 offen offset:1024 lds
    v_pk_mul_f32 v[214:215], v[214:215], v[182:183]
    v_pk_mul_f32 v[216:217], v[216:217], v[184:185]
    v_pk_mul_f32 v[218:219], v[218:219], v[186:187]
    v_pk_mul_f32 v[220:221], v[220:221], v[188:189]
    v_pk_mul_f32 v[222:223], v[222:223], v[190:191]
    v_exp_f32 v208, v208
    buffer_load_dwordx4 v10, s[44:47], s73 offen offset:2048 lds
    v_exp_f32 v209, v209
    v_exp_f32 v210, v210
    v_exp_f32 v211, v211
    v_exp_f32 v212, v212
    v_exp_f32 v213, v213
    v_exp_f32 v214, v214
    buffer_load_dwordx4 v10, s[44:47], s73 offen offset:3072 lds
    v_exp_f32 v215, v215
    v_exp_f32 v216, v216
    v_exp_f32 v217, v217
    v_exp_f32 v218, v218
    v_exp_f32 v219, v219
    v_exp_f32 v220, v220
    s_add_u32 m0, s23, 16384
    s_add_u32 s73, s36, 49152
    buffer_load_dwordx4 v10, s[44:47], s73 offen offset:0 lds
    v_exp_f32 v221, v221
    v_exp_f32 v222, v222
    v_exp_f32 v223, v223
    v_pk_fma_f32 v[208:209], v[208:209], v[244:245], v[244:245]
    v_pk_fma_f32 v[210:211], v[210:211], v[244:245], v[244:245]
    v_pk_fma_f32 v[212:213], v[212:213], v[244:245], v[244:245]
    buffer_load_dwordx4 v10, s[44:47], s73 offen offset:1024 lds
    v_pk_fma_f32 v[214:215], v[214:215], v[244:245], v[244:245]
    v_pk_fma_f32 v[216:217], v[216:217], v[244:245], v[244:245]
    v_pk_fma_f32 v[218:219], v[218:219], v[244:245], v[244:245]
    v_pk_fma_f32 v[220:221], v[220:221], v[244:245], v[244:245]
we_all_136:
wp_all_136:
    s_cmp_eq_u32 s43, 1
    s_cbranch_scc1 wr_0
    v_pk_fma_f32 v[222:223], v[222:223], v[244:245], v[244:245]
    v_rcp_f32 v208, v208
    buffer_load_dwordx4 v10, s[44:47], s73 offen offset:2048 lds
    v_rcp_f32 v209, v209
    v_rcp_f32 v210, v210
    v_rcp_f32 v211, v211
    v_rcp_f32 v212, v212
    v_rcp_f32 v213, v213
    v_rcp_f32 v214, v214
    buffer_load_dwordx4 v10, s[44:47], s73 offen offset:3072 lds
    v_rcp_f32 v215, v215
    v_rcp_f32 v216, v216
    v_rcp_f32 v217, v217
    v_rcp_f32 v218, v218
    v_rcp_f32 v219, v219
    v_rcp_f32 v220, v220
    buffer_load_dwordx4 v[252:255], v26, s[44:47], 0 offen offset:1024 sc1
    v_rcp_f32 v221, v221
    v_rcp_f32 v222, v222
    v_rcp_f32 v223, v223
    v_pk_mul_f32 v[176:177], v[176:177], v[208:209]
    v_pk_mul_f32 v[178:179], v[178:179], v[210:211]
    v_pk_mul_f32 v[180:181], v[180:181], v[212:213]
    buffer_load_dwordx4 v[144:147], v12, s[44:47], s30 offen offset:0
    v_pk_mul_f32 v[182:183], v[182:183], v[214:215]
    v_pk_mul_f32 v[184:185], v[184:185], v[216:217]
    v_pk_mul_f32 v[186:187], v[186:187], v[218:219]
    v_pk_mul_f32 v[188:189], v[188:189], v[220:221]
    v_pk_mul_f32 v[190:191], v[190:191], v[222:223]
    v_cvt_pk_bf16_f32 v224, v176, v177
    buffer_load_dwordx4 v[148:151], v12, s[44:47], s30 offen offset:1024
    v_cvt_pk_bf16_f32 v225, v178, v179
    v_cvt_pk_bf16_f32 v226, v180, v181
    v_cvt_pk_bf16_f32 v227, v182, v183
    v_cvt_pk_bf16_f32 v228, v184, v185
    v_cvt_pk_bf16_f32 v229, v186, v187
    v_cvt_pk_bf16_f32 v230, v188, v189
    buffer_load_dwordx4 v[152:155], v12, s[44:47], s30 offen offset:2048
    v_cvt_pk_bf16_f32 v231, v190, v191
we_all_137:
wp_all_137:
    s_cmp_eq_u32 s43, 1
    s_cbranch_scc1 wr_0
    buffer_store_dwordx4 v[224:227], v11, s[44:47], s32 offen offset:0 sc1
    buffer_store_dwordx4 v[228:231], v11, s[44:47], s32 offen offset:1024 sc1
    s_waitcnt vmcnt(17)
    buffer_store_dword v246, v247, s[44:47], 0 offen offset:1024 sc1
    v_pk_mul_f32 v[208:209], v[192:193], v[192:193]
    buffer_load_dwordx4 v[156:159], v12, s[44:47], s30 offen offset:3072
    v_pk_mul_f32 v[210:211], v[194:195], v[194:195]
    v_pk_mul_f32 v[212:213], v[196:197], v[196:197]
    v_pk_mul_f32 v[214:215], v[198:199], v[198:199]
    v_pk_mul_f32 v[216:217], v[200:201], v[200:201]
    v_pk_mul_f32 v[218:219], v[202:203], v[202:203]
    v_pk_mul_f32 v[220:221], v[204:205], v[204:205]
    buffer_load_dwordx4 v[160:163], v12, s[44:47], s31 offen offset:0
    v_pk_mul_f32 v[222:223], v[206:207], v[206:207]
    v_pk_fma_f32 v[208:209], v[208:209], v[242:243], v[240:241]
    v_pk_fma_f32 v[210:211], v[210:211], v[242:243], v[240:241]
    v_pk_fma_f32 v[212:213], v[212:213], v[242:243], v[240:241]
    v_pk_fma_f32 v[214:215], v[214:215], v[242:243], v[240:241]
    v_pk_fma_f32 v[216:217], v[216:217], v[242:243], v[240:241]
    buffer_load_dwordx4 v[164:167], v12, s[44:47], s31 offen offset:1024
    v_pk_fma_f32 v[218:219], v[218:219], v[242:243], v[240:241]
    v_pk_fma_f32 v[220:221], v[220:221], v[242:243], v[240:241]
    v_pk_fma_f32 v[222:223], v[222:223], v[242:243], v[240:241]
    v_pk_mul_f32 v[208:209], v[208:209], v[192:193]
    v_pk_mul_f32 v[210:211], v[210:211], v[194:195]
    v_pk_mul_f32 v[212:213], v[212:213], v[196:197]
    buffer_load_dwordx4 v[168:171], v12, s[44:47], s31 offen offset:2048
    v_pk_mul_f32 v[214:215], v[214:215], v[198:199]
    v_pk_mul_f32 v[216:217], v[216:217], v[200:201]
    v_pk_mul_f32 v[218:219], v[218:219], v[202:203]
    v_pk_mul_f32 v[220:221], v[220:221], v[204:205]
    v_pk_mul_f32 v[222:223], v[222:223], v[206:207]
we_all_138:
wp_all_138:
    s_cmp_eq_u32 s43, 1
    s_cbranch_scc1 wr_0
    v_exp_f32 v208, v208
    buffer_load_dwordx4 v[172:175], v12, s[44:47], s31 offen offset:3072
    v_exp_f32 v209, v209
    v_exp_f32 v210, v210
    v_exp_f32 v211, v211
    v_exp_f32 v212, v212
    v_exp_f32 v213, v213
    v_exp_f32 v214, v214
    buffer_load_dwordx4 v[176:179], v13, s[44:47], s28 offen offset:0
    v_exp_f32 v215, v215
    v_exp_f32 v216, v216
    v_exp_f32 v217, v217
    v_exp_f32 v218, v218
    v_exp_f32 v219, v219
    v_exp_f32 v220, v220
    buffer_load_dwordx4 v[180:183], v13, s[44:47], s28 offen offset:1024
    v_exp_f32 v221, v221
    v_exp_f32 v222, v222
    v_exp_f32 v223, v223
    s_load_dwordx2 s[48:49], s[40:41], s56 offset:0 glc
    s_load_dwordx2 s[50:51], s[40:41], s57 offset:0 glc
    s_load_dwordx2 s[52:53], s[40:41], s58 offset:0 glc
    v_pk_fma_f32 v[208:209], v[208:209], v[244:245], v[244:245]
    v_pk_fma_f32 v[210:211], v[210:211], v[244:245], v[244:245]
    v_pk_fma_f32 v[212:213], v[212:213], v[244:245], v[244:245]
    buffer_load_dwordx4 v[184:187], v13, s[44:47], s28 offen offset:2048
    v_pk_fma_f32 v[214:215], v[214:215], v[244:245], v[244:245]
    v_pk_fma_f32 v[216:217], v[216:217], v[244:245], v[244:245]
    v_pk_fma_f32 v[218:219], v[218:219], v[244:245], v[244:245]
    v_pk_fma_f32 v[220:221], v[220:221], v[244:245], v[244:245]
    v_pk_fma_f32 v[222:223], v[222:223], v[244:245], v[244:245]
    v_rcp_f32 v208, v208
    buffer_load_dwordx4 v[188:191], v13, s[44:47], s28 offen offset:3072
    v_rcp_f32 v209, v209
    v_rcp_f32 v210, v210
    v_rcp_f32 v211, v211
    v_rcp_f32 v212, v212
    v_rcp_f32 v213, v213
    v_rcp_f32 v214, v214
    v_rcp_f32 v215, v215
    v_rcp_f32 v216, v216
    v_rcp_f32 v217, v217
    v_rcp_f32 v218, v218
    v_rcp_f32 v219, v219
    v_rcp_f32 v220, v220
we_all_139:
wp_all_139:
    s_cmp_eq_u32 s43, 1
    s_cbranch_scc1 wr_0
    v_rcp_f32 v221, v221
    v_rcp_f32 v222, v222
    v_rcp_f32 v223, v223
    v_pk_mul_f32 v[192:193], v[192:193], v[208:209]
    v_pk_mul_f32 v[194:195], v[194:195], v[210:211]
    v_pk_mul_f32 v[196:197], v[196:197], v[212:213]
    v_pk_mul_f32 v[198:199], v[198:199], v[214:215]
    v_pk_mul_f32 v[200:201], v[200:201], v[216:217]
    v_pk_mul_f32 v[202:203], v[202:203], v[218:219]
    v_pk_mul_f32 v[204:205], v[204:205], v[220:221]
    v_pk_mul_f32 v[206:207], v[206:207], v[222:223]
    v_cvt_pk_bf16_f32 v232, v192, v193
    v_cvt_pk_bf16_f32 v233, v194, v195
    v_cvt_pk_bf16_f32 v234, v196, v197
    v_cvt_pk_bf16_f32 v235, v198, v199
    v_cvt_pk_bf16_f32 v236, v200, v201
    v_cvt_pk_bf16_f32 v237, v202, v203
    v_cvt_pk_bf16_f32 v238, v204, v205
    v_cvt_pk_bf16_f32 v239, v206, v207
    buffer_store_dwordx4 v[232:235], v11, s[44:47], s32 offen offset:2048 sc1
    buffer_store_dwordx4 v[236:239], v11, s[44:47], s32 offen offset:3072 sc1
    s_waitcnt vmcnt(12)
    buffer_store_dword v246, v247, s[44:47], 0 offen offset:2048 sc1
    s_waitcnt lgkmcnt(0)
    s_and_b64 s[48:49], s[48:49], s[50:51]
    s_and_b64 s[48:49], s[48:49], s[52:53]
    s_and_b32 s48, s48, s49
    s_cmp_eq_u32 s48, 1
    s_cbranch_scc0 kf_kernel_p0_sl
kf_kernel_p0_bk:
    buffer_load_dwordx4 v[32:35], v10, s[44:47], s24 offen offset:0 sc1
    buffer_load_dwordx4 v[40:43], v14, s[44:47], s24 offen offset:0 sc1
    ds_read_b128 a[208:211], v250 offset:0
    ds_read_b128 a[212:215], v250 offset:256
    ds_read_b128 a[216:219], v250 offset:2048
    ds_read_b128 a[220:223], v250 offset:2304
    ds_read_b128 a[224:227], v250 offset:4096
we_all_140:
wp_all_140:
    s_cmp_eq_u32 s43, 1
    s_cbranch_scc1 wr_0
    ds_read_b128 a[228:231], v250 offset:4352
    ds_read_b128 a[232:235], v250 offset:6144
    ds_read_b128 a[236:239], v250 offset:6400
    ds_read_b128 a[240:243], v250 offset:8192
    ds_read_b128 a[244:247], v250 offset:8448
    s_waitcnt lgkmcnt(8)
    v_mfma_f32_16x16x32_bf16 v[224:227], a[208:211], a[144:147], 0
    ds_read_b128 a[248:251], v250 offset:10240
    v_mfma_f32_16x16x32_bf16 v[228:231], a[212:215], a[144:147], 0
    ds_read_b128 a[252:255], v250 offset:10496
    buffer_load_dwordx4 v[36:39], v10, s[44:47], s24 offen offset:1024 sc1
    s_waitcnt lgkmcnt(8)
    v_mfma_f32_16x16x32_bf16 v[232:235], a[216:219], a[144:147], 0
    ds_read_b128 a[208:211], v250 offset:12288
    v_mfma_f32_16x16x32_bf16 v[236:239], a[220:223], a[144:147], 0
    ds_read_b128 a[212:215], v250 offset:12544
    s_waitcnt lgkmcnt(8)
    v_mfma_f32_16x16x32_bf16 v[224:227], a[224:227], a[148:151], v[224:227]
    ds_read_b128 a[216:219], v250 offset:14336
    v_mfma_f32_16x16x32_bf16 v[228:231], a[228:231], a[148:151], v[228:231]
    ds_read_b128 a[220:223], v250 offset:14592
    buffer_load_dwordx4 v[44:47], v14, s[44:47], s24 offen offset:1024 sc1
    s_waitcnt lgkmcnt(8)
    v_mfma_f32_16x16x32_bf16 v[232:235], a[232:235], a[148:151], v[232:235]
    ds_read_b128 a[224:227], v250 offset:16384
    v_mfma_f32_16x16x32_bf16 v[236:239], a[236:239], a[148:151], v[236:239]
    ds_read_b128 a[228:231], v250 offset:16640
    s_waitcnt lgkmcnt(8)
    v_mfma_f32_16x16x32_bf16 v[224:227], a[240:243], a[152:155], v[224:227]
    ds_read_b128 a[232:235], v250 offset:18432
    v_mfma_f32_16x16x32_bf16 v[228:231], a[244:247], a[152:155], v[228:231]
    ds_read_b128 a[236:239], v250 offset:18688
    buffer_load_dwordx4 v[48:51], v10, s[44:47], s25 offen offset:0 sc1
    s_waitcnt lgkmcnt(8)
we_all_141:
wp_all_141:
    s_cmp_eq_u32 s43, 1
    s_cbranch_scc1 wr_0
    v_mfma_f32_16x16x32_bf16 v[232:235], a[248:251], a[152:155], v[232:235]
    ds_read_b128 a[240:243], v250 offset:20480
    v_mfma_f32_16x16x32_bf16 v[236:239], a[252:255], a[152:155], v[236:239]
    ds_read_b128 a[244:247], v250 offset:20736
    s_waitcnt lgkmcnt(8)
    v_mfma_f32_16x16x32_bf16 v[224:227], a[208:211], a[156:159], v[224:227]
    ds_read_b128 a[248:251], v250 offset:22528
    v_mfma_f32_16x16x32_bf16 v[228:231], a[212:215], a[156:159], v[228:231]
    ds_read_b128 a[252:255], v250 offset:22784
    buffer_load_dwordx4 v[56:59], v14, s[44:47], s25 offen offset:0 sc1
    s_waitcnt lgkmcnt(8)
    v_mfma_f32_16x16x32_bf16 v[232:235], a[216:219], a[156:159], v[232:235]
    ds_read_b128 a[208:211], v250 offset:24576
    v_mfma_f32_16x16x32_bf16 v[236:239], a[220:223], a[156:159], v[236:239]
    ds_read_b128 a[212:215], v250 offset:24832
    s_load_dwordx2 s[16:17], s[40:41], s56 offset:1024 glc
    s_load_dwordx2 s[18:19], s[40:41], s57 offset:1024 glc
    s_load_dwordx2 s[20:21], s[40:41], s58 offset:1024 glc
    s_load_dwordx2 s[54:55], s[40:41], s59 offset:1024 glc
    s_waitcnt lgkmcnt(8)
    v_mfma_f32_16x16x32_bf16 v[224:227], a[224:227], a[160:163], v[224:227]
    ds_read_b128 a[216:219], v250 offset:26624
    v_mfma_f32_16x16x32_bf16 v[228:231], a[228:231], a[160:163], v[228:231]
    ds_read_b128 a[220:223], v250 offset:26880
    buffer_load_dwordx4 v[52:55], v10, s[44:47], s25 offen offset:1024 sc1
    s_waitcnt lgkmcnt(8)
    v_mfma_f32_16x16x32_bf16 v[232:235], a[232:235], a[160:163], v[232:235]
    ds_read_b128 a[224:227], v250 offset:28672
    v_mfma_f32_16x16x32_bf16 v[236:239], a[236:239], a[160:163], v[236:239]
    ds_read_b128 a[228:231], v250 offset:28928
    s_waitcnt lgkmcnt(8)
    v_mfma_f32_16x16x32_bf16 v[224:227], a[240:243], a[164:167], v[224:227]
    ds_read_b128 a[232:235], v250 offset:30720
    v_mfma_f32_16x16x32_bf16 v[228:231], a[244:247], a[164:167], v[228:231]
we_all_142:
wp_all_142:
    s_cmp_eq_u32 s43, 1
    s_cbranch_scc1 wr_0
    ds_read_b128 a[236:239], v250 offset:30976
    buffer_load_dwordx4 v[60:63], v14, s[44:47], s25 offen offset:1024 sc1
    s_barrier
    s_waitcnt lgkmcnt(8)
    v_mfma_f32_16x16x32_bf16 v[232:235], a[248:251], a[164:167], v[232:235]
    ds_read_b128 a[240:243], v251 offset:0
    v_mfma_f32_16x16x32_bf16 v[236:239], a[252:255], a[164:167], v[236:239]
    ds_read_b128 a[244:247], v251 offset:256
    s_waitcnt lgkmcnt(8)
    v_mfma_f32_16x16x32_bf16 v[224:227], a[208:211], a[168:171], v[224:227]
    ds_read_b128 a[248:251], v251 offset:2048
    v_mfma_f32_16x16x32_bf16 v[228:231], a[212:215], a[168:171], v[228:231]
    ds_read_b128 a[252:255], v251 offset:2304
    buffer_load_dwordx4 v[64:67], v10, s[44:47], s26 offen offset:0 sc1
    s_waitcnt lgkmcnt(8)
    v_mfma_f32_16x16x32_bf16 v[232:235], a[216:219], a[168:171], v[232:235]
    ds_read_b128 a[208:211], v251 offset:4096
    v_mfma_f32_16x16x32_bf16 v[236:239], a[220:223], a[168:171], v[236:239]
    ds_read_b128 a[212:215], v251 offset:4352
    s_waitcnt lgkmcnt(8)
    v_mfma_f32_16x16x32_bf16 v[224:227], a[224:227], a[172:175], v[224:227]
    ds_read_b128 a[216:219], v251 offset:6144
    v_mfma_f32_16x16x32_bf16 v[228:231], a[228:231], a[172:175], v[228:231]
    ds_read_b128 a[220:223], v251 offset:6400
    buffer_load_dwordx4 v[72:75], v14, s[44:47], s26 offen offset:0 sc1
    s_waitcnt lgkmcnt(8)
    v_mfma_f32_16x16x32_bf16 v[232:235], a[232:235], a[172:175], v[232:235]
    ds_read_b128 a[224:227], v251 offset:8192
    v_mfma_f32_16x16x32_bf16 v[236:239], a[236:239], a[172:175], v[236:239]
    ds_read_b128 a[228:231], v251 offset:8448
    s_waitcnt lgkmcnt(8)
    v_mfma_f32_16x16x32_bf16 v[224:227], a[240:243], a[176:179], v[224:227]
    ds_read_b128 a[232:235], v251 offset:10240
    v_mfma_f32_16x16x32_bf16 v[228:231], a[244:247], a[176:179], v[228:231]
we_all_143:
wp_all_143:
    s_cmp_eq_u32 s43, 1
    s_cbranch_scc1 wr_0
    ds_read_b128 a[236:239], v251 offset:10496
    buffer_load_dwordx4 v[68:71], v10, s[44:47], s26 offen offset:1024 sc1
    s_waitcnt lgkmcnt(8)
    v_mfma_f32_16x16x32_bf16 v[232:235], a[248:251], a[176:179], v[232:235]
    ds_read_b128 a[240:243], v251 offset:12288
    v_mfma_f32_16x16x32_bf16 v[236:239], a[252:255], a[176:179], v[236:239]
    ds_read_b128 a[244:247], v251 offset:12544
    s_waitcnt lgkmcnt(0)
    s_waitcnt lgkmcnt(0)
    s_and_b64 s[16:17], s[16:17], s[18:19]
    s_and_b64 s[16:17], s[16:17], s[20:21]
    s_and_b64 s[16:17], s[16:17], s[54:55]
    s_and_b32 s16, s16, s17
    s_cmp_eq_u32 s16, 1
    s_cbranch_scc0 kf_kernel_p1_sl
kf_kernel_p1_bk:
    buffer_load_dwordx4 v[76:79], v14, s[44:47], s26 offen offset:1024 sc1
    buffer_load_dwordx4 v[80:83], v10, s[44:47], s27 offen offset:0 sc1
    v_mfma_f32_16x16x32_bf16 v[224:227], a[208:211], a[180:183], v[224:227]
    ds_read_b128 a[248:251], v251 offset:14336
    v_mfma_f32_16x16x32_bf16 v[228:231], a[212:215], a[180:183], v[228:231]
    ds_read_b128 a[252:255], v251 offset:14592
    buffer_load_dwordx4 v[88:91], v14, s[44:47], s27 offen offset:0 sc1
    v_mfma_f32_16x16x32_bf16 v[232:235], a[216:219], a[180:183], v[232:235]
    ds_read_b128 a[208:211], v251 offset:16384
    v_mfma_f32_16x16x32_bf16 v[236:239], a[220:223], a[180:183], v[236:239]
    ds_read_b128 a[212:215], v251 offset:16640
    v_mfma_f32_16x16x32_bf16 v[224:227], a[224:227], a[184:187], v[224:227]
    ds_read_b128 a[216:219], v251 offset:18432
    v_mfma_f32_16x16x32_bf16 v[228:231], a[228:231], a[184:187], v[228:231]
    ds_read_b128 a[220:223], v251 offset:18688
    buffer_load_dwordx4 v[84:87], v10, s[44:47], s27 offen offset:1024 sc1
    v_mfma_f32_16x16x32_bf16 v[232:235], a[232:235], a[184:187], v[232:235]
    ds_read_b128 a[224:227], v251 offset:20480
    v_mfma_f32_16x16x32_bf16 v[236:239], a[236:239], a[184:187], v[236:239]
    ds_read_b128 a[228:231], v251 offset:20736
    v_mfma_f32_16x16x32_bf16 v[224:227], a[240:243], a[188:191], v[224:227]
we_all_144:
wp_all_144:
    s_cmp_eq_u32 s43, 1
    s_cbranch_scc1 wr_0
    ds_read_b128 a[232:235], v251 offset:22528
    v_mfma_f32_16x16x32_bf16 v[228:231], a[244:247], a[188:191], v[228:231]
    ds_read_b128 a[236:239], v251 offset:22784
    buffer_load_dwordx4 v[92:95], v14, s[44:47], s27 offen offset:1024 sc1
    s_waitcnt lgkmcnt(8)
    v_mfma_f32_16x16x32_bf16 v[232:235], a[248:251], a[188:191], v[232:235]
    ds_read_b128 a[240:243], v251 offset:24576
    v_mfma_f32_16x16x32_bf16 v[236:239], a[252:255], a[188:191], v[236:239]
    ds_read_b128 a[244:247], v251 offset:24832
    s_waitcnt lgkmcnt(8)
    v_mfma_f32_16x16x32_bf16 v[224:227], a[208:211], a[192:195], v[224:227]
    ds_read_b128 a[248:251], v251 offset:26624
    v_mfma_f32_16x16x32_bf16 v[228:231], a[212:215], a[192:195], v[228:231]
    ds_read_b128 a[252:255], v251 offset:26880
    buffer_load_dwordx4 v[96:99], v10, s[44:47], s24 offen offset:2048 sc1
    s_waitcnt lgkmcnt(8)
    v_mfma_f32_16x16x32_bf16 v[232:235], a[216:219], a[192:195], v[232:235]
    ds_read_b128 a[208:211], v251 offset:28672
    v_mfma_f32_16x16x32_bf16 v[236:239], a[220:223], a[192:195], v[236:239]
    ds_read_b128 a[212:215], v251 offset:28928
    s_waitcnt lgkmcnt(8)
    v_mfma_f32_16x16x32_bf16 v[224:227], a[224:227], a[196:199], v[224:227]
    ds_read_b128 a[216:219], v251 offset:30720
    v_mfma_f32_16x16x32_bf16 v[228:231], a[228:231], a[196:199], v[228:231]
    ds_read_b128 a[220:223], v251 offset:30976
    buffer_load_dwordx4 v[104:107], v14, s[44:47], s24 offen offset:2048 sc1
    s_waitcnt lgkmcnt(8)
    v_mfma_f32_16x16x32_bf16 v[232:235], a[232:235], a[196:199], v[232:235]
    v_mfma_f32_16x16x32_bf16 v[236:239], a[236:239], a[196:199], v[236:239]
    s_waitcnt lgkmcnt(6)
    v_mfma_f32_16x16x32_bf16 v[224:227], a[240:243], a[200:203], v[224:227]
    v_mfma_f32_16x16x32_bf16 v[228:231], a[244:247], a[200:203], v[228:231]
    buffer_load_dwordx4 v[100:103], v10, s[44:47], s24 offen offset:3072 sc1
    s_waitcnt lgkmcnt(4)
we_all_145:
wp_all_145:
    s_cmp_eq_u32 s43, 1
    s_cbranch_scc1 wr_0
    v_mfma_f32_16x16x32_bf16 v[232:235], a[248:251], a[200:203], v[232:235]
    v_mfma_f32_16x16x32_bf16 v[236:239], a[252:255], a[200:203], v[236:239]
    s_waitcnt lgkmcnt(2)
    v_mfma_f32_16x16x32_bf16 v[224:227], a[208:211], a[204:207], v[224:227]
    v_mfma_f32_16x16x32_bf16 v[228:231], a[212:215], a[204:207], v[228:231]
    buffer_load_dwordx4 v[108:111], v14, s[44:47], s24 offen offset:3072 sc1
    s_waitcnt lgkmcnt(0)
    v_mfma_f32_16x16x32_bf16 v[232:235], a[216:219], a[204:207], v[232:235]
    v_mfma_f32_16x16x32_bf16 v[236:239], a[220:223], a[204:207], v[236:239]
    buffer_load_dwordx4 v[112:115], v10, s[44:47], s25 offen offset:2048 sc1
    buffer_load_dwordx4 v[120:123], v14, s[44:47], s25 offen offset:2048 sc1
    buffer_load_dwordx4 v[116:119], v10, s[44:47], s25 offen offset:3072 sc1
    buffer_load_dwordx4 v[124:127], v14, s[44:47], s25 offen offset:3072 sc1
    buffer_load_dwordx4 v[128:131], v10, s[44:47], s26 offen offset:2048 sc1
    buffer_load_dwordx4 v[136:139], v14, s[44:47], s26 offen offset:2048 sc1
    buffer_load_dwordx4 v[132:135], v10, s[44:47], s26 offen offset:3072 sc1
    buffer_load_dwordx4 v[140:143], v14, s[44:47], s26 offen offset:3072 sc1
    s_waitcnt vmcnt(29)
    buffer_store_dword v246, v247, s[44:47], 0 offen offset:3072 sc1
    s_load_dwordx2 s[48:49], s[40:41], s56 offset:2048 glc
    s_load_dwordx2 s[50:51], s[40:41], s57 offset:2048 glc
    s_load_dwordx2 s[52:53], s[40:41], s58 offset:2048 glc
    s_waitcnt vmcnt(28)
    v_mfma_f32_32x32x16_bf16 a[144:159], a[0:3], v[32:35], 0
    buffer_load_dwordx4 v[192:195], v13, s[44:47], s29 offen offset:0
    v_and_b32 v5, 1, v4
    v_cmp_eq_u32 vcc, 1, v5
    s_nop 1
    v_cndmask_b32 v255, v255, 0, vcc
    v_add_f32 v252, v252, v253
    v_add_f32 v254, v254, v255
    v_add_f32 v252, v252, v254
    v_cmp_u_f32 vcc, v252, v252
    s_nop 0
    s_or_b64 vcc, vcc, vcc
    s_cbranch_scc1 kf_kernel_gtc_sl
kf_kernel_gtc_bk:
    v_mfma_f32_32x32x16_bf16 a[160:175], a[8:11], v[32:35], 0
    v_mov_b32 v253, v252
    s_nop 1
we_all_146:
wp_all_146:
    s_cmp_eq_u32 s43, 1
    s_cbranch_scc1 wr_0
    v_permlane16_swap_b32 v253, v252
    v_add_f32 v252, v252, v253
    v_cvt_pk_bf16_f32 v252, v252, v252
    s_waitcnt vmcnt(28)
    v_mfma_f32_32x32x16_bf16 a[176:191], a[0:3], v[40:43], 0
    v_lshlrev_b32 v252, 16, v252
    v_mul_f32 v252, 0xbfb8aa3b, v252
    v_exp_f32 v252, v252
    v_mfma_f32_32x32x16_bf16 a[192:207], a[8:11], v[40:43], 0
    buffer_load_dwordx4 v[196:199], v13, s[44:47], s29 offen offset:1024
    s_mul_i32 s68, s3, 2304
    v_add_f32 v252, 1.0, v252
    v_rcp_f32 v252, v252
    s_waitcnt vmcnt(28)
    v_mfma_f32_32x32x16_bf16 a[144:159], a[4:7], v[36:39], a[144:159]
    s_add_u32 s68, s68, 102400
    v_cvt_pk_bf16_f32 v252, v252, v252
    v_lshlrev_b32 v252, 16, v252
    v_sub_f32 v253, 1.0, v252
    v_mfma_f32_32x32x16_bf16 a[160:175], a[12:15], v[36:39], a[160:175]
    v_cvt_pk_bf16_f32 v253, v253, v253
    v_lshlrev_b32 v253, 16, v253
    v_mul_u32_u24 v8, 144, v3
    v_add_u32 v8, s68, v8
    v_lshl_add_u32 v254, v4, 2, v8
    s_waitcnt vmcnt(27)
    v_mfma_f32_32x32x16_bf16 a[176:191], a[4:7], v[44:47], a[176:191]
    buffer_load_dwordx4 v[200:203], v13, s[44:47], s29 offen offset:2048
    ds_write_b32 v254, v253 offset:128
    v_and_b32 v5, 1, v4
    v_lshl_add_u32 v8, v5, 4, v8
    v_mfma_f32_32x32x16_bf16 a[192:207], a[12:15], v[44:47], a[192:207]
    v_lshrrev_b32 v5, 1, v4
    v_lshl_add_u32 v8, v5, 3, v8
    v_cvt_pk_bf16_f32 v30, v224, v225
    v_cvt_pk_bf16_f32 v31, v226, v227
    s_waitcnt vmcnt(27)
    v_mfma_f32_32x32x16_bf16 a[144:159], a[16:19], v[48:51], a[144:159]
    v_lshlrev_b32 v224, 16, v30
    v_and_b32 v225, 0xffff0000, v30
we_all_147:
wp_all_147:
    s_cmp_eq_u32 s43, 1
    s_cbranch_scc1 wr_0
    v_lshlrev_b32 v226, 16, v31
    v_and_b32 v227, 0xffff0000, v31
    v_mfma_f32_32x32x16_bf16 a[160:175], a[24:27], v[48:51], a[160:175]
    buffer_load_dwordx4 v[204:207], v13, s[44:47], s29 offen offset:3072
    v_mul_f32 v224, v224, v252
    v_mul_f32 v225, v225, v252
    v_mul_f32 v226, v226, v252
    v_mul_f32 v227, v227, v252
    s_waitcnt vmcnt(27)
    v_mfma_f32_32x32x16_bf16 a[176:191], a[16:19], v[56:59], a[176:191]
    v_cvt_pk_bf16_f32 v224, v224, v225
    v_cvt_pk_bf16_f32 v225, v226, v227
    ds_write_b64 v8, v[224:225] offset:0
    v_cvt_pk_bf16_f32 v30, v228, v229
    v_mfma_f32_32x32x16_bf16 a[192:207], a[24:27], v[56:59], a[192:207]
    v_cvt_pk_bf16_f32 v31, v230, v231
    v_lshlrev_b32 v228, 16, v30
    v_and_b32 v229, 0xffff0000, v30
    v_lshlrev_b32 v230, 16, v31
    v_and_b32 v231, 0xffff0000, v31
    s_waitcnt vmcnt(26)
    v_mfma_f32_32x32x16_bf16 a[144:159], a[20:23], v[52:55], a[144:159]
    buffer_load_dwordx4 v[208:211], v13, s[44:47], s30 offen offset:0
    v_mul_f32 v228, v228, v252
    v_mul_f32 v229, v229, v252
    v_mul_f32 v230, v230, v252
    v_mfma_f32_32x32x16_bf16 a[160:175], a[28:31], v[52:55], a[160:175]
    v_mul_f32 v231, v231, v252
    v_cvt_pk_bf16_f32 v228, v228, v229
    v_cvt_pk_bf16_f32 v229, v230, v231
    ds_write_b64 v8, v[228:229] offset:32
    v_cvt_pk_bf16_f32 v30, v232, v233
    s_waitcnt vmcnt(26)
    v_mfma_f32_32x32x16_bf16 a[176:191], a[20:23], v[60:63], a[176:191]
    v_cvt_pk_bf16_f32 v31, v234, v235
    v_lshlrev_b32 v232, 16, v30
    v_and_b32 v233, 0xffff0000, v30
    v_lshlrev_b32 v234, 16, v31
    v_mfma_f32_32x32x16_bf16 a[192:207], a[28:31], v[60:63], a[192:207]
we_all_148:
wp_all_148:
    s_cmp_eq_u32 s43, 1
    s_cbranch_scc1 wr_0
    buffer_load_dwordx4 v[212:215], v13, s[44:47], s30 offen offset:1024
    v_and_b32 v235, 0xffff0000, v31
    v_mul_f32 v232, v232, v252
    v_mul_f32 v233, v233, v252
    v_mul_f32 v234, v234, v252
    s_waitcnt lgkmcnt(0)
    s_waitcnt lgkmcnt(0)
    s_and_b64 s[48:49], s[48:49], s[50:51]
    s_and_b64 s[48:49], s[48:49], s[52:53]
    s_and_b32 s48, s48, s49
    s_cmp_eq_u32 s48, 1
    s_cbranch_scc0 kf_kernel_p2_sl
kf_kernel_p2_bk:
    s_add_u32 m0, s35, 0
    s_nop 0
    buffer_load_dwordx4 v11, s[44:47], s24 offen offset:0 sc1 lds
    buffer_load_dwordx4 v11, s[44:47], s24 offen offset:1024 sc1 lds
    s_waitcnt vmcnt(28)
    v_mfma_f32_32x32x16_bf16 a[144:159], a[32:35], v[64:67], a[144:159]
    v_mul_f32 v235, v235, v252
    v_cvt_pk_bf16_f32 v232, v232, v233
    v_cvt_pk_bf16_f32 v233, v234, v235
    ds_write_b64 v8, v[232:233] offset:64
    v_mfma_f32_32x32x16_bf16 a[160:175], a[40:43], v[64:67], a[160:175]
    v_cvt_pk_bf16_f32 v30, v236, v237
    v_cvt_pk_bf16_f32 v31, v238, v239
    v_lshlrev_b32 v236, 16, v30
    v_and_b32 v237, 0xffff0000, v30
    v_lshlrev_b32 v238, 16, v31
    s_waitcnt vmcnt(27)
    v_mfma_f32_32x32x16_bf16 a[176:191], a[32:35], v[72:75], a[176:191]
    s_add_u32 m0, s35, 2048
    s_nop 0
    buffer_load_dwordx4 v15, s[44:47], s24 offen offset:0 sc1 lds
    v_and_b32 v239, 0xffff0000, v31
    v_mfma_f32_32x32x16_bf16 a[192:207], a[40:43], v[72:75], a[192:207]
    v_mul_f32 v236, v236, v252
    v_mul_f32 v237, v237, v252
    v_mul_f32 v238, v238, v252
    v_mul_f32 v239, v239, v252
    v_cvt_pk_bf16_f32 v236, v236, v237
    s_waitcnt vmcnt(27)
    v_mfma_f32_32x32x16_bf16 a[144:159], a[36:39], v[68:71], a[144:159]
we_all_149:
wp_all_149:
    s_cmp_eq_u32 s43, 1
    s_cbranch_scc1 wr_0
    v_cvt_pk_bf16_f32 v237, v238, v239
    ds_write_b64 v8, v[236:237] offset:96
    v_lshrrev_b32 v5, 3, v1
    v_and_b32 v6, 7, v1
    v_mfma_f32_32x32x16_bf16 a[160:175], a[44:47], v[68:71], a[160:175]
    buffer_load_dwordx4 v15, s[44:47], s24 offen offset:1024 sc1 lds
    v_mul_u32_u24 v9, 144, v5
    v_add_u32 v9, s68, v9
    s_waitcnt lgkmcnt(0)
    ds_read_b32 v26, v9 offset:128
    s_waitcnt vmcnt(27)
    v_mfma_f32_32x32x16_bf16 a[176:191], a[36:39], v[76:79], a[176:191]
    ds_read_b32 v28, v9 offset:1280
    v_lshl_add_u32 v9, v6, 4, v9
    ds_read_b128 v[224:227], v9
    ds_read_b128 v[228:231], v9 offset:1152
    v_mfma_f32_32x32x16_bf16 a[192:207], a[44:47], v[76:79], a[192:207]
    v_lshrrev_b32 v7, 1, v5
    v_xor_b32 v7, v7, v6
    v_lshlrev_b32 v7, 4, v7
    v_lshl_add_u32 v7, v5, 7, v7
    v_add_u32 v7, s11, v7
    s_load_dwordx2 s[16:17], s[40:41], s56 offset:3072 glc
    s_load_dwordx2 s[18:19], s[40:41], s57 offset:3072 glc
    s_load_dwordx2 s[20:21], s[40:41], s58 offset:3072 glc
    s_load_dwordx2 s[54:55], s[40:41], s59 offset:3072 glc
    s_waitcnt vmcnt(26)
    v_mfma_f32_32x32x16_bf16 a[144:159], a[48:51], v[80:83], a[144:159]
    s_add_u32 m0, s35, 4096
    s_nop 0
    buffer_load_dwordx4 v11, s[44:47], s25 offen offset:0 sc1 lds
    ds_read_b128 v[232:235], v7
    v_mfma_f32_32x32x16_bf16 a[160:175], a[56:59], v[80:83], a[160:175]
    v_xor_b32 v7, 64, v7
    ds_read_b128 v[236:239], v7 offset:1024
    s_lshl_b32 s72, s6, 6
    s_lshl_b32 s71, s3, 4
    s_add_u32 s72, s71, s72
    s_waitcnt vmcnt(26)
we_all_150:
wp_all_150:
    s_cmp_eq_u32 s43, 1
    s_cbranch_scc1 wr_0
    v_mfma_f32_32x32x16_bf16 a[176:191], a[48:51], v[88:91], a[176:191]
    v_add_u32 v24, s72, v5
    v_mul_u32_u24 v24, 896, v24
    v_lshl_add_u32 v24, v6, 4, v24
    s_lshl_b32 s69, s7, 7
    v_mfma_f32_32x32x16_bf16 a[192:207], a[56:59], v[88:91], a[192:207]
    buffer_load_dwordx4 v11, s[44:47], s25 offen offset:1024 sc1 lds
    v_add_u32 v24, s69, v24
    s_mov_b32 s101, 7168
    v_add_u32 v9, s71, v5
    v_mul_u32_u24 v9, 272, v9
    s_waitcnt vmcnt(26)
    v_mfma_f32_32x32x16_bf16 a[144:159], a[52:55], v[84:87], a[144:159]
    v_lshl_add_u32 v9, v6, 5, v9
    v_add_u32 v9, 32768, v9
    s_mul_i32 s68, s3, 17408
    s_add_u32 s68, s68, 32768
    v_mfma_f32_32x32x16_bf16 a[160:175], a[60:63], v[84:87], a[160:175]
    v_and_b32 v5, 31, v1
    v_mul_u32_u24 v8, 272, v5
    v_lshrrev_b32 v5, 5, v1
    v_lshl_add_u32 v8, v5, 5, v8
    v_add_u32 v8, s68, v8
    s_waitcnt vmcnt(25)
    v_mfma_f32_32x32x16_bf16 a[176:191], a[52:55], v[92:95], a[176:191]
    s_add_u32 m0, s35, 6144
    s_nop 0
    buffer_load_dwordx4 v15, s[44:47], s25 offen offset:0 sc1 lds
    s_waitcnt lgkmcnt(5)
    v_mov_b32 v27, v26
    v_mfma_f32_32x32x16_bf16 a[192:207], a[60:63], v[92:95], a[192:207]
    s_waitcnt lgkmcnt(4)
    v_mov_b32 v29, v28
    s_waitcnt vmcnt(25)
    v_mfma_f32_32x32x16_bf16 a[144:159], a[64:67], v[96:99], a[144:159]
    v_mfma_f32_32x32x16_bf16 a[160:175], a[72:75], v[96:99], a[160:175]
    buffer_load_dwordx4 v15, s[44:47], s25 offen offset:1024 sc1 lds
    s_waitcnt vmcnt(25)
    v_mfma_f32_32x32x16_bf16 a[176:191], a[64:67], v[104:107], a[176:191]
we_all_151:
wp_all_151:
    s_cmp_eq_u32 s43, 1
    s_cbranch_scc1 wr_0
    v_mfma_f32_32x32x16_bf16 a[192:207], a[72:75], v[104:107], a[192:207]
    s_waitcnt vmcnt(24)
    v_mfma_f32_32x32x16_bf16 a[144:159], a[68:71], v[100:103], a[144:159]
    s_add_u32 m0, s35, 8192
    s_nop 0
    buffer_load_dwordx4 v11, s[44:47], s26 offen offset:0 sc1 lds
    v_mfma_f32_32x32x16_bf16 a[160:175], a[76:79], v[100:103], a[160:175]
    s_waitcnt vmcnt(24)
    v_mfma_f32_32x32x16_bf16 a[176:191], a[68:71], v[108:111], a[176:191]
    v_mfma_f32_32x32x16_bf16 a[192:207], a[76:79], v[108:111], a[192:207]
    buffer_load_dwordx4 v11, s[44:47], s26 offen offset:1024 sc1 lds
    s_waitcnt lgkmcnt(0)
    s_waitcnt lgkmcnt(0)
    s_and_b64 s[16:17], s[16:17], s[18:19]
    s_and_b64 s[16:17], s[16:17], s[20:21]
    s_and_b64 s[16:17], s[16:17], s[54:55]
    s_and_b32 s16, s16, s17
    s_cmp_eq_u32 s16, 1
    s_cbranch_scc0 kf_kernel_p3_sl
kf_kernel_p3_bk:
    s_add_u32 m0, s35, 10240
    s_nop 0
    buffer_load_dwordx4 v15, s[44:47], s26 offen offset:0 sc1 lds
    buffer_load_dwordx4 v15, s[44:47], s26 offen offset:1024 sc1 lds
    s_waitcnt vmcnt(26)
    v_mfma_f32_32x32x16_bf16 a[144:159], a[80:83], v[112:115], a[144:159]
    v_mfma_f32_32x32x16_bf16 a[160:175], a[88:91], v[112:115], a[160:175]
    s_waitcnt vmcnt(25)
    v_mfma_f32_32x32x16_bf16 a[176:191], a[80:83], v[120:123], a[176:191]
    s_add_u32 m0, s35, 12288
    s_nop 0
    buffer_load_dwordx4 v11, s[44:47], s27 offen offset:0 sc1 lds
    v_mfma_f32_32x32x16_bf16 a[192:207], a[88:91], v[120:123], a[192:207]
    s_waitcnt vmcnt(25)
    v_mfma_f32_32x32x16_bf16 a[144:159], a[84:87], v[116:119], a[144:159]
    v_mfma_f32_32x32x16_bf16 a[160:175], a[92:95], v[116:119], a[160:175]
    buffer_load_dwordx4 v11, s[44:47], s27 offen offset:1024 sc1 lds
    s_waitcnt vmcnt(25)
    v_mfma_f32_32x32x16_bf16 a[176:191], a[84:87], v[124:127], a[176:191]
    v_mfma_f32_32x32x16_bf16 a[192:207], a[92:95], v[124:127], a[192:207]
    s_waitcnt vmcnt(24)
we_all_152:
wp_all_152:
    s_cmp_eq_u32 s43, 1
    s_cbranch_scc1 wr_0
    v_mfma_f32_32x32x16_bf16 a[144:159], a[96:99], v[128:131], a[144:159]
    s_add_u32 m0, s35, 14336
    s_nop 0
    buffer_load_dwordx4 v15, s[44:47], s27 offen offset:0 sc1 lds
    v_mfma_f32_32x32x16_bf16 a[160:175], a[104:107], v[128:131], a[160:175]
    s_waitcnt vmcnt(24)
    v_mfma_f32_32x32x16_bf16 a[176:191], a[96:99], v[136:139], a[176:191]
    v_mfma_f32_32x32x16_bf16 a[192:207], a[104:107], v[136:139], a[192:207]
    buffer_load_dwordx4 v15, s[44:47], s27 offen offset:1024 sc1 lds
    s_waitcnt vmcnt(12)
    ds_read_b128 v[32:35], v16 offset:0
    ds_read_b128 v[40:43], v16 offset:2048
    ds_read_b128 v[36:39], v16 offset:1024
    ds_read_b128 v[44:47], v16 offset:3072
    v_mfma_f32_32x32x16_bf16 a[144:159], a[100:103], v[132:135], a[144:159]
    v_mfma_f32_32x32x16_bf16 a[160:175], a[108:111], v[132:135], a[160:175]
    v_mfma_f32_32x32x16_bf16 a[176:191], a[100:103], v[140:143], a[176:191]
    buffer_load_dwordx4 a[208:211], v11, s[44:47], s24 offen offset:2048 sc1
    v_mfma_f32_32x32x16_bf16 a[192:207], a[108:111], v[140:143], a[192:207]
    s_waitcnt lgkmcnt(3)
    v_mfma_f32_32x32x16_bf16 a[144:159], a[112:115], v[32:35], a[144:159]
    v_mfma_f32_32x32x16_bf16 a[160:175], a[120:123], v[32:35], a[160:175]
    buffer_load_dwordx4 a[216:219], v15, s[44:47], s24 offen offset:2048 sc1
    s_waitcnt lgkmcnt(2)
    v_mfma_f32_32x32x16_bf16 a[176:191], a[112:115], v[40:43], a[176:191]
    v_mfma_f32_32x32x16_bf16 a[192:207], a[120:123], v[40:43], a[192:207]
    s_waitcnt vmcnt(10)
    ds_read_b128 v[48:51], v16 offset:4096
    ds_read_b128 v[56:59], v16 offset:6144
    ds_read_b128 v[52:55], v16 offset:5120
    ds_read_b128 v[60:63], v16 offset:7168
    s_waitcnt lgkmcnt(5)
    v_mfma_f32_32x32x16_bf16 a[144:159], a[116:119], v[36:39], a[144:159]
    buffer_load_dwordx4 a[212:215], v11, s[44:47], s24 offen offset:3072 sc1
    v_mfma_f32_32x32x16_bf16 a[160:175], a[124:127], v[36:39], a[160:175]
we_all_153:
wp_all_153:
    s_cmp_eq_u32 s43, 1
    s_cbranch_scc1 wr_0
    s_waitcnt lgkmcnt(4)
    v_mfma_f32_32x32x16_bf16 a[176:191], a[116:119], v[44:47], a[176:191]
    v_mfma_f32_32x32x16_bf16 a[192:207], a[124:127], v[44:47], a[192:207]
    buffer_load_dwordx4 a[220:223], v15, s[44:47], s24 offen offset:3072 sc1
    s_waitcnt lgkmcnt(3)
    v_mfma_f32_32x32x16_bf16 a[144:159], a[128:131], v[48:51], a[144:159]
    v_mfma_f32_32x32x16_bf16 a[160:175], a[136:139], v[48:51], a[160:175]
    s_waitcnt lgkmcnt(2)
    v_mfma_f32_32x32x16_bf16 a[176:191], a[128:131], v[56:59], a[176:191]
    buffer_load_dwordx4 a[224:227], v11, s[44:47], s25 offen offset:2048 sc1
    v_mfma_f32_32x32x16_bf16 a[192:207], a[136:139], v[56:59], a[192:207]
    s_waitcnt vmcnt(9)
    ds_read_b128 v[64:67], v16 offset:8192
    ds_read_b128 v[72:75], v16 offset:10240
    ds_read_b128 v[68:71], v16 offset:9216
    ds_read_b128 v[76:79], v16 offset:11264
    s_waitcnt lgkmcnt(5)
    v_mfma_f32_32x32x16_bf16 a[144:159], a[132:135], v[52:55], a[144:159]
    v_mfma_f32_32x32x16_bf16 a[160:175], a[140:143], v[52:55], a[160:175]
    buffer_load_dwordx4 a[232:235], v15, s[44:47], s25 offen offset:2048 sc1
    s_waitcnt lgkmcnt(4)
    v_mfma_f32_32x32x16_bf16 a[176:191], a[132:135], v[60:63], a[176:191]
    v_mfma_f32_32x32x16_bf16 a[192:207], a[140:143], v[60:63], a[192:207]
    buffer_load_dwordx4 a[228:231], v11, s[44:47], s25 offen offset:3072 sc1
    buffer_load_dwordx4 a[236:239], v15, s[44:47], s25 offen offset:3072 sc1
    buffer_load_dwordx4 a[240:243], v11, s[44:47], s26 offen offset:2048 sc1
    buffer_load_dwordx4 a[248:251], v15, s[44:47], s26 offen offset:2048 sc1
    buffer_load_dwordx4 a[244:247], v11, s[44:47], s26 offen offset:3072 sc1
    buffer_load_dwordx4 a[252:255], v15, s[44:47], s26 offen offset:3072 sc1
    buffer_load_dwordx4 v[216:219], v13, s[44:47], s30 offen offset:2048
    buffer_load_dwordx4 v[220:223], v13, s[44:47], s30 offen offset:3072
    s_waitcnt lgkmcnt(3)
    v_mfma_f32_32x32x16_bf16 a[144:159], v[144:147], v[64:67], a[144:159]
    v_mfma_f32_32x32x16_bf16 a[160:175], v[152:155], v[64:67], a[160:175]
we_all_154:
wp_all_154:
    s_cmp_eq_u32 s43, 1
    s_cbranch_scc1 wr_0
    s_waitcnt lgkmcnt(2)
    v_mfma_f32_32x32x16_bf16 a[176:191], v[144:147], v[72:75], a[176:191]
    v_mfma_f32_32x32x16_bf16 a[192:207], v[152:155], v[72:75], a[192:207]
    s_waitcnt vmcnt(14)
    ds_read_b128 v[80:83], v16 offset:12288
    ds_read_b128 v[88:91], v16 offset:14336
    ds_read_b128 v[84:87], v16 offset:13312
    ds_read_b128 v[92:95], v16 offset:15360
    s_waitcnt lgkmcnt(5)
    v_mfma_f32_32x32x16_bf16 a[144:159], v[148:151], v[68:71], a[144:159]
    v_mfma_f32_32x32x16_bf16 a[160:175], v[156:159], v[68:71], a[160:175]
    s_waitcnt lgkmcnt(4)
    v_mfma_f32_32x32x16_bf16 a[176:191], v[148:151], v[76:79], a[176:191]
    v_mfma_f32_32x32x16_bf16 a[192:207], v[156:159], v[76:79], a[192:207]
    s_waitcnt lgkmcnt(3)
    v_mfma_f32_32x32x16_bf16 a[144:159], v[160:163], v[80:83], a[144:159]
    v_mfma_f32_32x32x16_bf16 a[160:175], v[168:171], v[80:83], a[160:175]
    s_waitcnt lgkmcnt(2)
    v_mfma_f32_32x32x16_bf16 a[176:191], v[160:163], v[88:91], a[176:191]
    v_mfma_f32_32x32x16_bf16 a[192:207], v[168:171], v[88:91], a[192:207]
    s_waitcnt lgkmcnt(1)
    v_mfma_f32_32x32x16_bf16 a[144:159], v[164:167], v[84:87], a[144:159]
    v_mfma_f32_32x32x16_bf16 a[160:175], v[172:175], v[84:87], a[160:175]
    s_waitcnt lgkmcnt(0)
    v_mfma_f32_32x32x16_bf16 a[176:191], v[164:167], v[92:95], a[176:191]
    v_mfma_f32_32x32x16_bf16 a[192:207], v[172:175], v[92:95], a[192:207]
    s_waitcnt vmcnt(13)
    v_mfma_f32_32x32x16_bf16 a[144:159], v[176:179], a[208:211], a[144:159]
    v_lshlrev_b32 v160, 16, v224
    v_and_b32 v161, 0xffff0000, v224
    v_lshlrev_b32 v144, 16, v232
    v_and_b32 v145, 0xffff0000, v232
    v_mfma_f32_32x32x16_bf16 a[160:175], v[184:187], a[208:211], a[160:175]
    v_lshlrev_b32 v162, 16, v225
    v_and_b32 v163, 0xffff0000, v225
    v_lshlrev_b32 v146, 16, v233
    v_and_b32 v147, 0xffff0000, v233
    v_lshlrev_b32 v164, 16, v226
we_all_155:
wp_all_155:
    s_cmp_eq_u32 s43, 1
    s_cbranch_scc1 wr_0
    v_and_b32 v165, 0xffff0000, v226
    s_waitcnt vmcnt(12)
    v_mfma_f32_32x32x16_bf16 a[176:191], v[176:179], a[216:219], a[176:191]
    v_lshlrev_b32 v148, 16, v234
    v_and_b32 v149, 0xffff0000, v234
    v_lshlrev_b32 v166, 16, v227
    v_and_b32 v167, 0xffff0000, v227
    v_mfma_f32_32x32x16_bf16 a[192:207], v[184:187], a[216:219], a[192:207]
    v_lshlrev_b32 v150, 16, v235
    v_and_b32 v151, 0xffff0000, v235
    v_lshlrev_b32 v168, 16, v228
    v_and_b32 v169, 0xffff0000, v228
    v_lshlrev_b32 v152, 16, v236
    v_and_b32 v153, 0xffff0000, v236
    s_waitcnt vmcnt(11)
    v_mfma_f32_32x32x16_bf16 a[144:159], v[180:183], a[212:215], a[144:159]
    v_lshlrev_b32 v170, 16, v229
    v_and_b32 v171, 0xffff0000, v229
    v_lshlrev_b32 v154, 16, v237
    v_and_b32 v155, 0xffff0000, v237
    v_mfma_f32_32x32x16_bf16 a[160:175], v[188:191], a[212:215], a[160:175]
    v_lshlrev_b32 v172, 16, v230
    v_and_b32 v173, 0xffff0000, v230
    v_lshlrev_b32 v156, 16, v238
    v_and_b32 v157, 0xffff0000, v238
    v_lshlrev_b32 v174, 16, v231
    v_and_b32 v175, 0xffff0000, v231
    s_waitcnt vmcnt(10)
    v_mfma_f32_32x32x16_bf16 a[176:191], v[180:183], a[220:223], a[176:191]
    v_lshlrev_b32 v158, 16, v239
    v_and_b32 v159, 0xffff0000, v239
    v_mfma_f32_32x32x16_bf16 a[192:207], v[188:191], a[220:223], a[192:207]
    s_waitcnt vmcnt(9)
    v_mfma_f32_32x32x16_bf16 a[144:159], v[192:195], a[224:227], a[144:159]
    s_waitcnt vmcnt(7)
    v_mfma_f32_32x32x16_bf16 a[144:159], v[196:199], a[228:231], a[144:159]
    s_waitcnt vmcnt(5)
    v_mfma_f32_32x32x16_bf16 a[144:159], v[208:211], a[240:243], a[144:159]
    s_waitcnt vmcnt(3)
    v_mfma_f32_32x32x16_bf16 a[144:159], v[212:215], a[244:247], a[144:159]
we_all_156:
wp_all_156:
    s_cmp_eq_u32 s43, 1
    s_cbranch_scc1 wr_0
    v_mfma_f32_32x32x16_bf16 a[160:175], v[200:203], a[224:227], a[160:175]
    v_mfma_f32_32x32x16_bf16 a[160:175], v[204:207], a[228:231], a[160:175]
    s_waitcnt vmcnt(1)
    v_mfma_f32_32x32x16_bf16 a[160:175], v[216:219], a[240:243], a[160:175]
    ds_write_b128 v8, a[144:147] offset:0
    ds_write_b128 v8, a[148:151] offset:16
    s_waitcnt vmcnt(0)
    v_mfma_f32_32x32x16_bf16 a[160:175], v[220:223], a[244:247], a[160:175]
    ds_write_b128 v8, a[152:155] offset:64
    ds_write_b128 v8, a[156:159] offset:80
    v_mfma_f32_32x32x16_bf16 a[176:191], v[192:195], a[232:235], a[176:191]
    v_mfma_f32_32x32x16_bf16 a[176:191], v[196:199], a[236:239], a[176:191]
    v_mfma_f32_32x32x16_bf16 a[176:191], v[208:211], a[248:251], a[176:191]
    ds_write_b128 v8, a[160:163] offset:128
    ds_write_b128 v8, a[164:167] offset:144
    v_mfma_f32_32x32x16_bf16 a[176:191], v[212:215], a[252:255], a[176:191]
    ds_write_b128 v8, a[168:171] offset:192
    ds_write_b128 v8, a[172:175] offset:208
    v_mfma_f32_32x32x16_bf16 a[192:207], v[200:203], a[232:235], a[192:207]
    v_mfma_f32_32x32x16_bf16 a[192:207], v[204:207], a[236:239], a[192:207]
    v_mfma_f32_32x32x16_bf16 a[192:207], v[216:219], a[248:251], a[192:207]
    ds_write_b128 v8, a[176:179] offset:8704
    ds_write_b128 v8, a[180:183] offset:8720
    v_mfma_f32_32x32x16_bf16 a[192:207], v[220:223], a[252:255], a[192:207]
    ds_write_b128 v8, a[184:187] offset:8768
    ds_write_b128 v8, a[188:191] offset:8784
    s_nop 7
    s_nop 1
    ds_write_b128 v8, a[192:195] offset:8832
    ds_write_b128 v8, a[196:199] offset:8848
    ds_write_b128 v8, a[200:203] offset:8896
    ds_write_b128 v8, a[204:207] offset:8912
    s_waitcnt lgkmcnt(0)
    s_barrier
we_all_157:
wp_all_157:
    s_cmp_eq_u32 s43, 1
    s_cbranch_scc1 wr_0
    ds_read_b128 v[32:35], v9 offset:0
    ds_read_b128 v[36:39], v9 offset:16
    ds_read_b128 v[40:43], v9 offset:17408
    ds_read_b128 v[44:47], v9 offset:17424
    ds_read_b128 v[48:51], v9 offset:34816
    ds_read_b128 v[52:55], v9 offset:34832
    ds_read_b128 v[56:59], v9 offset:52224
    ds_read_b128 v[60:63], v9 offset:52240
    ds_read_b128 v[64:67], v9 offset:2176
    ds_read_b128 v[68:71], v9 offset:2192
    ds_read_b128 v[72:75], v9 offset:19584
    ds_read_b128 v[76:79], v9 offset:19600
    ds_read_b128 v[80:83], v9 offset:36992
    ds_read_b128 v[84:87], v9 offset:37008
    ds_read_b128 v[88:91], v9 offset:54400
    ds_read_b128 v[92:95], v9 offset:54416
    s_waitcnt lgkmcnt(13)
    v_pk_add_f32 v[32:33], v[32:33], v[40:41]
    v_pk_add_f32 v[34:35], v[34:35], v[42:43]
    s_waitcnt lgkmcnt(12)
    v_pk_add_f32 v[36:37], v[36:37], v[44:45]
    v_pk_add_f32 v[38:39], v[38:39], v[46:47]
    s_waitcnt lgkmcnt(9)
    v_pk_add_f32 v[48:49], v[48:49], v[56:57]
    v_pk_add_f32 v[50:51], v[50:51], v[58:59]
    s_waitcnt lgkmcnt(8)
    v_pk_add_f32 v[52:53], v[52:53], v[60:61]
    v_pk_add_f32 v[54:55], v[54:55], v[62:63]
    v_pk_add_f32 v[32:33], v[32:33], v[48:49]
    v_pk_add_f32 v[34:35], v[34:35], v[50:51]
    v_pk_add_f32 v[36:37], v[36:37], v[52:53]
    v_pk_add_f32 v[38:39], v[38:39], v[54:55]
    v_cvt_pk_bf16_f32 v96, v32, v33
we_all_158:
wp_all_158:
    s_cmp_eq_u32 s43, 1
    s_cbranch_scc1 wr_0
    v_cvt_pk_bf16_f32 v97, v34, v35
    v_cvt_pk_bf16_f32 v98, v36, v37
    v_cvt_pk_bf16_f32 v99, v38, v39
    v_lshlrev_b32 v32, 16, v96
    v_and_b32 v33, 0xffff0000, v96
    v_lshlrev_b32 v34, 16, v97
    v_and_b32 v35, 0xffff0000, v97
    v_lshlrev_b32 v36, 16, v98
    v_and_b32 v37, 0xffff0000, v98
    v_lshlrev_b32 v38, 16, v99
    v_and_b32 v39, 0xffff0000, v99
    v_pk_add_f32 v[32:33], v[32:33], v[144:145]
    v_pk_add_f32 v[34:35], v[34:35], v[146:147]
    v_pk_add_f32 v[36:37], v[36:37], v[148:149]
    v_pk_add_f32 v[38:39], v[38:39], v[150:151]
    v_cvt_pk_bf16_f32 v96, v32, v33
    v_cvt_pk_bf16_f32 v97, v34, v35
    v_cvt_pk_bf16_f32 v98, v36, v37
    v_cvt_pk_bf16_f32 v99, v38, v39
    v_lshlrev_b32 v32, 16, v96
    v_and_b32 v33, 0xffff0000, v96
    v_lshlrev_b32 v34, 16, v97
    v_and_b32 v35, 0xffff0000, v97
    v_lshlrev_b32 v36, 16, v98
    v_and_b32 v37, 0xffff0000, v98
    v_lshlrev_b32 v38, 16, v99
    v_and_b32 v39, 0xffff0000, v99
    v_pk_mul_f32 v[32:33], v[32:33], v[26:27]
    v_pk_mul_f32 v[34:35], v[34:35], v[26:27]
    v_pk_mul_f32 v[36:37], v[36:37], v[26:27]
    v_pk_mul_f32 v[38:39], v[38:39], v[26:27]
    v_cvt_pk_bf16_f32 v96, v32, v33
    v_cvt_pk_bf16_f32 v97, v34, v35
    v_cvt_pk_bf16_f32 v98, v36, v37
    v_cvt_pk_bf16_f32 v99, v38, v39
we_all_159:
wp_all_159:
    s_cmp_eq_u32 s43, 1
    s_cbranch_scc1 wr_0
    v_lshlrev_b32 v32, 16, v96
    v_and_b32 v33, 0xffff0000, v96
    v_lshlrev_b32 v34, 16, v97
    v_and_b32 v35, 0xffff0000, v97
    v_lshlrev_b32 v36, 16, v98
    v_and_b32 v37, 0xffff0000, v98
    v_lshlrev_b32 v38, 16, v99
    v_and_b32 v39, 0xffff0000, v99
    v_pk_add_f32 v[32:33], v[32:33], v[160:161]
    v_pk_add_f32 v[34:35], v[34:35], v[162:163]
    v_pk_add_f32 v[36:37], v[36:37], v[164:165]
    v_pk_add_f32 v[38:39], v[38:39], v[166:167]
    v_cvt_pk_bf16_f32 v96, v32, v33
    v_cvt_pk_bf16_f32 v97, v34, v35
    v_cvt_pk_bf16_f32 v98, v36, v37
    v_cvt_pk_bf16_f32 v99, v38, v39
    buffer_store_dwordx4 v[96:99], v24, s[60:63], 0 offen sc1
    s_waitcnt lgkmcnt(5)
    v_pk_add_f32 v[64:65], v[64:65], v[72:73]
    v_pk_add_f32 v[66:67], v[66:67], v[74:75]
    s_waitcnt lgkmcnt(4)
    v_pk_add_f32 v[68:69], v[68:69], v[76:77]
    v_pk_add_f32 v[70:71], v[70:71], v[78:79]
    s_waitcnt lgkmcnt(1)
    v_pk_add_f32 v[80:81], v[80:81], v[88:89]
    v_pk_add_f32 v[82:83], v[82:83], v[90:91]
    s_waitcnt lgkmcnt(0)
    v_pk_add_f32 v[84:85], v[84:85], v[92:93]
    v_pk_add_f32 v[86:87], v[86:87], v[94:95]
    v_pk_add_f32 v[64:65], v[64:65], v[80:81]
    v_pk_add_f32 v[66:67], v[66:67], v[82:83]
    v_pk_add_f32 v[68:69], v[68:69], v[84:85]
    v_pk_add_f32 v[70:71], v[70:71], v[86:87]
    v_cvt_pk_bf16_f32 v100, v64, v65
    v_cvt_pk_bf16_f32 v101, v66, v67
we_all_160:
wp_all_160:
    s_cmp_eq_u32 s43, 1
    s_cbranch_scc1 wr_0
    v_cvt_pk_bf16_f32 v102, v68, v69
    v_cvt_pk_bf16_f32 v103, v70, v71
    v_lshlrev_b32 v64, 16, v100
    v_and_b32 v65, 0xffff0000, v100
    v_lshlrev_b32 v66, 16, v101
    v_and_b32 v67, 0xffff0000, v101
    v_lshlrev_b32 v68, 16, v102
    v_and_b32 v69, 0xffff0000, v102
    v_lshlrev_b32 v70, 16, v103
    v_and_b32 v71, 0xffff0000, v103
    v_pk_add_f32 v[64:65], v[64:65], v[152:153]
    v_pk_add_f32 v[66:67], v[66:67], v[154:155]
    v_pk_add_f32 v[68:69], v[68:69], v[156:157]
    v_pk_add_f32 v[70:71], v[70:71], v[158:159]
    v_cvt_pk_bf16_f32 v100, v64, v65
    v_cvt_pk_bf16_f32 v101, v66, v67
    v_cvt_pk_bf16_f32 v102, v68, v69
    v_cvt_pk_bf16_f32 v103, v70, v71
    v_lshlrev_b32 v64, 16, v100
    v_and_b32 v65, 0xffff0000, v100
    v_lshlrev_b32 v66, 16, v101
    v_and_b32 v67, 0xffff0000, v101
    v_lshlrev_b32 v68, 16, v102
    v_and_b32 v69, 0xffff0000, v102
    v_lshlrev_b32 v70, 16, v103
    v_and_b32 v71, 0xffff0000, v103
    v_pk_mul_f32 v[64:65], v[64:65], v[28:29]
    v_pk_mul_f32 v[66:67], v[66:67], v[28:29]
    v_pk_mul_f32 v[68:69], v[68:69], v[28:29]
    v_pk_mul_f32 v[70:71], v[70:71], v[28:29]
    v_cvt_pk_bf16_f32 v100, v64, v65
    v_cvt_pk_bf16_f32 v101, v66, v67
    v_cvt_pk_bf16_f32 v102, v68, v69
    v_cvt_pk_bf16_f32 v103, v70, v71
    v_lshlrev_b32 v64, 16, v100
    v_and_b32 v65, 0xffff0000, v100
we_all_161:
wp_all_161:
    s_cmp_eq_u32 s43, 1
    s_cbranch_scc1 wr_0
    v_lshlrev_b32 v66, 16, v101
    v_and_b32 v67, 0xffff0000, v101
    v_lshlrev_b32 v68, 16, v102
    v_and_b32 v69, 0xffff0000, v102
    v_lshlrev_b32 v70, 16, v103
    v_and_b32 v71, 0xffff0000, v103
    v_pk_add_f32 v[64:65], v[64:65], v[168:169]
    v_pk_add_f32 v[66:67], v[66:67], v[170:171]
    v_pk_add_f32 v[68:69], v[68:69], v[172:173]
    v_pk_add_f32 v[70:71], v[70:71], v[174:175]
    v_cvt_pk_bf16_f32 v100, v64, v65
    v_cvt_pk_bf16_f32 v101, v66, v67
    v_cvt_pk_bf16_f32 v102, v68, v69
    v_cvt_pk_bf16_f32 v103, v70, v71
    buffer_store_dwordx4 v[100:103], v24, s[60:63], s101 offen sc1
    s_endpgm
kf_kernel_o:
    v_mov_b32 v246, 1
we_all_162:
wp_all_162:
    s_cmp_eq_u32 s43, 1
    s_cbranch_scc1 wr_0
    s_lshl_b32 s68, s2, 12
    s_add_u32 s68, s68, 0x1500000
    s_lshl_b32 s69, s3, 2
    s_add_u32 s68, s68, s69
    v_mov_b32 v247, s68
    s_sub_u32 s68, s2, 224
    s_and_b32 s69, s68, 7
    s_lshl_b32 s69, s69, 1
    s_lshr_b32 s70, s68, 4
    s_add_u32 s69, s69, s70
    s_bfe_u32 s70, s68, 0x10003
    s_lshl_b32 s70, s70, 2
    s_add_u32 s70, s70, s3
    s_lshl_b32 s70, s70, 8
    s_lshl_b32 s8, s69, 2
    s_add_u32 s8, s8, s3
    s_lshl_b32 s8, s8, 11
    s_add_u32 s70, s70, s69
    s_lshl_b32 s9, s70, 11
    s_lshl_b32 s10, s70, 10
    v_mov_b32 v7, 0x7f000000
    v_cmp_eq_u32 vcc, 3, v4
    s_nop 1
    v_cndmask_b32 v6, v10, v7, vcc
    v_lshlrev_b32 v8, 5, v1
    s_waitcnt lgkmcnt(0)
we_all_163:
wp_all_163:
    s_cmp_eq_u32 s43, 1
    s_cbranch_scc1 wr_0
    s_add_u32 s48, s40, 0x200000
    s_addc_u32 s49, s41, 0
    s_mov_b32 s50, 0x400000
    s_mov_b32 s51, 0x20000
    s_add_u32 s52, s40, 0x600000
    s_addc_u32 s53, s41, 0
    s_mov_b32 s54, 0x200000
    s_mov_b32 s55, 0x20000
    s_add_u32 s56, s40, 0xb00000
    s_addc_u32 s57, s41, 0
    s_mov_b32 s58, 0x200000
    s_mov_b32 s59, 0x20000
    s_mov_b32 s44, s40
    s_mov_b32 s45, s41
    s_mov_b32 s46, 0x1c00000
    s_mov_b32 s47, 0x20000
    buffer_load_dwordx4 v[64:67], v10, s[52:55], s8 offen
    s_add_u32 s8, s8, 131072
    buffer_load_dwordx4 v[68:71], v10, s[52:55], s8 offen
    s_add_u32 s8, s8, 131072
    buffer_load_dwordx4 v[72:75], v10, s[52:55], s8 offen
    s_add_u32 s8, s8, 131072
    buffer_load_dwordx4 v[76:79], v10, s[52:55], s8 offen
    s_add_u32 s8, s8, 131072
    buffer_load_dwordx4 v[80:83], v10, s[52:55], s8 offen
    s_add_u32 s8, s8, 131072
    buffer_load_dwordx4 v[84:87], v10, s[52:55], s8 offen
    s_add_u32 s8, s8, 131072
    buffer_load_dwordx4 v[88:91], v10, s[52:55], s8 offen
    s_add_u32 s8, s8, 131072
    buffer_load_dwordx4 v[92:95], v10, s[52:55], s8 offen
    s_add_u32 s8, s8, 131072
    buffer_load_dwordx4 v[96:99], v10, s[52:55], s8 offen
    s_add_u32 s8, s8, 131072
we_all_164:
wp_all_164:
    s_cmp_eq_u32 s43, 1
    s_cbranch_scc1 wr_0
    buffer_load_dwordx4 v[100:103], v10, s[52:55], s8 offen
    s_add_u32 s8, s8, 131072
    buffer_load_dwordx4 v[104:107], v10, s[52:55], s8 offen
    s_add_u32 s8, s8, 131072
    buffer_load_dwordx4 v[108:111], v10, s[52:55], s8 offen
    s_add_u32 s8, s8, 131072
    buffer_load_dwordx4 v[112:115], v10, s[52:55], s8 offen
    s_add_u32 s8, s8, 131072
    buffer_load_dwordx4 v[116:119], v10, s[52:55], s8 offen
    s_add_u32 s8, s8, 131072
    buffer_load_dwordx4 v[120:123], v10, s[52:55], s8 offen
    s_add_u32 s8, s8, 131072
    buffer_load_dwordx4 v[124:127], v10, s[52:55], s8 offen
    buffer_load_dwordx4 a[32:35], v10, s[48:51], s9 offen
    buffer_load_dwordx4 a[36:39], v6, s[48:51], s9 offen offset:1024
    s_add_u32 s9, s9, 32768
    buffer_load_dwordx4 a[40:43], v10, s[48:51], s9 offen
    buffer_load_dwordx4 a[44:47], v6, s[48:51], s9 offen offset:1024
    s_add_u32 s9, s9, 32768
    buffer_load_dwordx4 a[48:51], v10, s[48:51], s9 offen
    buffer_load_dwordx4 a[52:55], v6, s[48:51], s9 offen offset:1024
    s_add_u32 s9, s9, 32768
    buffer_load_dwordx4 a[56:59], v10, s[48:51], s9 offen
    buffer_load_dwordx4 a[60:63], v6, s[48:51], s9 offen offset:1024
    s_add_u32 s9, s9, 32768
    buffer_load_dwordx4 a[64:67], v10, s[48:51], s9 offen
    buffer_load_dwordx4 a[68:71], v6, s[48:51], s9 offen offset:1024
    s_add_u32 s9, s9, 32768
    buffer_load_dwordx4 a[72:75], v10, s[48:51], s9 offen
    buffer_load_dwordx4 a[76:79], v6, s[48:51], s9 offen offset:1024
    s_add_u32 s9, s9, 32768
we_all_165:
wp_all_165:
    s_cmp_eq_u32 s43, 1
    s_cbranch_scc1 wr_0
    buffer_load_dwordx4 a[80:83], v10, s[48:51], s9 offen
    buffer_load_dwordx4 a[84:87], v6, s[48:51], s9 offen offset:1024
    s_add_u32 s9, s9, 32768
    buffer_load_dwordx4 a[88:91], v10, s[48:51], s9 offen
    buffer_load_dwordx4 a[92:95], v6, s[48:51], s9 offen offset:1024
    s_add_u32 s9, s9, 32768
    buffer_load_dwordx4 a[96:99], v10, s[48:51], s9 offen
    buffer_load_dwordx4 a[100:103], v6, s[48:51], s9 offen offset:1024
    s_add_u32 s9, s9, 32768
    buffer_load_dwordx4 a[104:107], v10, s[48:51], s9 offen
    buffer_load_dwordx4 a[108:111], v6, s[48:51], s9 offen offset:1024
    s_add_u32 s9, s9, 32768
    buffer_load_dwordx4 a[112:115], v10, s[48:51], s9 offen
    buffer_load_dwordx4 a[116:119], v6, s[48:51], s9 offen offset:1024
    s_add_u32 s9, s9, 32768
    buffer_load_dwordx4 a[120:123], v10, s[48:51], s9 offen
    buffer_load_dwordx4 a[124:127], v6, s[48:51], s9 offen offset:1024
    s_add_u32 s9, s9, 32768
    buffer_load_dwordx4 a[128:131], v10, s[48:51], s9 offen
    buffer_load_dwordx4 a[132:135], v6, s[48:51], s9 offen offset:1024
    s_add_u32 s9, s9, 32768
    buffer_load_dwordx4 a[136:139], v10, s[48:51], s9 offen
    buffer_load_dwordx4 a[140:143], v6, s[48:51], s9 offen offset:1024
    s_add_u32 s9, s9, 32768
    buffer_load_dwordx4 a[144:147], v10, s[48:51], s9 offen
    buffer_load_dwordx4 a[148:151], v6, s[48:51], s9 offen offset:1024
    s_add_u32 s9, s9, 32768
    buffer_load_dwordx4 a[152:155], v10, s[48:51], s9 offen
    buffer_load_dwordx4 a[156:159], v6, s[48:51], s9 offen offset:1024
    s_waitcnt vmcnt(47)
    v_fma_mix_f32 v32, v64, 1.0, 0 op_sel_hi:[1,0,0]
we_all_166:
wp_all_166:
    s_cmp_eq_u32 s43, 1
    s_cbranch_scc1 wr_0
    v_fma_mix_f32 v33, v64, 1.0, 0 op_sel:[1,0,0] op_sel_hi:[1,0,0]
    v_fma_mix_f32 v34, v65, 1.0, 0 op_sel_hi:[1,0,0]
    v_fma_mix_f32 v35, v65, 1.0, 0 op_sel:[1,0,0] op_sel_hi:[1,0,0]
    v_fma_mix_f32 v36, v66, 1.0, 0 op_sel_hi:[1,0,0]
    v_fma_mix_f32 v37, v66, 1.0, 0 op_sel:[1,0,0] op_sel_hi:[1,0,0]
    v_fma_mix_f32 v38, v67, 1.0, 0 op_sel_hi:[1,0,0]
    v_fma_mix_f32 v39, v67, 1.0, 0 op_sel:[1,0,0] op_sel_hi:[1,0,0]
    s_waitcnt vmcnt(46)
    v_fma_mix_f32 v32, v68, 1.0, v32 op_sel_hi:[1,0,0]
    v_fma_mix_f32 v33, v68, 1.0, v33 op_sel:[1,0,0] op_sel_hi:[1,0,0]
    v_fma_mix_f32 v34, v69, 1.0, v34 op_sel_hi:[1,0,0]
    v_fma_mix_f32 v35, v69, 1.0, v35 op_sel:[1,0,0] op_sel_hi:[1,0,0]
    v_fma_mix_f32 v36, v70, 1.0, v36 op_sel_hi:[1,0,0]
    v_fma_mix_f32 v37, v70, 1.0, v37 op_sel:[1,0,0] op_sel_hi:[1,0,0]
    v_fma_mix_f32 v38, v71, 1.0, v38 op_sel_hi:[1,0,0]
    v_fma_mix_f32 v39, v71, 1.0, v39 op_sel:[1,0,0] op_sel_hi:[1,0,0]
    s_waitcnt vmcnt(45)
    v_fma_mix_f32 v32, v72, 1.0, v32 op_sel_hi:[1,0,0]
    v_fma_mix_f32 v33, v72, 1.0, v33 op_sel:[1,0,0] op_sel_hi:[1,0,0]
    v_fma_mix_f32 v34, v73, 1.0, v34 op_sel_hi:[1,0,0]
    v_fma_mix_f32 v35, v73, 1.0, v35 op_sel:[1,0,0] op_sel_hi:[1,0,0]
    v_fma_mix_f32 v36, v74, 1.0, v36 op_sel_hi:[1,0,0]
    v_fma_mix_f32 v37, v74, 1.0, v37 op_sel:[1,0,0] op_sel_hi:[1,0,0]
    v_fma_mix_f32 v38, v75, 1.0, v38 op_sel_hi:[1,0,0]
    v_fma_mix_f32 v39, v75, 1.0, v39 op_sel:[1,0,0] op_sel_hi:[1,0,0]
    s_waitcnt vmcnt(44)
    v_fma_mix_f32 v32, v76, 1.0, v32 op_sel_hi:[1,0,0]
    v_fma_mix_f32 v33, v76, 1.0, v33 op_sel:[1,0,0] op_sel_hi:[1,0,0]
    v_fma_mix_f32 v34, v77, 1.0, v34 op_sel_hi:[1,0,0]
    v_fma_mix_f32 v35, v77, 1.0, v35 op_sel:[1,0,0] op_sel_hi:[1,0,0]
    v_fma_mix_f32 v36, v78, 1.0, v36 op_sel_hi:[1,0,0]
    v_fma_mix_f32 v37, v78, 1.0, v37 op_sel:[1,0,0] op_sel_hi:[1,0,0]
    v_fma_mix_f32 v38, v79, 1.0, v38 op_sel_hi:[1,0,0]
we_all_167:
wp_all_167:
    s_cmp_eq_u32 s43, 1
    s_cbranch_scc1 wr_0
    v_fma_mix_f32 v39, v79, 1.0, v39 op_sel:[1,0,0] op_sel_hi:[1,0,0]
    s_waitcnt vmcnt(43)
    v_fma_mix_f32 v32, v80, 1.0, v32 op_sel_hi:[1,0,0]
    v_fma_mix_f32 v33, v80, 1.0, v33 op_sel:[1,0,0] op_sel_hi:[1,0,0]
    v_fma_mix_f32 v34, v81, 1.0, v34 op_sel_hi:[1,0,0]
    v_fma_mix_f32 v35, v81, 1.0, v35 op_sel:[1,0,0] op_sel_hi:[1,0,0]
    v_fma_mix_f32 v36, v82, 1.0, v36 op_sel_hi:[1,0,0]
    v_fma_mix_f32 v37, v82, 1.0, v37 op_sel:[1,0,0] op_sel_hi:[1,0,0]
    v_fma_mix_f32 v38, v83, 1.0, v38 op_sel_hi:[1,0,0]
    v_fma_mix_f32 v39, v83, 1.0, v39 op_sel:[1,0,0] op_sel_hi:[1,0,0]
    s_waitcnt vmcnt(42)
    v_fma_mix_f32 v32, v84, 1.0, v32 op_sel_hi:[1,0,0]
    v_fma_mix_f32 v33, v84, 1.0, v33 op_sel:[1,0,0] op_sel_hi:[1,0,0]
    v_fma_mix_f32 v34, v85, 1.0, v34 op_sel_hi:[1,0,0]
    v_fma_mix_f32 v35, v85, 1.0, v35 op_sel:[1,0,0] op_sel_hi:[1,0,0]
    v_fma_mix_f32 v36, v86, 1.0, v36 op_sel_hi:[1,0,0]
    v_fma_mix_f32 v37, v86, 1.0, v37 op_sel:[1,0,0] op_sel_hi:[1,0,0]
    v_fma_mix_f32 v38, v87, 1.0, v38 op_sel_hi:[1,0,0]
    v_fma_mix_f32 v39, v87, 1.0, v39 op_sel:[1,0,0] op_sel_hi:[1,0,0]
    s_waitcnt vmcnt(41)
    v_fma_mix_f32 v32, v88, 1.0, v32 op_sel_hi:[1,0,0]
    v_fma_mix_f32 v33, v88, 1.0, v33 op_sel:[1,0,0] op_sel_hi:[1,0,0]
    v_fma_mix_f32 v34, v89, 1.0, v34 op_sel_hi:[1,0,0]
    v_fma_mix_f32 v35, v89, 1.0, v35 op_sel:[1,0,0] op_sel_hi:[1,0,0]
    v_fma_mix_f32 v36, v90, 1.0, v36 op_sel_hi:[1,0,0]
    v_fma_mix_f32 v37, v90, 1.0, v37 op_sel:[1,0,0] op_sel_hi:[1,0,0]
    v_fma_mix_f32 v38, v91, 1.0, v38 op_sel_hi:[1,0,0]
    v_fma_mix_f32 v39, v91, 1.0, v39 op_sel:[1,0,0] op_sel_hi:[1,0,0]
    s_waitcnt vmcnt(40)
    v_fma_mix_f32 v32, v92, 1.0, v32 op_sel_hi:[1,0,0]
    v_fma_mix_f32 v33, v92, 1.0, v33 op_sel:[1,0,0] op_sel_hi:[1,0,0]
    v_fma_mix_f32 v34, v93, 1.0, v34 op_sel_hi:[1,0,0]
    v_fma_mix_f32 v35, v93, 1.0, v35 op_sel:[1,0,0] op_sel_hi:[1,0,0]
we_all_168:
wp_all_168:
    s_cmp_eq_u32 s43, 1
    s_cbranch_scc1 wr_0
    v_fma_mix_f32 v36, v94, 1.0, v36 op_sel_hi:[1,0,0]
    v_fma_mix_f32 v37, v94, 1.0, v37 op_sel:[1,0,0] op_sel_hi:[1,0,0]
    v_fma_mix_f32 v38, v95, 1.0, v38 op_sel_hi:[1,0,0]
    v_fma_mix_f32 v39, v95, 1.0, v39 op_sel:[1,0,0] op_sel_hi:[1,0,0]
    s_waitcnt vmcnt(39)
    v_fma_mix_f32 v32, v96, 1.0, v32 op_sel_hi:[1,0,0]
    v_fma_mix_f32 v33, v96, 1.0, v33 op_sel:[1,0,0] op_sel_hi:[1,0,0]
    v_fma_mix_f32 v34, v97, 1.0, v34 op_sel_hi:[1,0,0]
    v_fma_mix_f32 v35, v97, 1.0, v35 op_sel:[1,0,0] op_sel_hi:[1,0,0]
    v_fma_mix_f32 v36, v98, 1.0, v36 op_sel_hi:[1,0,0]
    v_fma_mix_f32 v37, v98, 1.0, v37 op_sel:[1,0,0] op_sel_hi:[1,0,0]
    v_fma_mix_f32 v38, v99, 1.0, v38 op_sel_hi:[1,0,0]
    v_fma_mix_f32 v39, v99, 1.0, v39 op_sel:[1,0,0] op_sel_hi:[1,0,0]
    s_waitcnt vmcnt(38)
    v_fma_mix_f32 v32, v100, 1.0, v32 op_sel_hi:[1,0,0]
    v_fma_mix_f32 v33, v100, 1.0, v33 op_sel:[1,0,0] op_sel_hi:[1,0,0]
    v_fma_mix_f32 v34, v101, 1.0, v34 op_sel_hi:[1,0,0]
    v_fma_mix_f32 v35, v101, 1.0, v35 op_sel:[1,0,0] op_sel_hi:[1,0,0]
    v_fma_mix_f32 v36, v102, 1.0, v36 op_sel_hi:[1,0,0]
    v_fma_mix_f32 v37, v102, 1.0, v37 op_sel:[1,0,0] op_sel_hi:[1,0,0]
    v_fma_mix_f32 v38, v103, 1.0, v38 op_sel_hi:[1,0,0]
    v_fma_mix_f32 v39, v103, 1.0, v39 op_sel:[1,0,0] op_sel_hi:[1,0,0]
    s_waitcnt vmcnt(37)
    v_fma_mix_f32 v32, v104, 1.0, v32 op_sel_hi:[1,0,0]
    v_fma_mix_f32 v33, v104, 1.0, v33 op_sel:[1,0,0] op_sel_hi:[1,0,0]
    v_fma_mix_f32 v34, v105, 1.0, v34 op_sel_hi:[1,0,0]
    v_fma_mix_f32 v35, v105, 1.0, v35 op_sel:[1,0,0] op_sel_hi:[1,0,0]
    v_fma_mix_f32 v36, v106, 1.0, v36 op_sel_hi:[1,0,0]
    v_fma_mix_f32 v37, v106, 1.0, v37 op_sel:[1,0,0] op_sel_hi:[1,0,0]
    v_fma_mix_f32 v38, v107, 1.0, v38 op_sel_hi:[1,0,0]
    v_fma_mix_f32 v39, v107, 1.0, v39 op_sel:[1,0,0] op_sel_hi:[1,0,0]
    s_waitcnt vmcnt(36)
    v_fma_mix_f32 v32, v108, 1.0, v32 op_sel_hi:[1,0,0]
we_all_169:
wp_all_169:
    s_cmp_eq_u32 s43, 1
    s_cbranch_scc1 wr_0
    v_fma_mix_f32 v33, v108, 1.0, v33 op_sel:[1,0,0] op_sel_hi:[1,0,0]
    v_fma_mix_f32 v34, v109, 1.0, v34 op_sel_hi:[1,0,0]
    v_fma_mix_f32 v35, v109, 1.0, v35 op_sel:[1,0,0] op_sel_hi:[1,0,0]
    v_fma_mix_f32 v36, v110, 1.0, v36 op_sel_hi:[1,0,0]
    v_fma_mix_f32 v37, v110, 1.0, v37 op_sel:[1,0,0] op_sel_hi:[1,0,0]
    v_fma_mix_f32 v38, v111, 1.0, v38 op_sel_hi:[1,0,0]
    v_fma_mix_f32 v39, v111, 1.0, v39 op_sel:[1,0,0] op_sel_hi:[1,0,0]
    s_waitcnt vmcnt(35)
    v_fma_mix_f32 v32, v112, 1.0, v32 op_sel_hi:[1,0,0]
    v_fma_mix_f32 v33, v112, 1.0, v33 op_sel:[1,0,0] op_sel_hi:[1,0,0]
    v_fma_mix_f32 v34, v113, 1.0, v34 op_sel_hi:[1,0,0]
    v_fma_mix_f32 v35, v113, 1.0, v35 op_sel:[1,0,0] op_sel_hi:[1,0,0]
    v_fma_mix_f32 v36, v114, 1.0, v36 op_sel_hi:[1,0,0]
    v_fma_mix_f32 v37, v114, 1.0, v37 op_sel:[1,0,0] op_sel_hi:[1,0,0]
    v_fma_mix_f32 v38, v115, 1.0, v38 op_sel_hi:[1,0,0]
    v_fma_mix_f32 v39, v115, 1.0, v39 op_sel:[1,0,0] op_sel_hi:[1,0,0]
    s_waitcnt vmcnt(34)
    v_fma_mix_f32 v32, v116, 1.0, v32 op_sel_hi:[1,0,0]
    v_fma_mix_f32 v33, v116, 1.0, v33 op_sel:[1,0,0] op_sel_hi:[1,0,0]
    v_fma_mix_f32 v34, v117, 1.0, v34 op_sel_hi:[1,0,0]
    v_fma_mix_f32 v35, v117, 1.0, v35 op_sel:[1,0,0] op_sel_hi:[1,0,0]
    v_fma_mix_f32 v36, v118, 1.0, v36 op_sel_hi:[1,0,0]
    v_fma_mix_f32 v37, v118, 1.0, v37 op_sel:[1,0,0] op_sel_hi:[1,0,0]
    v_fma_mix_f32 v38, v119, 1.0, v38 op_sel_hi:[1,0,0]
    v_fma_mix_f32 v39, v119, 1.0, v39 op_sel:[1,0,0] op_sel_hi:[1,0,0]
    s_waitcnt vmcnt(33)
    v_fma_mix_f32 v32, v120, 1.0, v32 op_sel_hi:[1,0,0]
    v_fma_mix_f32 v33, v120, 1.0, v33 op_sel:[1,0,0] op_sel_hi:[1,0,0]
    v_fma_mix_f32 v34, v121, 1.0, v34 op_sel_hi:[1,0,0]
    v_fma_mix_f32 v35, v121, 1.0, v35 op_sel:[1,0,0] op_sel_hi:[1,0,0]
    v_fma_mix_f32 v36, v122, 1.0, v36 op_sel_hi:[1,0,0]
    v_fma_mix_f32 v37, v122, 1.0, v37 op_sel:[1,0,0] op_sel_hi:[1,0,0]
we_all_170:
wp_all_170:
    s_cmp_eq_u32 s43, 1
    s_cbranch_scc1 wr_0
    v_fma_mix_f32 v38, v123, 1.0, v38 op_sel_hi:[1,0,0]
    v_fma_mix_f32 v39, v123, 1.0, v39 op_sel:[1,0,0] op_sel_hi:[1,0,0]
    s_waitcnt vmcnt(32)
    v_fma_mix_f32 v32, v124, 1.0, v32 op_sel_hi:[1,0,0]
    v_fma_mix_f32 v33, v124, 1.0, v33 op_sel:[1,0,0] op_sel_hi:[1,0,0]
    v_fma_mix_f32 v34, v125, 1.0, v34 op_sel_hi:[1,0,0]
    v_fma_mix_f32 v35, v125, 1.0, v35 op_sel:[1,0,0] op_sel_hi:[1,0,0]
    v_fma_mix_f32 v36, v126, 1.0, v36 op_sel_hi:[1,0,0]
    v_fma_mix_f32 v37, v126, 1.0, v37 op_sel:[1,0,0] op_sel_hi:[1,0,0]
    v_fma_mix_f32 v38, v127, 1.0, v38 op_sel_hi:[1,0,0]
    v_fma_mix_f32 v39, v127, 1.0, v39 op_sel:[1,0,0] op_sel_hi:[1,0,0]
    v_cvt_pk_bf16_f32 v12, v32, v33
    v_cvt_pk_bf16_f32 v13, v34, v35
    v_cvt_pk_bf16_f32 v14, v36, v37
    v_cvt_pk_bf16_f32 v15, v38, v39
    s_bitcmp1_b32 s3, 0
    s_cselect_b32 s71, 3, 7
    v_cmp_eq_u32 vcc, s71, v4
    s_nop 1
    v_cndmask_b32 v12, v12, 0, vcc
    v_cndmask_b32 v13, v13, 0, vcc
    v_cndmask_b32 v14, v14, 0, vcc
    v_cndmask_b32 v15, v15, 0, vcc
    s_lshl_b32 s71, s3, 10
    v_add_u32 v9, s71, v10
    ds_write_b128 v9, v[12:15]
    s_waitcnt lgkmcnt(0)
    s_barrier
    ds_read_b128 v[16:19], v10 offset:0
    ds_read_b128 v[20:23], v10 offset:1024
    ds_read_b128 v[24:27], v10 offset:2048
    ds_read_b128 v[28:31], v10 offset:3072
    s_waitcnt vmcnt(31) lgkmcnt(3)
    v_mfma_f32_16x16x32_bf16 v[160:163], v[16:19], a[32:35], 0
    s_waitcnt vmcnt(30) lgkmcnt(2)
    v_mfma_f32_16x16x32_bf16 v[160:163], v[20:23], a[36:39], v[160:163]
    s_waitcnt lgkmcnt(1)
we_all_171:
wp_all_171:
    s_cmp_eq_u32 s43, 1
    s_cbranch_scc1 wr_0
    v_mfma_f32_16x16x32_bf16 v[164:167], v[24:27], a[32:35], 0
    s_waitcnt lgkmcnt(0)
    v_mfma_f32_16x16x32_bf16 v[164:167], v[28:31], a[36:39], v[164:167]
    s_waitcnt vmcnt(29)
    v_mfma_f32_16x16x32_bf16 v[168:171], v[16:19], a[40:43], 0
    s_waitcnt vmcnt(28)
    v_mfma_f32_16x16x32_bf16 v[168:171], v[20:23], a[44:47], v[168:171]
    v_mfma_f32_16x16x32_bf16 v[172:175], v[24:27], a[40:43], 0
    v_mfma_f32_16x16x32_bf16 v[172:175], v[28:31], a[44:47], v[172:175]
    s_waitcnt vmcnt(27)
    v_mfma_f32_16x16x32_bf16 v[176:179], v[16:19], a[48:51], 0
    s_waitcnt vmcnt(26)
    v_mfma_f32_16x16x32_bf16 v[176:179], v[20:23], a[52:55], v[176:179]
    v_mfma_f32_16x16x32_bf16 v[180:183], v[24:27], a[48:51], 0
    v_mfma_f32_16x16x32_bf16 v[180:183], v[28:31], a[52:55], v[180:183]
    s_waitcnt vmcnt(25)
    v_mfma_f32_16x16x32_bf16 v[184:187], v[16:19], a[56:59], 0
    s_waitcnt vmcnt(24)
    v_mfma_f32_16x16x32_bf16 v[184:187], v[20:23], a[60:63], v[184:187]
    v_mfma_f32_16x16x32_bf16 v[188:191], v[24:27], a[56:59], 0
    v_mfma_f32_16x16x32_bf16 v[188:191], v[28:31], a[60:63], v[188:191]
    v_cvt_pk_bf16_f32 v167, v167, v167
    v_lshlrev_b32 v167, 16, v167
    v_add_f32 v167, 0x358637bd, v167
    v_cvt_pk_bf16_f32 v167, v167, v167
    v_lshlrev_b32 v167, 16, v167
    v_rcp_f32 v167, v167
    v_cvt_pk_bf16_f32 v192, v160, v161
    v_cvt_pk_bf16_f32 v193, v162, v163
    v_cvt_pk_bf16_f32 v194, v164, v165
    v_cvt_pk_bf16_f32 v195, v166, v167
    v_lshlrev_b32 v160, 16, v192
    v_and_b32 v161, 0xffff0000, v192
    v_lshlrev_b32 v162, 16, v193
    v_and_b32 v163, 0xffff0000, v193
    v_lshlrev_b32 v164, 16, v194
    v_and_b32 v165, 0xffff0000, v194
    v_lshlrev_b32 v166, 16, v195
we_all_172:
wp_all_172:
    s_cmp_eq_u32 s43, 1
    s_cbranch_scc1 wr_0
    v_mul_f32 v160, v160, v167
    v_mul_f32 v161, v161, v167
    v_mul_f32 v162, v162, v167
    v_mul_f32 v163, v163, v167
    v_mul_f32 v164, v164, v167
    v_mul_f32 v165, v165, v167
    v_mul_f32 v166, v166, v167
    v_mov_b32 v167, 0
    v_cvt_pk_bf16_f32 v192, v160, v161
    v_cvt_pk_bf16_f32 v193, v162, v163
    v_cvt_pk_bf16_f32 v194, v164, v165
    v_cvt_pk_bf16_f32 v195, v166, v167
    buffer_store_dwordx4 v[192:195], v10, s[56:59], s10 offen sc1
    s_add_u32 s10, s10, 16384
    v_cvt_pk_bf16_f32 v175, v175, v175
    v_lshlrev_b32 v175, 16, v175
    v_add_f32 v175, 0x358637bd, v175
    v_cvt_pk_bf16_f32 v175, v175, v175
    v_lshlrev_b32 v175, 16, v175
    v_rcp_f32 v175, v175
    v_cvt_pk_bf16_f32 v196, v168, v169
    v_cvt_pk_bf16_f32 v197, v170, v171
    v_cvt_pk_bf16_f32 v198, v172, v173
    v_cvt_pk_bf16_f32 v199, v174, v175
    v_lshlrev_b32 v168, 16, v196
    v_and_b32 v169, 0xffff0000, v196
    v_lshlrev_b32 v170, 16, v197
    v_and_b32 v171, 0xffff0000, v197
    v_lshlrev_b32 v172, 16, v198
    v_and_b32 v173, 0xffff0000, v198
    v_lshlrev_b32 v174, 16, v199
    v_mul_f32 v168, v168, v175
    v_mul_f32 v169, v169, v175
    v_mul_f32 v170, v170, v175
    v_mul_f32 v171, v171, v175
    v_mul_f32 v172, v172, v175
    v_mul_f32 v173, v173, v175
    v_mul_f32 v174, v174, v175
    v_mov_b32 v175, 0
    v_cvt_pk_bf16_f32 v196, v168, v169
    v_cvt_pk_bf16_f32 v197, v170, v171
    v_cvt_pk_bf16_f32 v198, v172, v173
    v_cvt_pk_bf16_f32 v199, v174, v175
we_all_173:
wp_all_173:
    s_cmp_eq_u32 s43, 1
    s_cbranch_scc1 wr_0
    buffer_store_dwordx4 v[196:199], v10, s[56:59], s10 offen sc1
    s_add_u32 s10, s10, 16384
    v_cvt_pk_bf16_f32 v183, v183, v183
    v_lshlrev_b32 v183, 16, v183
    v_add_f32 v183, 0x358637bd, v183
    v_cvt_pk_bf16_f32 v183, v183, v183
    v_lshlrev_b32 v183, 16, v183
    v_rcp_f32 v183, v183
    v_cvt_pk_bf16_f32 v200, v176, v177
    v_cvt_pk_bf16_f32 v201, v178, v179
    v_cvt_pk_bf16_f32 v202, v180, v181
    v_cvt_pk_bf16_f32 v203, v182, v183
    v_lshlrev_b32 v176, 16, v200
    v_and_b32 v177, 0xffff0000, v200
    v_lshlrev_b32 v178, 16, v201
    v_and_b32 v179, 0xffff0000, v201
    v_lshlrev_b32 v180, 16, v202
    v_and_b32 v181, 0xffff0000, v202
    v_lshlrev_b32 v182, 16, v203
    v_mul_f32 v176, v176, v183
    v_mul_f32 v177, v177, v183
    v_mul_f32 v178, v178, v183
    v_mul_f32 v179, v179, v183
    v_mul_f32 v180, v180, v183
    v_mul_f32 v181, v181, v183
    v_mul_f32 v182, v182, v183
    v_mov_b32 v183, 0
    v_cvt_pk_bf16_f32 v200, v176, v177
    v_cvt_pk_bf16_f32 v201, v178, v179
    v_cvt_pk_bf16_f32 v202, v180, v181
    v_cvt_pk_bf16_f32 v203, v182, v183
    buffer_store_dwordx4 v[200:203], v10, s[56:59], s10 offen sc1
    s_add_u32 s10, s10, 16384
    v_cvt_pk_bf16_f32 v191, v191, v191
    v_lshlrev_b32 v191, 16, v191
    v_add_f32 v191, 0x358637bd, v191
    v_cvt_pk_bf16_f32 v191, v191, v191
    v_lshlrev_b32 v191, 16, v191
    v_rcp_f32 v191, v191
    v_cvt_pk_bf16_f32 v204, v184, v185
we_all_174:
wp_all_174:
    s_cmp_eq_u32 s43, 1
    s_cbranch_scc1 wr_0
    v_cvt_pk_bf16_f32 v205, v186, v187
    v_cvt_pk_bf16_f32 v206, v188, v189
    v_cvt_pk_bf16_f32 v207, v190, v191
    v_lshlrev_b32 v184, 16, v204
    v_and_b32 v185, 0xffff0000, v204
    v_lshlrev_b32 v186, 16, v205
    v_and_b32 v187, 0xffff0000, v205
    v_lshlrev_b32 v188, 16, v206
    v_and_b32 v189, 0xffff0000, v206
    v_lshlrev_b32 v190, 16, v207
    v_mul_f32 v184, v184, v191
    v_mul_f32 v185, v185, v191
    v_mul_f32 v186, v186, v191
    v_mul_f32 v187, v187, v191
    v_mul_f32 v188, v188, v191
    v_mul_f32 v189, v189, v191
    v_mul_f32 v190, v190, v191
    v_mov_b32 v191, 0
    v_cvt_pk_bf16_f32 v204, v184, v185
    v_cvt_pk_bf16_f32 v205, v186, v187
    v_cvt_pk_bf16_f32 v206, v188, v189
    v_cvt_pk_bf16_f32 v207, v190, v191
    buffer_store_dwordx4 v[204:207], v10, s[56:59], s10 offen sc1
    s_add_u32 s10, s10, 16384
    s_waitcnt vmcnt(27)
    v_mfma_f32_16x16x32_bf16 v[160:163], v[16:19], a[64:67], 0
    s_waitcnt vmcnt(26)
    v_mfma_f32_16x16x32_bf16 v[160:163], v[20:23], a[68:71], v[160:163]
    v_mfma_f32_16x16x32_bf16 v[164:167], v[24:27], a[64:67], 0
    v_mfma_f32_16x16x32_bf16 v[164:167], v[28:31], a[68:71], v[164:167]
    s_waitcnt vmcnt(25)
    v_mfma_f32_16x16x32_bf16 v[168:171], v[16:19], a[72:75], 0
    s_waitcnt vmcnt(24)
    v_mfma_f32_16x16x32_bf16 v[168:171], v[20:23], a[76:79], v[168:171]
    v_mfma_f32_16x16x32_bf16 v[172:175], v[24:27], a[72:75], 0
    v_mfma_f32_16x16x32_bf16 v[172:175], v[28:31], a[76:79], v[172:175]
    s_waitcnt vmcnt(23)
    v_mfma_f32_16x16x32_bf16 v[176:179], v[16:19], a[80:83], 0
    s_waitcnt vmcnt(22)
    v_mfma_f32_16x16x32_bf16 v[176:179], v[20:23], a[84:87], v[176:179]
we_all_175:
wp_all_175:
    s_cmp_eq_u32 s43, 1
    s_cbranch_scc1 wr_0
    v_mfma_f32_16x16x32_bf16 v[180:183], v[24:27], a[80:83], 0
    v_mfma_f32_16x16x32_bf16 v[180:183], v[28:31], a[84:87], v[180:183]
    s_waitcnt vmcnt(21)
    v_mfma_f32_16x16x32_bf16 v[184:187], v[16:19], a[88:91], 0
    s_waitcnt vmcnt(20)
    v_mfma_f32_16x16x32_bf16 v[184:187], v[20:23], a[92:95], v[184:187]
    v_mfma_f32_16x16x32_bf16 v[188:191], v[24:27], a[88:91], 0
    v_mfma_f32_16x16x32_bf16 v[188:191], v[28:31], a[92:95], v[188:191]
    v_cvt_pk_bf16_f32 v167, v167, v167
    v_lshlrev_b32 v167, 16, v167
    v_add_f32 v167, 0x358637bd, v167
    v_cvt_pk_bf16_f32 v167, v167, v167
    v_lshlrev_b32 v167, 16, v167
    v_rcp_f32 v167, v167
    v_cvt_pk_bf16_f32 v208, v160, v161
    v_cvt_pk_bf16_f32 v209, v162, v163
    v_cvt_pk_bf16_f32 v210, v164, v165
    v_cvt_pk_bf16_f32 v211, v166, v167
    v_lshlrev_b32 v160, 16, v208
    v_and_b32 v161, 0xffff0000, v208
    v_lshlrev_b32 v162, 16, v209
    v_and_b32 v163, 0xffff0000, v209
    v_lshlrev_b32 v164, 16, v210
    v_and_b32 v165, 0xffff0000, v210
    v_lshlrev_b32 v166, 16, v211
    v_mul_f32 v160, v160, v167
    v_mul_f32 v161, v161, v167
    v_mul_f32 v162, v162, v167
    v_mul_f32 v163, v163, v167
    v_mul_f32 v164, v164, v167
    v_mul_f32 v165, v165, v167
    v_mul_f32 v166, v166, v167
    v_mov_b32 v167, 0
    v_cvt_pk_bf16_f32 v208, v160, v161
    v_cvt_pk_bf16_f32 v209, v162, v163
    v_cvt_pk_bf16_f32 v210, v164, v165
    v_cvt_pk_bf16_f32 v211, v166, v167
    buffer_store_dwordx4 v[208:211], v10, s[56:59], s10 offen sc1
    s_add_u32 s10, s10, 16384
we_all_176:
wp_all_176:
    s_cmp_eq_u32 s43, 1
    s_cbranch_scc1 wr_0
    v_cvt_pk_bf16_f32 v175, v175, v175
    v_lshlrev_b32 v175, 16, v175
    v_add_f32 v175, 0x358637bd, v175
    v_cvt_pk_bf16_f32 v175, v175, v175
    v_lshlrev_b32 v175, 16, v175
    v_rcp_f32 v175, v175
    v_cvt_pk_bf16_f32 v212, v168, v169
    v_cvt_pk_bf16_f32 v213, v170, v171
    v_cvt_pk_bf16_f32 v214, v172, v173
    v_cvt_pk_bf16_f32 v215, v174, v175
    v_lshlrev_b32 v168, 16, v212
    v_and_b32 v169, 0xffff0000, v212
    v_lshlrev_b32 v170, 16, v213
    v_and_b32 v171, 0xffff0000, v213
    v_lshlrev_b32 v172, 16, v214
    v_and_b32 v173, 0xffff0000, v214
    v_lshlrev_b32 v174, 16, v215
    v_mul_f32 v168, v168, v175
    v_mul_f32 v169, v169, v175
    v_mul_f32 v170, v170, v175
    v_mul_f32 v171, v171, v175
    v_mul_f32 v172, v172, v175
    v_mul_f32 v173, v173, v175
    v_mul_f32 v174, v174, v175
    v_mov_b32 v175, 0
    v_cvt_pk_bf16_f32 v212, v168, v169
    v_cvt_pk_bf16_f32 v213, v170, v171
    v_cvt_pk_bf16_f32 v214, v172, v173
    v_cvt_pk_bf16_f32 v215, v174, v175
    buffer_store_dwordx4 v[212:215], v10, s[56:59], s10 offen sc1
    s_add_u32 s10, s10, 16384
    v_cvt_pk_bf16_f32 v183, v183, v183
    v_lshlrev_b32 v183, 16, v183
    v_add_f32 v183, 0x358637bd, v183
    v_cvt_pk_bf16_f32 v183, v183, v183
    v_lshlrev_b32 v183, 16, v183
    v_rcp_f32 v183, v183
    v_cvt_pk_bf16_f32 v216, v176, v177
    v_cvt_pk_bf16_f32 v217, v178, v179
    v_cvt_pk_bf16_f32 v218, v180, v181
we_all_177:
wp_all_177:
    s_cmp_eq_u32 s43, 1
    s_cbranch_scc1 wr_0
    v_cvt_pk_bf16_f32 v219, v182, v183
    v_lshlrev_b32 v176, 16, v216
    v_and_b32 v177, 0xffff0000, v216
    v_lshlrev_b32 v178, 16, v217
    v_and_b32 v179, 0xffff0000, v217
    v_lshlrev_b32 v180, 16, v218
    v_and_b32 v181, 0xffff0000, v218
    v_lshlrev_b32 v182, 16, v219
    v_mul_f32 v176, v176, v183
    v_mul_f32 v177, v177, v183
    v_mul_f32 v178, v178, v183
    v_mul_f32 v179, v179, v183
    v_mul_f32 v180, v180, v183
    v_mul_f32 v181, v181, v183
    v_mul_f32 v182, v182, v183
    v_mov_b32 v183, 0
    v_cvt_pk_bf16_f32 v216, v176, v177
    v_cvt_pk_bf16_f32 v217, v178, v179
    v_cvt_pk_bf16_f32 v218, v180, v181
    v_cvt_pk_bf16_f32 v219, v182, v183
    buffer_store_dwordx4 v[216:219], v10, s[56:59], s10 offen sc1
    s_add_u32 s10, s10, 16384
    v_cvt_pk_bf16_f32 v191, v191, v191
    v_lshlrev_b32 v191, 16, v191
    v_add_f32 v191, 0x358637bd, v191
    v_cvt_pk_bf16_f32 v191, v191, v191
    v_lshlrev_b32 v191, 16, v191
    v_rcp_f32 v191, v191
    v_cvt_pk_bf16_f32 v220, v184, v185
    v_cvt_pk_bf16_f32 v221, v186, v187
    v_cvt_pk_bf16_f32 v222, v188, v189
    v_cvt_pk_bf16_f32 v223, v190, v191
    v_lshlrev_b32 v184, 16, v220
    v_and_b32 v185, 0xffff0000, v220
    v_lshlrev_b32 v186, 16, v221
    v_and_b32 v187, 0xffff0000, v221
    v_lshlrev_b32 v188, 16, v222
    v_and_b32 v189, 0xffff0000, v222
    v_lshlrev_b32 v190, 16, v223
    v_mul_f32 v184, v184, v191
    v_mul_f32 v185, v185, v191
    v_mul_f32 v186, v186, v191
we_all_178:
wp_all_178:
    s_cmp_eq_u32 s43, 1
    s_cbranch_scc1 wr_0
    v_mul_f32 v187, v187, v191
    v_mul_f32 v188, v188, v191
    v_mul_f32 v189, v189, v191
    v_mul_f32 v190, v190, v191
    v_mov_b32 v191, 0
    v_cvt_pk_bf16_f32 v220, v184, v185
    v_cvt_pk_bf16_f32 v221, v186, v187
    v_cvt_pk_bf16_f32 v222, v188, v189
    v_cvt_pk_bf16_f32 v223, v190, v191
    buffer_store_dwordx4 v[220:223], v10, s[56:59], s10 offen sc1
    s_add_u32 s10, s10, 16384
    s_waitcnt vmcnt(23)
    v_mfma_f32_16x16x32_bf16 v[160:163], v[16:19], a[96:99], 0
    s_waitcnt vmcnt(22)
    v_mfma_f32_16x16x32_bf16 v[160:163], v[20:23], a[100:103], v[160:163]
    v_mfma_f32_16x16x32_bf16 v[164:167], v[24:27], a[96:99], 0
    v_mfma_f32_16x16x32_bf16 v[164:167], v[28:31], a[100:103], v[164:167]
    s_waitcnt vmcnt(21)
    v_mfma_f32_16x16x32_bf16 v[168:171], v[16:19], a[104:107], 0
    s_waitcnt vmcnt(20)
    v_mfma_f32_16x16x32_bf16 v[168:171], v[20:23], a[108:111], v[168:171]
    v_mfma_f32_16x16x32_bf16 v[172:175], v[24:27], a[104:107], 0
    v_mfma_f32_16x16x32_bf16 v[172:175], v[28:31], a[108:111], v[172:175]
    s_waitcnt vmcnt(19)
    v_mfma_f32_16x16x32_bf16 v[176:179], v[16:19], a[112:115], 0
    s_waitcnt vmcnt(18)
    v_mfma_f32_16x16x32_bf16 v[176:179], v[20:23], a[116:119], v[176:179]
    v_mfma_f32_16x16x32_bf16 v[180:183], v[24:27], a[112:115], 0
    v_mfma_f32_16x16x32_bf16 v[180:183], v[28:31], a[116:119], v[180:183]
    s_waitcnt vmcnt(17)
    v_mfma_f32_16x16x32_bf16 v[184:187], v[16:19], a[120:123], 0
    s_waitcnt vmcnt(16)
    v_mfma_f32_16x16x32_bf16 v[184:187], v[20:23], a[124:127], v[184:187]
    v_mfma_f32_16x16x32_bf16 v[188:191], v[24:27], a[120:123], 0
    v_mfma_f32_16x16x32_bf16 v[188:191], v[28:31], a[124:127], v[188:191]
    v_cvt_pk_bf16_f32 v167, v167, v167
    v_lshlrev_b32 v167, 16, v167
    v_add_f32 v167, 0x358637bd, v167
we_all_179:
wp_all_179:
    s_cmp_eq_u32 s43, 1
    s_cbranch_scc1 wr_0
    v_cvt_pk_bf16_f32 v167, v167, v167
    v_lshlrev_b32 v167, 16, v167
    v_rcp_f32 v167, v167
    v_cvt_pk_bf16_f32 v192, v160, v161
    v_cvt_pk_bf16_f32 v193, v162, v163
    v_cvt_pk_bf16_f32 v194, v164, v165
    v_cvt_pk_bf16_f32 v195, v166, v167
    v_lshlrev_b32 v160, 16, v192
    v_and_b32 v161, 0xffff0000, v192
    v_lshlrev_b32 v162, 16, v193
    v_and_b32 v163, 0xffff0000, v193
    v_lshlrev_b32 v164, 16, v194
    v_and_b32 v165, 0xffff0000, v194
    v_lshlrev_b32 v166, 16, v195
    v_mul_f32 v160, v160, v167
    v_mul_f32 v161, v161, v167
    v_mul_f32 v162, v162, v167
    v_mul_f32 v163, v163, v167
    v_mul_f32 v164, v164, v167
    v_mul_f32 v165, v165, v167
    v_mul_f32 v166, v166, v167
    v_mov_b32 v167, 0
    v_cvt_pk_bf16_f32 v192, v160, v161
    v_cvt_pk_bf16_f32 v193, v162, v163
    v_cvt_pk_bf16_f32 v194, v164, v165
    v_cvt_pk_bf16_f32 v195, v166, v167
    buffer_store_dwordx4 v[192:195], v10, s[56:59], s10 offen sc1
    s_add_u32 s10, s10, 16384
    v_cvt_pk_bf16_f32 v175, v175, v175
    v_lshlrev_b32 v175, 16, v175
    v_add_f32 v175, 0x358637bd, v175
    v_cvt_pk_bf16_f32 v175, v175, v175
    v_lshlrev_b32 v175, 16, v175
    v_rcp_f32 v175, v175
    v_cvt_pk_bf16_f32 v196, v168, v169
    v_cvt_pk_bf16_f32 v197, v170, v171
    v_cvt_pk_bf16_f32 v198, v172, v173
    v_cvt_pk_bf16_f32 v199, v174, v175
    v_lshlrev_b32 v168, 16, v196
    v_and_b32 v169, 0xffff0000, v196
we_all_180:
wp_all_180:
    s_cmp_eq_u32 s43, 1
    s_cbranch_scc1 wr_0
    v_lshlrev_b32 v170, 16, v197
    v_and_b32 v171, 0xffff0000, v197
    v_lshlrev_b32 v172, 16, v198
    v_and_b32 v173, 0xffff0000, v198
    v_lshlrev_b32 v174, 16, v199
    v_mul_f32 v168, v168, v175
    v_mul_f32 v169, v169, v175
    v_mul_f32 v170, v170, v175
    v_mul_f32 v171, v171, v175
    v_mul_f32 v172, v172, v175
    v_mul_f32 v173, v173, v175
    v_mul_f32 v174, v174, v175
    v_mov_b32 v175, 0
    v_cvt_pk_bf16_f32 v196, v168, v169
    v_cvt_pk_bf16_f32 v197, v170, v171
    v_cvt_pk_bf16_f32 v198, v172, v173
    v_cvt_pk_bf16_f32 v199, v174, v175
    buffer_store_dwordx4 v[196:199], v10, s[56:59], s10 offen sc1
    s_add_u32 s10, s10, 16384
    v_cvt_pk_bf16_f32 v183, v183, v183
    v_lshlrev_b32 v183, 16, v183
    v_add_f32 v183, 0x358637bd, v183
    v_cvt_pk_bf16_f32 v183, v183, v183
    v_lshlrev_b32 v183, 16, v183
    v_rcp_f32 v183, v183
    v_cvt_pk_bf16_f32 v200, v176, v177
    v_cvt_pk_bf16_f32 v201, v178, v179
    v_cvt_pk_bf16_f32 v202, v180, v181
    v_cvt_pk_bf16_f32 v203, v182, v183
    v_lshlrev_b32 v176, 16, v200
    v_and_b32 v177, 0xffff0000, v200
    v_lshlrev_b32 v178, 16, v201
    v_and_b32 v179, 0xffff0000, v201
    v_lshlrev_b32 v180, 16, v202
    v_and_b32 v181, 0xffff0000, v202
    v_lshlrev_b32 v182, 16, v203
    v_mul_f32 v176, v176, v183
    v_mul_f32 v177, v177, v183
    v_mul_f32 v178, v178, v183
    v_mul_f32 v179, v179, v183
    v_mul_f32 v180, v180, v183
    v_mul_f32 v181, v181, v183
    v_mul_f32 v182, v182, v183
    v_mov_b32 v183, 0
we_all_181:
wp_all_181:
    s_cmp_eq_u32 s43, 1
    s_cbranch_scc1 wr_0
    v_cvt_pk_bf16_f32 v200, v176, v177
    v_cvt_pk_bf16_f32 v201, v178, v179
    v_cvt_pk_bf16_f32 v202, v180, v181
    v_cvt_pk_bf16_f32 v203, v182, v183
    buffer_store_dwordx4 v[200:203], v10, s[56:59], s10 offen sc1
    s_add_u32 s10, s10, 16384
    v_cvt_pk_bf16_f32 v191, v191, v191
    v_lshlrev_b32 v191, 16, v191
    v_add_f32 v191, 0x358637bd, v191
    v_cvt_pk_bf16_f32 v191, v191, v191
    v_lshlrev_b32 v191, 16, v191
    v_rcp_f32 v191, v191
    v_cvt_pk_bf16_f32 v204, v184, v185
    v_cvt_pk_bf16_f32 v205, v186, v187
    v_cvt_pk_bf16_f32 v206, v188, v189
    v_cvt_pk_bf16_f32 v207, v190, v191
    v_lshlrev_b32 v184, 16, v204
    v_and_b32 v185, 0xffff0000, v204
    v_lshlrev_b32 v186, 16, v205
    v_and_b32 v187, 0xffff0000, v205
    v_lshlrev_b32 v188, 16, v206
    v_and_b32 v189, 0xffff0000, v206
    v_lshlrev_b32 v190, 16, v207
    v_mul_f32 v184, v184, v191
    v_mul_f32 v185, v185, v191
    v_mul_f32 v186, v186, v191
    v_mul_f32 v187, v187, v191
    v_mul_f32 v188, v188, v191
    v_mul_f32 v189, v189, v191
    v_mul_f32 v190, v190, v191
    v_mov_b32 v191, 0
    v_cvt_pk_bf16_f32 v204, v184, v185
    v_cvt_pk_bf16_f32 v205, v186, v187
    v_cvt_pk_bf16_f32 v206, v188, v189
    v_cvt_pk_bf16_f32 v207, v190, v191
    buffer_store_dwordx4 v[204:207], v10, s[56:59], s10 offen sc1
    s_add_u32 s10, s10, 16384
    s_waitcnt vmcnt(19)
    v_mfma_f32_16x16x32_bf16 v[160:163], v[16:19], a[128:131], 0
we_all_182:
wp_all_182:
    s_cmp_eq_u32 s43, 1
    s_cbranch_scc1 wr_0
    s_waitcnt vmcnt(18)
    v_mfma_f32_16x16x32_bf16 v[160:163], v[20:23], a[132:135], v[160:163]
    v_mfma_f32_16x16x32_bf16 v[164:167], v[24:27], a[128:131], 0
    v_mfma_f32_16x16x32_bf16 v[164:167], v[28:31], a[132:135], v[164:167]
    s_waitcnt vmcnt(17)
    v_mfma_f32_16x16x32_bf16 v[168:171], v[16:19], a[136:139], 0
    s_waitcnt vmcnt(16)
    v_mfma_f32_16x16x32_bf16 v[168:171], v[20:23], a[140:143], v[168:171]
    v_mfma_f32_16x16x32_bf16 v[172:175], v[24:27], a[136:139], 0
    v_mfma_f32_16x16x32_bf16 v[172:175], v[28:31], a[140:143], v[172:175]
    s_waitcnt vmcnt(15)
    v_mfma_f32_16x16x32_bf16 v[176:179], v[16:19], a[144:147], 0
    s_waitcnt vmcnt(14)
    v_mfma_f32_16x16x32_bf16 v[176:179], v[20:23], a[148:151], v[176:179]
    v_mfma_f32_16x16x32_bf16 v[180:183], v[24:27], a[144:147], 0
    v_mfma_f32_16x16x32_bf16 v[180:183], v[28:31], a[148:151], v[180:183]
    s_waitcnt vmcnt(13)
    v_mfma_f32_16x16x32_bf16 v[184:187], v[16:19], a[152:155], 0
    s_waitcnt vmcnt(12)
    v_mfma_f32_16x16x32_bf16 v[184:187], v[20:23], a[156:159], v[184:187]
    v_mfma_f32_16x16x32_bf16 v[188:191], v[24:27], a[152:155], 0
    v_mfma_f32_16x16x32_bf16 v[188:191], v[28:31], a[156:159], v[188:191]
    v_cvt_pk_bf16_f32 v167, v167, v167
    v_lshlrev_b32 v167, 16, v167
    v_add_f32 v167, 0x358637bd, v167
    v_cvt_pk_bf16_f32 v167, v167, v167
    v_lshlrev_b32 v167, 16, v167
    v_rcp_f32 v167, v167
    v_cvt_pk_bf16_f32 v208, v160, v161
    v_cvt_pk_bf16_f32 v209, v162, v163
    v_cvt_pk_bf16_f32 v210, v164, v165
    v_cvt_pk_bf16_f32 v211, v166, v167
    v_lshlrev_b32 v160, 16, v208
    v_and_b32 v161, 0xffff0000, v208
    v_lshlrev_b32 v162, 16, v209
    v_and_b32 v163, 0xffff0000, v209
    v_lshlrev_b32 v164, 16, v210
    v_and_b32 v165, 0xffff0000, v210
we_all_183:
wp_all_183:
    s_cmp_eq_u32 s43, 1
    s_cbranch_scc1 wr_0
    v_lshlrev_b32 v166, 16, v211
    v_mul_f32 v160, v160, v167
    v_mul_f32 v161, v161, v167
    v_mul_f32 v162, v162, v167
    v_mul_f32 v163, v163, v167
    v_mul_f32 v164, v164, v167
    v_mul_f32 v165, v165, v167
    v_mul_f32 v166, v166, v167
    v_mov_b32 v167, 0
    v_cvt_pk_bf16_f32 v208, v160, v161
    v_cvt_pk_bf16_f32 v209, v162, v163
    v_cvt_pk_bf16_f32 v210, v164, v165
    v_cvt_pk_bf16_f32 v211, v166, v167
    buffer_store_dwordx4 v[208:211], v10, s[56:59], s10 offen sc1
    s_add_u32 s10, s10, 16384
    v_cvt_pk_bf16_f32 v175, v175, v175
    v_lshlrev_b32 v175, 16, v175
    v_add_f32 v175, 0x358637bd, v175
    v_cvt_pk_bf16_f32 v175, v175, v175
    v_lshlrev_b32 v175, 16, v175
    v_rcp_f32 v175, v175
    v_cvt_pk_bf16_f32 v212, v168, v169
    v_cvt_pk_bf16_f32 v213, v170, v171
    v_cvt_pk_bf16_f32 v214, v172, v173
    v_cvt_pk_bf16_f32 v215, v174, v175
    v_lshlrev_b32 v168, 16, v212
    v_and_b32 v169, 0xffff0000, v212
    v_lshlrev_b32 v170, 16, v213
    v_and_b32 v171, 0xffff0000, v213
    v_lshlrev_b32 v172, 16, v214
    v_and_b32 v173, 0xffff0000, v214
    v_lshlrev_b32 v174, 16, v215
    v_mul_f32 v168, v168, v175
    v_mul_f32 v169, v169, v175
    v_mul_f32 v170, v170, v175
    v_mul_f32 v171, v171, v175
    v_mul_f32 v172, v172, v175
    v_mul_f32 v173, v173, v175
    v_mul_f32 v174, v174, v175
    v_mov_b32 v175, 0
    v_cvt_pk_bf16_f32 v212, v168, v169
    v_cvt_pk_bf16_f32 v213, v170, v171
    v_cvt_pk_bf16_f32 v214, v172, v173
we_all_184:
wp_all_184:
    s_cmp_eq_u32 s43, 1
    s_cbranch_scc1 wr_0
    v_cvt_pk_bf16_f32 v215, v174, v175
    buffer_store_dwordx4 v[212:215], v10, s[56:59], s10 offen sc1
    s_add_u32 s10, s10, 16384
    v_cvt_pk_bf16_f32 v183, v183, v183
    v_lshlrev_b32 v183, 16, v183
    v_add_f32 v183, 0x358637bd, v183
    v_cvt_pk_bf16_f32 v183, v183, v183
    v_lshlrev_b32 v183, 16, v183
    v_rcp_f32 v183, v183
    v_cvt_pk_bf16_f32 v216, v176, v177
    v_cvt_pk_bf16_f32 v217, v178, v179
    v_cvt_pk_bf16_f32 v218, v180, v181
    v_cvt_pk_bf16_f32 v219, v182, v183
    v_lshlrev_b32 v176, 16, v216
    v_and_b32 v177, 0xffff0000, v216
    v_lshlrev_b32 v178, 16, v217
    v_and_b32 v179, 0xffff0000, v217
    v_lshlrev_b32 v180, 16, v218
    v_and_b32 v181, 0xffff0000, v218
    v_lshlrev_b32 v182, 16, v219
    v_mul_f32 v176, v176, v183
    v_mul_f32 v177, v177, v183
    v_mul_f32 v178, v178, v183
    v_mul_f32 v179, v179, v183
    v_mul_f32 v180, v180, v183
    v_mul_f32 v181, v181, v183
    v_mul_f32 v182, v182, v183
    v_mov_b32 v183, 0
    v_cvt_pk_bf16_f32 v216, v176, v177
    v_cvt_pk_bf16_f32 v217, v178, v179
    v_cvt_pk_bf16_f32 v218, v180, v181
    v_cvt_pk_bf16_f32 v219, v182, v183
    buffer_store_dwordx4 v[216:219], v10, s[56:59], s10 offen sc1
    s_add_u32 s10, s10, 16384
    v_cvt_pk_bf16_f32 v191, v191, v191
    v_lshlrev_b32 v191, 16, v191
    v_add_f32 v191, 0x358637bd, v191
    v_cvt_pk_bf16_f32 v191, v191, v191
    v_lshlrev_b32 v191, 16, v191
we_all_185:
wp_all_185:
    s_cmp_eq_u32 s43, 1
    s_cbranch_scc1 wr_0
    v_rcp_f32 v191, v191
    v_cvt_pk_bf16_f32 v220, v184, v185
    v_cvt_pk_bf16_f32 v221, v186, v187
    v_cvt_pk_bf16_f32 v222, v188, v189
    v_cvt_pk_bf16_f32 v223, v190, v191
    v_lshlrev_b32 v184, 16, v220
    v_and_b32 v185, 0xffff0000, v220
    v_lshlrev_b32 v186, 16, v221
    v_and_b32 v187, 0xffff0000, v221
    v_lshlrev_b32 v188, 16, v222
    v_and_b32 v189, 0xffff0000, v222
    v_lshlrev_b32 v190, 16, v223
    v_mul_f32 v184, v184, v191
    v_mul_f32 v185, v185, v191
    v_mul_f32 v186, v186, v191
    v_mul_f32 v187, v187, v191
    v_mul_f32 v188, v188, v191
    v_mul_f32 v189, v189, v191
    v_mul_f32 v190, v190, v191
    v_mov_b32 v191, 0
    v_cvt_pk_bf16_f32 v220, v184, v185
    v_cvt_pk_bf16_f32 v221, v186, v187
    v_cvt_pk_bf16_f32 v222, v188, v189
    v_cvt_pk_bf16_f32 v223, v190, v191
    buffer_store_dwordx4 v[220:223], v10, s[56:59], s10 offen sc1
    s_waitcnt vmcnt(0)
    s_barrier
    buffer_store_dword v246, v247, s[44:47], 0 offen offset:0 sc1
    s_lshr_b32 s68, s2, 3
    s_sub_u32 s68, s68, 28
    s_lshl_b32 s68, s68, 2
    s_add_u32 s68, s68, s3
    s_mul_i32 s68, s68, 100352
    s_add_u32 s68, s68, 0x1800000
    v_lshlrev_b32 v8, 7, v1
    buffer_load_dword v16, v8, s[44:47], s68 offen
    s_add_u32 s68, s68, 8192
    buffer_load_dword v17, v8, s[44:47], s68 offen
    s_add_u32 s68, s68, 8192
    buffer_load_dword v18, v8, s[44:47], s68 offen
    s_add_u32 s68, s68, 8192
we_all_186:
wp_all_186:
    s_cmp_eq_u32 s43, 1
    s_cbranch_scc1 wr_0
    buffer_load_dword v19, v8, s[44:47], s68 offen
    s_add_u32 s68, s68, 8192
    buffer_load_dword v20, v8, s[44:47], s68 offen
    s_add_u32 s68, s68, 8192
    buffer_load_dword v21, v8, s[44:47], s68 offen
    s_add_u32 s68, s68, 8192
    buffer_load_dword v22, v8, s[44:47], s68 offen
    s_add_u32 s68, s68, 8192
    buffer_load_dword v23, v8, s[44:47], s68 offen
    s_add_u32 s68, s68, 8192
    buffer_load_dword v24, v8, s[44:47], s68 offen
    s_add_u32 s68, s68, 8192
    buffer_load_dword v25, v8, s[44:47], s68 offen
    s_add_u32 s68, s68, 8192
    buffer_load_dword v26, v8, s[44:47], s68 offen
    s_add_u32 s68, s68, 8192
    buffer_load_dword v27, v8, s[44:47], s68 offen
    s_add_u32 s68, s68, 8192
    buffer_load_dword v28, v8, s[44:47], s68 offen
kf_kernel_end:
    s_endpgm
kf_kernel_x0_sl:
    s_nop 7
    s_nop 7
    s_add_u32 s100, s100, 1
    s_cmp_gt_u32 s100, 30000
    s_cbranch_scc1 kf_kernel_x0_bk
    buffer_load_dwordx4 v[32:35], v17, s[44:47], s16 offen offset:0 sc1
    buffer_load_dwordx4 v[36:39], v17, s[44:47], s16 offen offset:512 sc1
    buffer_load_dwordx4 v[40:43], v17, s[44:47], s16 offen offset:1024 sc1
    buffer_load_dwordx4 v[44:47], v17, s[44:47], s16 offen offset:1536 sc1
    s_waitcnt vmcnt(0)
    s_waitcnt vmcnt(0)
    v_max3_u32 v23, v32, v36, v40
    v_max_u32 v23, v23, v44
    v_cmp_eq_u32 vcc, -1, v23
    s_nop 0
    s_or_b64 vcc, vcc, vcc
    s_cbranch_scc1 kf_kernel_x0_sl
    s_branch kf_kernel_x0_bk
kf_kernel_x1_sl:
    s_nop 7
    s_nop 7
    s_add_u32 s100, s100, 1
    s_cmp_gt_u32 s100, 30000
    s_cbranch_scc1 kf_kernel_x1_bk
    buffer_load_dwordx4 v[48:51], v17, s[44:47], s17 offen offset:0 sc1
    buffer_load_dwordx4 v[52:55], v17, s[44:47], s17 offen offset:512 sc1
    buffer_load_dwordx4 v[56:59], v17, s[44:47], s17 offen offset:1024 sc1
    buffer_load_dwordx4 v[60:63], v17, s[44:47], s17 offen offset:1536 sc1
    s_waitcnt vmcnt(0)
    s_waitcnt vmcnt(0)
    v_max3_u32 v23, v48, v52, v56
    v_max_u32 v23, v23, v60
    v_cmp_eq_u32 vcc, -1, v23
    s_nop 0
    s_or_b64 vcc, vcc, vcc
    s_cbranch_scc1 kf_kernel_x1_sl
    s_branch kf_kernel_x1_bk
kf_kernel_x2_sl:
    s_nop 7
    s_nop 7
    s_add_u32 s100, s100, 1
    s_cmp_gt_u32 s100, 30000
    s_cbranch_scc1 kf_kernel_x2_bk
    buffer_load_dwordx4 v[64:67], v17, s[44:47], s18 offen offset:0 sc1
    buffer_load_dwordx4 v[68:71], v17, s[44:47], s18 offen offset:512 sc1
    buffer_load_dwordx4 v[72:75], v17, s[44:47], s18 offen offset:1024 sc1
    buffer_load_dwordx4 v[76:79], v17, s[44:47], s18 offen offset:1536 sc1
    s_waitcnt vmcnt(0)
    s_waitcnt vmcnt(0)
    v_max3_u32 v23, v64, v68, v72
    v_max_u32 v23, v23, v76
    v_cmp_eq_u32 vcc, -1, v23
    s_nop 0
    s_or_b64 vcc, vcc, vcc
    s_cbranch_scc1 kf_kernel_x2_sl
    s_branch kf_kernel_x2_bk
kf_kernel_x3_sl:
    s_nop 7
    s_nop 7
    s_add_u32 s100, s100, 1
    s_cmp_gt_u32 s100, 30000
    s_cbranch_scc1 kf_kernel_x3_bk
    buffer_load_dwordx4 v[80:83], v17, s[44:47], s19 offen offset:0 sc1
    buffer_load_dwordx4 v[84:87], v17, s[44:47], s19 offen offset:512 sc1
    buffer_load_dwordx4 v[88:91], v17, s[44:47], s19 offen offset:1024 sc1
    buffer_load_dwordx4 v[92:95], v17, s[44:47], s19 offen offset:1536 sc1
    s_waitcnt vmcnt(0)
    s_waitcnt vmcnt(0)
    v_max3_u32 v23, v80, v84, v88
    v_max_u32 v23, v23, v92
    v_cmp_eq_u32 vcc, -1, v23
    s_nop 0
    s_or_b64 vcc, vcc, vcc
    s_cbranch_scc1 kf_kernel_x3_sl
    s_branch kf_kernel_x3_bk
kf_kernel_stc_sl:
    s_nop 7
    s_nop 7
    s_add_u32 s100, s100, 1
    s_cmp_gt_u32 s100, 30000
    s_cbranch_scc1 kf_kernel_stc_bk
    buffer_load_dwordx4 v[208:211], v20, s[44:47], 0 offen offset:0 sc1
    buffer_load_dwordx4 v[212:215], v20, s[44:47], 0 offen offset:256 sc1
    s_waitcnt vmcnt(0)
    s_waitcnt vmcnt(0)
    v_add_f32 v216, v208, v209
    v_add_f32 v217, v210, v211
    v_add_f32 v218, v212, v213
    v_add_f32 v216, v216, v217
    v_add_f32 v218, v218, v214
    v_add_f32 v216, v216, v218
    v_cmp_u_f32 vcc, v216, v216
    s_nop 0
    s_or_b64 vcc, vcc, vcc
    s_cbranch_scc1 kf_kernel_stc_sl
    s_branch kf_kernel_stc_bk
kf_kernel_x4_sl:
    s_nop 7
    s_nop 7
    s_add_u32 s100, s100, 1
    s_cmp_gt_u32 s100, 30000
    s_cbranch_scc1 kf_kernel_x4_bk
    buffer_load_dwordx4 v[96:99], v17, s[44:47], s20 offen offset:0 sc1
    buffer_load_dwordx4 v[100:103], v17, s[44:47], s20 offen offset:512 sc1
    buffer_load_dwordx4 v[104:107], v17, s[44:47], s20 offen offset:1024 sc1
    buffer_load_dwordx4 v[108:111], v17, s[44:47], s20 offen offset:1536 sc1
    s_waitcnt vmcnt(0)
    s_waitcnt vmcnt(0)
    v_max3_u32 v23, v96, v100, v104
    v_max_u32 v23, v23, v108
    v_cmp_eq_u32 vcc, -1, v23
    s_nop 0
    s_or_b64 vcc, vcc, vcc
    s_cbranch_scc1 kf_kernel_x4_sl
    s_branch kf_kernel_x4_bk
kf_kernel_x5_sl:
    s_nop 7
    s_nop 7
    s_add_u32 s100, s100, 1
    s_cmp_gt_u32 s100, 30000
    s_cbranch_scc1 kf_kernel_x5_bk
    buffer_load_dwordx4 v[112:115], v17, s[44:47], s21 offen offset:0 sc1
    buffer_load_dwordx4 v[116:119], v17, s[44:47], s21 offen offset:512 sc1
    buffer_load_dwordx4 v[120:123], v17, s[44:47], s21 offen offset:1024 sc1
    buffer_load_dwordx4 v[124:127], v17, s[44:47], s21 offen offset:1536 sc1
    s_waitcnt vmcnt(0)
    s_waitcnt vmcnt(0)
    v_max3_u32 v23, v112, v116, v120
    v_max_u32 v23, v23, v124
    v_cmp_eq_u32 vcc, -1, v23
    s_nop 0
    s_or_b64 vcc, vcc, vcc
    s_cbranch_scc1 kf_kernel_x5_sl
    s_branch kf_kernel_x5_bk
kf_kernel_x6_sl:
    s_nop 7
    s_nop 7
    s_add_u32 s100, s100, 1
    s_cmp_gt_u32 s100, 30000
    s_cbranch_scc1 kf_kernel_x6_bk
    buffer_load_dwordx4 v[128:131], v17, s[44:47], s22 offen offset:0 sc1
    buffer_load_dwordx4 v[132:135], v17, s[44:47], s22 offen offset:512 sc1
    buffer_load_dwordx4 v[136:139], v17, s[44:47], s22 offen offset:1024 sc1
    buffer_load_dwordx4 v[140:143], v17, s[44:47], s22 offen offset:1536 sc1
    s_waitcnt vmcnt(0)
    s_waitcnt vmcnt(0)
    v_max3_u32 v23, v128, v132, v136
    v_max_u32 v23, v23, v140
    v_cmp_eq_u32 vcc, -1, v23
    s_nop 0
    s_or_b64 vcc, vcc, vcc
    s_cbranch_scc1 kf_kernel_x6_sl
    s_branch kf_kernel_x6_bk
kf_kernel_p0_sl:
    s_sleep 2
    s_load_dwordx2 s[48:49], s[40:41], s56 offset:0 glc
    s_load_dwordx2 s[50:51], s[40:41], s57 offset:0 glc
    s_load_dwordx2 s[52:53], s[40:41], s58 offset:0 glc
    s_waitcnt lgkmcnt(0)
    s_and_b64 s[48:49], s[48:49], s[50:51]
    s_and_b64 s[48:49], s[48:49], s[52:53]
    s_and_b32 s48, s48, s49
    s_cmp_eq_u32 s48, 1
    s_cbranch_scc1 kf_kernel_p0_bk
    s_sleep 2
    s_load_dwordx2 s[48:49], s[40:41], s56 offset:0 glc
    s_load_dwordx2 s[50:51], s[40:41], s57 offset:0 glc
    s_load_dwordx2 s[52:53], s[40:41], s58 offset:0 glc
    s_waitcnt lgkmcnt(0)
    s_and_b64 s[48:49], s[48:49], s[50:51]
    s_and_b64 s[48:49], s[48:49], s[52:53]
    s_and_b32 s48, s48, s49
    s_cmp_eq_u32 s48, 1
    s_cbranch_scc1 kf_kernel_p0_bk
    s_sleep 2
    s_load_dwordx2 s[48:49], s[40:41], s56 offset:0 glc
    s_load_dwordx2 s[50:51], s[40:41], s57 offset:0 glc
    s_load_dwordx2 s[52:53], s[40:41], s58 offset:0 glc
    s_waitcnt lgkmcnt(0)
    s_and_b64 s[48:49], s[48:49], s[50:51]
    s_and_b64 s[48:49], s[48:49], s[52:53]
    s_and_b32 s48, s48, s49
    s_cmp_eq_u32 s48, 1
    s_cbranch_scc1 kf_kernel_p0_bk
    s_sleep 2
    s_load_dwordx2 s[48:49], s[40:41], s56 offset:0 glc
    s_load_dwordx2 s[50:51], s[40:41], s57 offset:0 glc
    s_load_dwordx2 s[52:53], s[40:41], s58 offset:0 glc
    s_waitcnt lgkmcnt(0)
    s_and_b64 s[48:49], s[48:49], s[50:51]
    s_and_b64 s[48:49], s[48:49], s[52:53]
    s_and_b32 s48, s48, s49
    s_cmp_eq_u32 s48, 1
    s_cbranch_scc1 kf_kernel_p0_bk
    s_sleep 2
    s_load_dwordx2 s[48:49], s[40:41], s56 offset:0 glc
    s_load_dwordx2 s[50:51], s[40:41], s57 offset:0 glc
    s_load_dwordx2 s[52:53], s[40:41], s58 offset:0 glc
    s_waitcnt lgkmcnt(0)
    s_and_b64 s[48:49], s[48:49], s[50:51]
    s_and_b64 s[48:49], s[48:49], s[52:53]
    s_and_b32 s48, s48, s49
    s_cmp_eq_u32 s48, 1
    s_cbranch_scc1 kf_kernel_p0_bk
    s_sleep 2
    s_load_dwordx2 s[48:49], s[40:41], s56 offset:0 glc
    s_load_dwordx2 s[50:51], s[40:41], s57 offset:0 glc
    s_load_dwordx2 s[52:53], s[40:41], s58 offset:0 glc
    s_waitcnt lgkmcnt(0)
    s_and_b64 s[48:49], s[48:49], s[50:51]
    s_and_b64 s[48:49], s[48:49], s[52:53]
    s_and_b32 s48, s48, s49
    s_cmp_eq_u32 s48, 1
    s_cbranch_scc1 kf_kernel_p0_bk
    s_nop 7
    buffer_load_dwordx2 v[248:249], v21, s[44:47], 0 offen offset:0 sc1
    s_waitcnt vmcnt(0)
kf_kernel_p0v_lp:
    v_and_b32 v248, v248, v249
    v_cmp_ne_u32 vcc, 1, v248
    s_add_u32 s100, s100, 1
    s_nop 3
    s_cbranch_vccz kf_kernel_p0v_ok
    s_cmp_gt_u32 s100, 30000
    s_cbranch_scc1 kf_kernel_p0v_ok
    s_sleep 1
    buffer_load_dwordx2 v[248:249], v21, s[44:47], 0 offen offset:0 sc1
    s_waitcnt vmcnt(0)
    s_branch kf_kernel_p0v_lp
kf_kernel_p0v_ok:
    s_nop 4
    s_branch kf_kernel_p0_bk
kf_kernel_p1_sl:
    s_sleep 2
    s_load_dwordx2 s[16:17], s[40:41], s56 offset:1024 glc
    s_load_dwordx2 s[18:19], s[40:41], s57 offset:1024 glc
    s_load_dwordx2 s[20:21], s[40:41], s58 offset:1024 glc
    s_load_dwordx2 s[54:55], s[40:41], s59 offset:1024 glc
    s_waitcnt lgkmcnt(0)
    s_and_b64 s[16:17], s[16:17], s[18:19]
    s_and_b64 s[16:17], s[16:17], s[20:21]
    s_and_b64 s[16:17], s[16:17], s[54:55]
    s_and_b32 s16, s16, s17
    s_cmp_eq_u32 s16, 1
    s_cbranch_scc1 kf_kernel_p1_bk
    s_sleep 2
    s_load_dwordx2 s[16:17], s[40:41], s56 offset:1024 glc
    s_load_dwordx2 s[18:19], s[40:41], s57 offset:1024 glc
    s_load_dwordx2 s[20:21], s[40:41], s58 offset:1024 glc
    s_load_dwordx2 s[54:55], s[40:41], s59 offset:1024 glc
    s_waitcnt lgkmcnt(0)
    s_and_b64 s[16:17], s[16:17], s[18:19]
    s_and_b64 s[16:17], s[16:17], s[20:21]
    s_and_b64 s[16:17], s[16:17], s[54:55]
    s_and_b32 s16, s16, s17
    s_cmp_eq_u32 s16, 1
    s_cbranch_scc1 kf_kernel_p1_bk
    s_sleep 2
    s_load_dwordx2 s[16:17], s[40:41], s56 offset:1024 glc
    s_load_dwordx2 s[18:19], s[40:41], s57 offset:1024 glc
    s_load_dwordx2 s[20:21], s[40:41], s58 offset:1024 glc
    s_load_dwordx2 s[54:55], s[40:41], s59 offset:1024 glc
    s_waitcnt lgkmcnt(0)
    s_and_b64 s[16:17], s[16:17], s[18:19]
    s_and_b64 s[16:17], s[16:17], s[20:21]
    s_and_b64 s[16:17], s[16:17], s[54:55]
    s_and_b32 s16, s16, s17
    s_cmp_eq_u32 s16, 1
    s_cbranch_scc1 kf_kernel_p1_bk
    s_sleep 2
    s_load_dwordx2 s[16:17], s[40:41], s56 offset:1024 glc
    s_load_dwordx2 s[18:19], s[40:41], s57 offset:1024 glc
    s_load_dwordx2 s[20:21], s[40:41], s58 offset:1024 glc
    s_load_dwordx2 s[54:55], s[40:41], s59 offset:1024 glc
    s_waitcnt lgkmcnt(0)
    s_and_b64 s[16:17], s[16:17], s[18:19]
    s_and_b64 s[16:17], s[16:17], s[20:21]
    s_and_b64 s[16:17], s[16:17], s[54:55]
    s_and_b32 s16, s16, s17
    s_cmp_eq_u32 s16, 1
    s_cbranch_scc1 kf_kernel_p1_bk
    s_sleep 2
    s_load_dwordx2 s[16:17], s[40:41], s56 offset:1024 glc
    s_load_dwordx2 s[18:19], s[40:41], s57 offset:1024 glc
    s_load_dwordx2 s[20:21], s[40:41], s58 offset:1024 glc
    s_load_dwordx2 s[54:55], s[40:41], s59 offset:1024 glc
    s_waitcnt lgkmcnt(0)
    s_and_b64 s[16:17], s[16:17], s[18:19]
    s_and_b64 s[16:17], s[16:17], s[20:21]
    s_and_b64 s[16:17], s[16:17], s[54:55]
    s_and_b32 s16, s16, s17
    s_cmp_eq_u32 s16, 1
    s_cbranch_scc1 kf_kernel_p1_bk
    s_sleep 2
    s_load_dwordx2 s[16:17], s[40:41], s56 offset:1024 glc
    s_load_dwordx2 s[18:19], s[40:41], s57 offset:1024 glc
    s_load_dwordx2 s[20:21], s[40:41], s58 offset:1024 glc
    s_load_dwordx2 s[54:55], s[40:41], s59 offset:1024 glc
    s_waitcnt lgkmcnt(0)
    s_and_b64 s[16:17], s[16:17], s[18:19]
    s_and_b64 s[16:17], s[16:17], s[20:21]
    s_and_b64 s[16:17], s[16:17], s[54:55]
    s_and_b32 s16, s16, s17
    s_cmp_eq_u32 s16, 1
    s_cbranch_scc1 kf_kernel_p1_bk
    s_nop 7
    buffer_load_dwordx2 v[248:249], v21, s[44:47], 0 offen offset:1024 sc1
    s_waitcnt vmcnt(0)
kf_kernel_p1v_lp:
    v_and_b32 v248, v248, v249
    v_cmp_ne_u32 vcc, 1, v248
    s_add_u32 s100, s100, 1
    s_nop 3
    s_cbranch_vccz kf_kernel_p1v_ok
    s_cmp_gt_u32 s100, 30000
    s_cbranch_scc1 kf_kernel_p1v_ok
    s_sleep 1
    buffer_load_dwordx2 v[248:249], v21, s[44:47], 0 offen offset:1024 sc1
    s_waitcnt vmcnt(0)
    s_branch kf_kernel_p1v_lp
kf_kernel_p1v_ok:
    s_nop 4
    s_branch kf_kernel_p1_bk
kf_kernel_gtc_sl:
    s_nop 7
    s_nop 7
    s_add_u32 s100, s100, 1
    s_cmp_gt_u32 s100, 30000
    s_cbranch_scc1 kf_kernel_gtc_bk
    buffer_load_dwordx4 v[252:255], v26, s[44:47], 0 offen offset:1024 sc1
    s_waitcnt vmcnt(0)
    s_waitcnt vmcnt(0)
    v_and_b32 v5, 1, v4
    v_cmp_eq_u32 vcc, 1, v5
    s_nop 1
    v_cndmask_b32 v255, v255, 0, vcc
    v_add_f32 v252, v252, v253
    v_add_f32 v254, v254, v255
    v_add_f32 v252, v252, v254
    v_cmp_u_f32 vcc, v252, v252
    s_nop 0
    s_or_b64 vcc, vcc, vcc
    s_cbranch_scc1 kf_kernel_gtc_sl
    s_branch kf_kernel_gtc_bk
kf_kernel_p2_sl:
    s_sleep 2
    s_load_dwordx2 s[48:49], s[40:41], s56 offset:2048 glc
    s_load_dwordx2 s[50:51], s[40:41], s57 offset:2048 glc
    s_load_dwordx2 s[52:53], s[40:41], s58 offset:2048 glc
    s_waitcnt lgkmcnt(0)
    s_and_b64 s[48:49], s[48:49], s[50:51]
    s_and_b64 s[48:49], s[48:49], s[52:53]
    s_and_b32 s48, s48, s49
    s_cmp_eq_u32 s48, 1
    s_cbranch_scc1 kf_kernel_p2_bk
    s_sleep 2
    s_load_dwordx2 s[48:49], s[40:41], s56 offset:2048 glc
    s_load_dwordx2 s[50:51], s[40:41], s57 offset:2048 glc
    s_load_dwordx2 s[52:53], s[40:41], s58 offset:2048 glc
    s_waitcnt lgkmcnt(0)
    s_and_b64 s[48:49], s[48:49], s[50:51]
    s_and_b64 s[48:49], s[48:49], s[52:53]
    s_and_b32 s48, s48, s49
    s_cmp_eq_u32 s48, 1
    s_cbranch_scc1 kf_kernel_p2_bk
    s_sleep 2
    s_load_dwordx2 s[48:49], s[40:41], s56 offset:2048 glc
    s_load_dwordx2 s[50:51], s[40:41], s57 offset:2048 glc
    s_load_dwordx2 s[52:53], s[40:41], s58 offset:2048 glc
    s_waitcnt lgkmcnt(0)
    s_and_b64 s[48:49], s[48:49], s[50:51]
    s_and_b64 s[48:49], s[48:49], s[52:53]
    s_and_b32 s48, s48, s49
    s_cmp_eq_u32 s48, 1
    s_cbranch_scc1 kf_kernel_p2_bk
    s_sleep 2
    s_load_dwordx2 s[48:49], s[40:41], s56 offset:2048 glc
    s_load_dwordx2 s[50:51], s[40:41], s57 offset:2048 glc
    s_load_dwordx2 s[52:53], s[40:41], s58 offset:2048 glc
    s_waitcnt lgkmcnt(0)
    s_and_b64 s[48:49], s[48:49], s[50:51]
    s_and_b64 s[48:49], s[48:49], s[52:53]
    s_and_b32 s48, s48, s49
    s_cmp_eq_u32 s48, 1
    s_cbranch_scc1 kf_kernel_p2_bk
    s_sleep 2
    s_load_dwordx2 s[48:49], s[40:41], s56 offset:2048 glc
    s_load_dwordx2 s[50:51], s[40:41], s57 offset:2048 glc
    s_load_dwordx2 s[52:53], s[40:41], s58 offset:2048 glc
    s_waitcnt lgkmcnt(0)
    s_and_b64 s[48:49], s[48:49], s[50:51]
    s_and_b64 s[48:49], s[48:49], s[52:53]
    s_and_b32 s48, s48, s49
    s_cmp_eq_u32 s48, 1
    s_cbranch_scc1 kf_kernel_p2_bk
    s_sleep 2
    s_load_dwordx2 s[48:49], s[40:41], s56 offset:2048 glc
    s_load_dwordx2 s[50:51], s[40:41], s57 offset:2048 glc
    s_load_dwordx2 s[52:53], s[40:41], s58 offset:2048 glc
    s_waitcnt lgkmcnt(0)
    s_and_b64 s[48:49], s[48:49], s[50:51]
    s_and_b64 s[48:49], s[48:49], s[52:53]
    s_and_b32 s48, s48, s49
    s_cmp_eq_u32 s48, 1
    s_cbranch_scc1 kf_kernel_p2_bk
    s_nop 7
    buffer_load_dwordx2 v[248:249], v21, s[44:47], 0 offen offset:2048 sc1
    s_waitcnt vmcnt(0)
kf_kernel_p2v_lp:
    v_and_b32 v248, v248, v249
    v_cmp_ne_u32 vcc, 1, v248
    s_add_u32 s100, s100, 1
    s_nop 3
    s_cbranch_vccz kf_kernel_p2v_ok
    s_cmp_gt_u32 s100, 30000
    s_cbranch_scc1 kf_kernel_p2v_ok
    s_sleep 1
    buffer_load_dwordx2 v[248:249], v21, s[44:47], 0 offen offset:2048 sc1
    s_waitcnt vmcnt(0)
    s_branch kf_kernel_p2v_lp
kf_kernel_p2v_ok:
    s_nop 4
    s_branch kf_kernel_p2_bk
kf_kernel_p3_sl:
    s_sleep 2
    s_load_dwordx2 s[16:17], s[40:41], s56 offset:3072 glc
    s_load_dwordx2 s[18:19], s[40:41], s57 offset:3072 glc
    s_load_dwordx2 s[20:21], s[40:41], s58 offset:3072 glc
    s_load_dwordx2 s[54:55], s[40:41], s59 offset:3072 glc
    s_waitcnt lgkmcnt(0)
    s_and_b64 s[16:17], s[16:17], s[18:19]
    s_and_b64 s[16:17], s[16:17], s[20:21]
    s_and_b64 s[16:17], s[16:17], s[54:55]
    s_and_b32 s16, s16, s17
    s_cmp_eq_u32 s16, 1
    s_cbranch_scc1 kf_kernel_p3_bk
    s_sleep 2
    s_load_dwordx2 s[16:17], s[40:41], s56 offset:3072 glc
    s_load_dwordx2 s[18:19], s[40:41], s57 offset:3072 glc
    s_load_dwordx2 s[20:21], s[40:41], s58 offset:3072 glc
    s_load_dwordx2 s[54:55], s[40:41], s59 offset:3072 glc
    s_waitcnt lgkmcnt(0)
    s_and_b64 s[16:17], s[16:17], s[18:19]
    s_and_b64 s[16:17], s[16:17], s[20:21]
    s_and_b64 s[16:17], s[16:17], s[54:55]
    s_and_b32 s16, s16, s17
    s_cmp_eq_u32 s16, 1
    s_cbranch_scc1 kf_kernel_p3_bk
    s_sleep 2
    s_load_dwordx2 s[16:17], s[40:41], s56 offset:3072 glc
    s_load_dwordx2 s[18:19], s[40:41], s57 offset:3072 glc
    s_load_dwordx2 s[20:21], s[40:41], s58 offset:3072 glc
    s_load_dwordx2 s[54:55], s[40:41], s59 offset:3072 glc
    s_waitcnt lgkmcnt(0)
    s_and_b64 s[16:17], s[16:17], s[18:19]
    s_and_b64 s[16:17], s[16:17], s[20:21]
    s_and_b64 s[16:17], s[16:17], s[54:55]
    s_and_b32 s16, s16, s17
    s_cmp_eq_u32 s16, 1
    s_cbranch_scc1 kf_kernel_p3_bk
    s_sleep 2
    s_load_dwordx2 s[16:17], s[40:41], s56 offset:3072 glc
    s_load_dwordx2 s[18:19], s[40:41], s57 offset:3072 glc
    s_load_dwordx2 s[20:21], s[40:41], s58 offset:3072 glc
    s_load_dwordx2 s[54:55], s[40:41], s59 offset:3072 glc
    s_waitcnt lgkmcnt(0)
    s_and_b64 s[16:17], s[16:17], s[18:19]
    s_and_b64 s[16:17], s[16:17], s[20:21]
    s_and_b64 s[16:17], s[16:17], s[54:55]
    s_and_b32 s16, s16, s17
    s_cmp_eq_u32 s16, 1
    s_cbranch_scc1 kf_kernel_p3_bk
    s_sleep 2
    s_load_dwordx2 s[16:17], s[40:41], s56 offset:3072 glc
    s_load_dwordx2 s[18:19], s[40:41], s57 offset:3072 glc
    s_load_dwordx2 s[20:21], s[40:41], s58 offset:3072 glc
    s_load_dwordx2 s[54:55], s[40:41], s59 offset:3072 glc
    s_waitcnt lgkmcnt(0)
    s_and_b64 s[16:17], s[16:17], s[18:19]
    s_and_b64 s[16:17], s[16:17], s[20:21]
    s_and_b64 s[16:17], s[16:17], s[54:55]
    s_and_b32 s16, s16, s17
    s_cmp_eq_u32 s16, 1
    s_cbranch_scc1 kf_kernel_p3_bk
    s_sleep 2
    s_load_dwordx2 s[16:17], s[40:41], s56 offset:3072 glc
    s_load_dwordx2 s[18:19], s[40:41], s57 offset:3072 glc
    s_load_dwordx2 s[20:21], s[40:41], s58 offset:3072 glc
    s_load_dwordx2 s[54:55], s[40:41], s59 offset:3072 glc
    s_waitcnt lgkmcnt(0)
    s_and_b64 s[16:17], s[16:17], s[18:19]
    s_and_b64 s[16:17], s[16:17], s[20:21]
    s_and_b64 s[16:17], s[16:17], s[54:55]
    s_and_b32 s16, s16, s17
    s_cmp_eq_u32 s16, 1
    s_cbranch_scc1 kf_kernel_p3_bk
    s_nop 7
    buffer_load_dwordx2 v[248:249], v21, s[44:47], 0 offen offset:3072 sc1
    s_waitcnt vmcnt(0)
kf_kernel_p3v_lp:
    v_and_b32 v248, v248, v249
    v_cmp_ne_u32 vcc, 1, v248
    s_add_u32 s100, s100, 1
    s_nop 3
    s_cbranch_vccz kf_kernel_p3v_ok
    s_cmp_gt_u32 s100, 30000
    s_cbranch_scc1 kf_kernel_p3v_ok
    s_sleep 1
    buffer_load_dwordx2 v[248:249], v21, s[44:47], 0 offen offset:3072 sc1
    s_waitcnt vmcnt(0)
    s_branch kf_kernel_p3v_lp
kf_kernel_p3v_ok:
    s_nop 4
    s_branch kf_kernel_p3_bk
.section .rodata,"a"
.p2align 6
.amdhsa_kernel k1_kernel
  .amdhsa_next_free_vgpr 512
  .amdhsa_next_free_sgpr 102
  .amdhsa_accum_offset 256
  .amdhsa_group_segment_fixed_size 0
  .amdhsa_kernarg_size 104
  .amdhsa_user_sgpr_count 2
  .amdhsa_user_sgpr_kernarg_segment_ptr 1
  .amdhsa_system_sgpr_workgroup_id_x 1
.end_amdhsa_kernel
.p2align 6
.amdhsa_kernel kf_kernel
  .amdhsa_next_free_vgpr 512
  .amdhsa_next_free_sgpr 102
  .amdhsa_accum_offset 256
  .amdhsa_group_segment_fixed_size 0
  .amdhsa_kernarg_size 104
  .amdhsa_user_sgpr_count 2
  .amdhsa_user_sgpr_kernarg_segment_ptr 1
  .amdhsa_system_sgpr_workgroup_id_x 1
.end_amdhsa_kernel
```
